```python
import torch

def _softmax(x, axis=-1):
    return torch.softmax(x, dim=axis)
def _gelu(x):
    return torch.nn.functional.gelu(x, approximate="tanh")
def _silu(x):
    return torch.nn.functional.silu(x)
def _sigmoid(x):
    return torch.sigmoid(x)
def _layernorm(x, axis=-1, eps=1e-5):
    m = x.mean(dim=axis, keepdim=True)
    v = x.var(dim=axis, keepdim=True, unbiased=False)
    return (x - m) / torch.sqrt(v + eps)
def _scatter_add(tgt, idx, src, axis=0):
    return tgt.clone().index_add_(axis, idx, src)
def _segment_sum(src, seg, n):
    out = torch.zeros((n,) + src.shape[1:], dtype=src.dtype)
    return out.index_add_(0, seg, src)
def _pad(x, pw):
    flat = tuple(v for pair in reversed(pw) for v in pair)
    return torch.nn.functional.pad(x, flat)

kernel_name = 'recurrent_scan__grouped_kv_mqa__mixer_s_mlp__prompt'

def setup_inputs():

    _w = (lambda a: (lambda t: t.to(torch.bfloat16) if t.is_floating_point() else t)(torch.as_tensor(a)))
    def _A_setup():
        B, S, D, H = 1, 2048, 448, 16
        Dh = D // H
        return {
            "x": _w((lambda *s: torch.randn(*s, dtype=torch.bfloat16) * 0.05)(B, S, D)),
            "wq": _w((lambda *s: torch.randn(*s, dtype=torch.bfloat16) * 0.05)(D, H * Dh)),
            "wk": _w((lambda *s: torch.randn(*s, dtype=torch.bfloat16) * 0.05)(D, Dh)),
            "wv": _w((lambda *s: torch.randn(*s, dtype=torch.bfloat16) * 0.05)(D, Dh)),
            "wo": _w((lambda *s: torch.randn(*s, dtype=torch.bfloat16) * 0.05)(H * Dh, D)),
        }
    _A_in = _A_setup()

    def _B_setup():
        B, S, D, F = 1, 2048, 448, 1792
        return {
            "x":  _w((lambda *s: torch.randn(*s, dtype=torch.bfloat16) * 0.05)(B, S, D)),
            "w1": _w((lambda *s: torch.randn(*s, dtype=torch.bfloat16) * 3.2)(D, D) * (D ** -0.5)),
            "w2": _w((lambda *s: torch.randn(*s, dtype=torch.bfloat16) * 3.2)(D, D) * (D ** -0.5)),
            "w3": _w((lambda *s: torch.randn(*s, dtype=torch.bfloat16) * 3.2)(D, F) * (D ** -0.5)),
            "w4": _w((lambda *s: torch.randn(*s, dtype=torch.bfloat16) * 3.2)(F, D) * (F ** -0.5)),
        }
    _B_in = _B_setup()

    return {
        "A_x": _A_in["x"],
        "A_wq": _A_in["wq"],
        "A_wk": _A_in["wk"],
        "A_wv": _A_in["wv"],
        "A_wo": _A_in["wo"],
        "B_x": _B_in["x"],
        "B_w1": _B_in["w1"],
        "B_w2": _B_in["w2"],
        "B_w3": _B_in["w3"],
        "B_w4": _B_in["w4"],
    }

def reference(A_x, A_wq, A_wk, A_wv, A_wo, B_x, B_w1, B_w2, B_w3, B_w4):
    def _A_ref(x, wq, wk, wv, wo):
        B, S, D = x.shape
        H = 16
        Dh = D // H
        q = (lambda x, *d: x.permute(*d))((x @ wq).reshape(B, S, H, Dh), 0, 2, 1, 3)
        k = x @ wk
        v = x @ wv
        scores = torch.einsum("bhqd,bkd->bhqk", q, k) * (Dh ** -0.5)
        p = _softmax(scores, axis=-1)
        o = torch.einsum("bhqk,bkd->bhqd", p, v)
        return (lambda x, *d: x.permute(*d))(o, 0, 2, 1, 3).reshape(B, S, H * Dh) @ wo

    def _B_ref(x, w1, w2, w3, w4):
        B, S, D = x.shape
        h = _gelu(_layernorm(x, axis=-1) @ w1)
        c = D // 4
        g0 = _pad(h[:, :, 0*c:1*c], ((0, 0), (1, 0), (0, 0)))[:, :S, :]
        g1 = _pad(h[:, :, 1*c:2*c], ((0, 0), (0, 1), (0, 0)))[:, 1:, :]
        g2 = _pad(h[:, :, 2*c:3*c], ((0, 0), (2, 0), (0, 0)))[:, :S, :]
        g3 = _pad(h[:, :, 3*c:   ], ((0, 0), (0, 2), (0, 0)))[:, 2:, :]
        hs = torch.concatenate([g0, g1, g2, g3], axis=-1) @ w2
        x1 = x + hs
        h2 = _gelu(_layernorm(x1, axis=-1) @ w3) @ w4
        return x1 + h2

    x = A_x
    xn = _layernorm(x, axis=-1)
    s = _A_ref(xn, A_wq, A_wk, A_wv, A_wo)
    g = _silu(_B_ref(xn, B_w1, B_w2, B_w3, B_w4))
    return x + s * g
```

```asm
; @launch grid=(256,1,1) block=(512,1,1) lds=163840
.amdgcn_target "amdgcn-amd-amdhsa--gfx950"
.text
.globl recurrent_scan__grouped_kv_mqa__mixer_s_mlp__prompt_kernel
.p2align 8
.type recurrent_scan__grouped_kv_mqa__mixer_s_mlp__prompt_kernel,@function
recurrent_scan__grouped_kv_mqa__mixer_s_mlp__prompt_kernel:
    s_cmp_ge_u32 s2, 256
    s_cbranch_scc1 L_END
    s_load_dwordx16 s[64:79], s[0:1], 0
    s_load_dwordx8 s[80:87], s[0:1], 64
    s_load_dwordx2 s[88:89], s[0:1], 96
    v_and_b32 v1, 63, v0
    v_lshrrev_b32 v13, 6, v0
    v_lshlrev_b32 v2, 4, v1
    v_readfirstlane_b32 s3, v13
    v_and_b32 v3, 31, v1
    v_lshrrev_b32 v4, 5, v1
    s_and_b32 s6, s2, 7
    s_lshr_b32 s7, s2, 3
    s_and_b32 s5, s7, 7
    s_lshr_b32 s7, s7, 3
    s_lshl_b32 s4, s6, 2
    s_add_u32 s4, s4, s7
    s_mul_i32 s60, s4, 524288
    s_add_u32 s60, s60, 1048576
    s_and_b32 s61, s3, 3
    s_lshr_b32 s62, s61, 1
    s_and_b32 s63, s61, 1
    s_mov_b32 s10, 1835008
    s_mov_b32 s11, 0x20000
    s_lshl_b32 s7, s4, 3
    s_add_u32 s7, s7, s3
    s_mul_i32 s7, s7, 7168
    s_mul_i32 m0, s3, 7296
    s_add_u32 m0, m0, 57344
    s_mov_b32 exec_hi, 0x00ffffff
    s_waitcnt lgkmcnt(0)
    s_mov_b64 s[8:9], s[64:65]
    buffer_load_dwordx4 v2, s[8:11], s7 offen lds
    s_add_u32 m0, m0, 912
    s_add_u32 s7, s7, 896
    buffer_load_dwordx4 v2, s[8:11], s7 offen lds
    s_add_u32 m0, m0, 912
    s_add_u32 s7, s7, 896
    buffer_load_dwordx4 v2, s[8:11], s7 offen lds
    s_add_u32 m0, m0, 912
    s_add_u32 s7, s7, 896
    buffer_load_dwordx4 v2, s[8:11], s7 offen lds
    s_add_u32 m0, m0, 912
    s_add_u32 s7, s7, 896
    buffer_load_dwordx4 v2, s[8:11], s7 offen lds
    s_add_u32 m0, m0, 912
    s_add_u32 s7, s7, 896
    buffer_load_dwordx4 v2, s[8:11], s7 offen lds
    s_add_u32 m0, m0, 912
    s_add_u32 s7, s7, 896
    buffer_load_dwordx4 v2, s[8:11], s7 offen lds
    s_add_u32 m0, m0, 912
    s_add_u32 s7, s7, 896
    buffer_load_dwordx4 v2, s[8:11], s7 offen lds
    s_mov_b64 exec, -1
    s_mov_b64 s[12:13], s[66:67]
    s_mov_b32 s14, 401408
    s_mov_b32 s15, 0x20000
    s_mov_b64 s[48:49], s[68:69]
    s_mov_b32 s50, 25088
    s_mov_b32 s51, 0x20000
    s_mov_b64 s[52:53], s[70:71]
    s_mov_b32 s54, 25088
    s_mov_b32 s55, 0x20000
    s_mov_b64 s[16:17], s[72:73]
    s_mov_b32 s18, 401408
    s_mov_b32 s19, 0x20000
    s_mov_b64 s[20:21], s[76:77]
    s_mov_b32 s22, 401408
    s_mov_b32 s23, 0x20000
    s_mov_b64 s[24:25], s[78:79]
    s_mov_b32 s26, 401408
    s_mov_b32 s27, 0x20000
    s_mov_b64 s[28:29], s[80:81]
    s_mov_b32 s30, 1605632
    s_mov_b32 s31, 0x20000
    s_mov_b64 s[32:33], s[82:83]
    s_mov_b32 s34, 1605632
    s_mov_b32 s35, 0x20000
    s_mov_b64 s[36:37], s[84:85]
    s_mov_b32 s38, 1835008
    s_mov_b32 s39, 0x20000
    s_mov_b64 s[40:41], s[86:87]
    s_mov_b32 s42, 256
    s_mov_b32 s43, 0x20000
    s_mov_b64 s[44:45], s[88:89]
    s_mov_b32 s46, 23068672
    s_mov_b32 s47, 0x20000
    s_mov_b64 s[56:57], s[28:29]
    s_mov_b32 s58, 1605632
    s_mov_b32 s59, 0x20000
    s_mul_i32 s80, s4, 12288
    s_cmp_eq_u32 s5, 7
    s_cselect_b32 s81, 1, 0
    v_mov_b32 v17, 1
    v_mov_b32 v18, 160768
    v_lshrrev_b32 v13, 3, v1
    v_lshlrev_b32 v14, 2, v1
    v_and_b32 v14, 64, v14
    v_and_b32 v15, 7, v1
    v_lshlrev_b32 v15, 4, v15
    v_xor_b32 v14, v14, v15
    v_mul_u32_u24 v11, 896, v13
    v_add_u32 v11, v11, v14
    s_cmp_ge_u32 s3, 4
    s_cbranch_scc1 L_role_A
    s_setprio 2
    v_mov_b32 v14, 0
    s_cmp_eq_u32 s61, 1
    s_cbranch_scc0 L_g_nozero
    v_lshl_add_u32 v13, v3, 2, v18
    ds_write_b32 v13, v14
L_g_nozero:
    s_lshl_b32 s64, s81, 2
    s_add_u32 s64, s64, s61
    s_cmp_eq_u32 s64, 4
    s_cbranch_scc0 L_g_noclear
    v_lshlrev_b32 v13, 7, v1
    s_mov_b32 exec_hi, 1
    buffer_store_dword v14, v13, s[44:47], s80 offen sc1
    s_mov_b32 exec_hi, -1
    v_lshrrev_b32 v13, 3, v1
    v_lshlrev_b32 v13, 7, v13
    v_and_b32 v15, 7, v1
    v_lshl_add_u32 v13, v15, 2, v13
    buffer_store_dword v14, v13, s[44:47], s80 offen offset:2048 sc1
L_g_noclear:
    s_cmp_eq_u32 s61, 2
    s_cbranch_scc0 L_nocode
L_pc:
    s_getpc_b64 s[66:67]
    s_lshr_b32 s65, s2, 3
    s_lshl_b32 s65, s65, 4
    v_and_b32 v13, 15, v1
    v_add_u32 v13, s65, v13
    v_lshlrev_b32 v13, 7, v13
    v_mov_b32 v25, s67
    v_add_co_u32 v24, vcc, s66, v13
    s_nop 1
    v_addc_co_u32 v25, vcc, 0, v25, vcc
    v_cmp_gt_u32 vcc, L_CODE_END-L_pc-128, v13
    s_nop 1
    s_and_b64 exec, vcc, 0xffff
    s_cbranch_execz L_nocode
    global_load_dword v31, v[24:25], off sc1
L_nocode:
    s_mov_b64 exec, -1
    s_cmp_eq_u32 s61, 3
    s_cbranch_scc0 L_tlb_1
    s_mov_b64 exec, 1
    v_mov_b32 v13, 0
    s_mov_b32 s65, 0x7ff80
    buffer_load_dword v31, v13, s[44:47], s65 offen sc1
    s_add_u32 s65, s60, 524160
    buffer_load_dword v31, v13, s[44:47], s65 offen sc1
    s_mul_i32 s65, s4, 57344
    buffer_load_dword v31, v13, s[36:39], s65 offen sc1
    buffer_load_dword v31, v13, s[24:27], 0 offen
    buffer_load_dword v31, v13, s[28:31], 0 offen
    buffer_load_dword v31, v13, s[32:35], 0 offen
    buffer_load_dword v31, v13, s[16:19], 0 offen
    buffer_load_dword v31, v13, s[40:43], 0 offen sc1
    s_mov_b64 exec, -1
    s_mul_i32 s65, s2, 1664
    v_lshlrev_b32 v13, 7, v1
    s_mov_b64 exec, 0x1fff
    buffer_load_dword v31, v13, s[24:27], s65 offen sc1
    s_mov_b64 exec, -1
    s_mul_i32 s65, s2, 1792
    v_lshlrev_b32 v13, 7, v1
    s_mov_b64 exec, 0x3fff
    buffer_load_dword v31, v13, s[28:31], s65 offen sc1
    s_mov_b64 exec, -1
L_tlb_1:
    v_lshl_add_u32 v8, s62, 5, v3
    v_mul_u32_u24 v8, 912, v8
    v_lshl_add_u32 v8, v4, 4, v8
    v_add_u32 v8, 57344, v8
    v_bfe_u32 v13, v1, 2, 2
    v_and_b32 v14, 3, v1
    v_bfe_u32 v15, v1, 4, 1
    v_lshlrev_b32 v14, 3, v14
    v_lshl_add_u32 v14, v15, 5, v14
    v_and_b32 v16, 1, v1
    v_cmp_eq_u32 vcc, v16, v15
    v_mov_b32 v16, 1065369472
    s_nop 0
    v_cndmask_b32 v20, 0, v16, vcc
    v_cndmask_b32 v21, 0, v16, vcc
    v_cndmask_b32 v22, 0, v16, vcc
    v_cndmask_b32 v23, 0, v16, vcc
    v_lshl_add_u32 v16, v4, 3, v13
    v_mul_u32_u24 v10, 56, v16
    v_add_u32 v10, v10, v14
    v_cmp_le_u32 vcc, 56, v14
    v_lshl_add_u32 v12, v16, 7, v14
    v_lshlrev_b32 v13, 5, v13
    v_and_b32 v13, 64, v13
    v_add_u32 v12, v12, v13
    v_cndmask_b32 v13, 0, 32, vcc
    v_sub_u32 v10, v10, v13
    s_lshl_b32 s65, s63, 6
    v_xor_b32 v9, s65, v12
    v_add_u32 v9, 0, v9
    s_mul_i32 s65, s63, 448
    v_add_u32 v13, s65, v8
    s_mov_b32 s86, 0xc0135761
    s_mov_b32 s87, 0xbdd2d3e8
    s_mov_b32 s67, 1065369472
    v_mov_b32 v24, 0
    v_mov_b32 v25, 0
    v_mov_b32 v26, 0
    v_mov_b32 v27, 0
    s_cmp_eq_u32 s61, 3
    s_cbranch_scc0 L_g_wall
    s_waitcnt vmcnt(10)
    s_branch L_g_b1
L_g_wall:
    s_waitcnt vmcnt(0) lgkmcnt(0)
    s_cmp_eq_u32 s64, 4
    s_cbranch_scc0 L_g_b1
    s_lshl_b32 s65, s4, 2
    s_mov_b64 exec, 1
    buffer_store_dword v17, v24, s[40:43], s65 offen offset:128 sc1
    s_mov_b64 exec, -1
L_g_b1:
    s_barrier
    ds_read_b128 v[136:139], v13 offset:0
    ds_read_b128 v[140:143], v13 offset:32
    ds_read_b128 v[144:147], v13 offset:64
    ds_read_b128 v[148:151], v13 offset:96
    ds_read_b128 v[152:155], v13 offset:128
    ds_read_b128 v[156:159], v13 offset:160
    ds_read_b128 v[160:163], v13 offset:192
    ds_read_b128 v[164:167], v13 offset:224
    ds_read_b128 v[168:171], v13 offset:256
    ds_read_b128 v[172:175], v13 offset:288
    ds_read_b128 v[176:179], v13 offset:320
    ds_read_b128 v[180:183], v13 offset:352
    ds_read_b128 v[184:187], v13 offset:384
    ds_read_b128 v[188:191], v13 offset:416
    s_waitcnt lgkmcnt(13)
    v_dot2_f32_bf16 v24, v136, s67, v24
    v_dot2_f32_bf16 v26, v136, v136, v26
    v_dot2_f32_bf16 v25, v137, s67, v25
    v_dot2_f32_bf16 v27, v137, v137, v27
    v_dot2_f32_bf16 v24, v138, s67, v24
    v_dot2_f32_bf16 v26, v138, v138, v26
    v_dot2_f32_bf16 v25, v139, s67, v25
    v_dot2_f32_bf16 v27, v139, v139, v27
    s_waitcnt lgkmcnt(12)
    v_dot2_f32_bf16 v24, v140, s67, v24
    v_dot2_f32_bf16 v26, v140, v140, v26
    v_dot2_f32_bf16 v25, v141, s67, v25
    v_dot2_f32_bf16 v27, v141, v141, v27
    v_dot2_f32_bf16 v24, v142, s67, v24
    v_dot2_f32_bf16 v26, v142, v142, v26
    v_dot2_f32_bf16 v25, v143, s67, v25
    v_dot2_f32_bf16 v27, v143, v143, v27
    s_waitcnt lgkmcnt(11)
    v_dot2_f32_bf16 v24, v144, s67, v24
    v_dot2_f32_bf16 v26, v144, v144, v26
    v_dot2_f32_bf16 v25, v145, s67, v25
    v_dot2_f32_bf16 v27, v145, v145, v27
    v_dot2_f32_bf16 v24, v146, s67, v24
    v_dot2_f32_bf16 v26, v146, v146, v26
    v_dot2_f32_bf16 v25, v147, s67, v25
    v_dot2_f32_bf16 v27, v147, v147, v27
    s_waitcnt lgkmcnt(10)
    v_dot2_f32_bf16 v24, v148, s67, v24
    v_dot2_f32_bf16 v26, v148, v148, v26
    v_dot2_f32_bf16 v25, v149, s67, v25
    v_dot2_f32_bf16 v27, v149, v149, v27
    v_dot2_f32_bf16 v24, v150, s67, v24
    v_dot2_f32_bf16 v26, v150, v150, v26
    v_dot2_f32_bf16 v25, v151, s67, v25
    v_dot2_f32_bf16 v27, v151, v151, v27
    s_waitcnt lgkmcnt(9)
    v_dot2_f32_bf16 v24, v152, s67, v24
    v_dot2_f32_bf16 v26, v152, v152, v26
    v_dot2_f32_bf16 v25, v153, s67, v25
    v_dot2_f32_bf16 v27, v153, v153, v27
    v_dot2_f32_bf16 v24, v154, s67, v24
    v_dot2_f32_bf16 v26, v154, v154, v26
    v_dot2_f32_bf16 v25, v155, s67, v25
    v_dot2_f32_bf16 v27, v155, v155, v27
    s_waitcnt lgkmcnt(8)
    v_dot2_f32_bf16 v24, v156, s67, v24
    v_dot2_f32_bf16 v26, v156, v156, v26
    v_dot2_f32_bf16 v25, v157, s67, v25
    v_dot2_f32_bf16 v27, v157, v157, v27
    v_dot2_f32_bf16 v24, v158, s67, v24
    v_dot2_f32_bf16 v26, v158, v158, v26
    v_dot2_f32_bf16 v25, v159, s67, v25
    v_dot2_f32_bf16 v27, v159, v159, v27
    s_waitcnt lgkmcnt(7)
    ds_read_b128 v[32:35], v8 offset:0
    v_dot2_f32_bf16 v24, v160, s67, v24
    v_dot2_f32_bf16 v26, v160, v160, v26
    v_dot2_f32_bf16 v25, v161, s67, v25
    v_dot2_f32_bf16 v27, v161, v161, v27
    v_dot2_f32_bf16 v24, v162, s67, v24
    v_dot2_f32_bf16 v26, v162, v162, v26
    v_dot2_f32_bf16 v25, v163, s67, v25
    v_dot2_f32_bf16 v27, v163, v163, v27
    s_waitcnt lgkmcnt(7)
    ds_read_b128 v[36:39], v8 offset:32
    v_dot2_f32_bf16 v24, v164, s67, v24
    v_dot2_f32_bf16 v26, v164, v164, v26
    v_dot2_f32_bf16 v25, v165, s67, v25
    v_dot2_f32_bf16 v27, v165, v165, v27
    v_dot2_f32_bf16 v24, v166, s67, v24
    v_dot2_f32_bf16 v26, v166, v166, v26
    v_dot2_f32_bf16 v25, v167, s67, v25
    v_dot2_f32_bf16 v27, v167, v167, v27
    s_waitcnt lgkmcnt(7)
    ds_read_b128 v[40:43], v8 offset:64
    v_dot2_f32_bf16 v24, v168, s67, v24
    v_dot2_f32_bf16 v26, v168, v168, v26
    v_dot2_f32_bf16 v25, v169, s67, v25
    v_dot2_f32_bf16 v27, v169, v169, v27
    v_dot2_f32_bf16 v24, v170, s67, v24
    v_dot2_f32_bf16 v26, v170, v170, v26
    v_dot2_f32_bf16 v25, v171, s67, v25
    v_dot2_f32_bf16 v27, v171, v171, v27
    s_waitcnt lgkmcnt(7)
    ds_read_b128 v[44:47], v8 offset:96
    v_dot2_f32_bf16 v24, v172, s67, v24
    v_dot2_f32_bf16 v26, v172, v172, v26
    v_dot2_f32_bf16 v25, v173, s67, v25
    v_dot2_f32_bf16 v27, v173, v173, v27
    v_dot2_f32_bf16 v24, v174, s67, v24
    v_dot2_f32_bf16 v26, v174, v174, v26
    v_dot2_f32_bf16 v25, v175, s67, v25
    v_dot2_f32_bf16 v27, v175, v175, v27
    s_waitcnt lgkmcnt(7)
    ds_read_b128 v[48:51], v8 offset:128
    v_dot2_f32_bf16 v24, v176, s67, v24
    v_dot2_f32_bf16 v26, v176, v176, v26
    v_dot2_f32_bf16 v25, v177, s67, v25
    v_dot2_f32_bf16 v27, v177, v177, v27
    v_dot2_f32_bf16 v24, v178, s67, v24
    v_dot2_f32_bf16 v26, v178, v178, v26
    v_dot2_f32_bf16 v25, v179, s67, v25
    v_dot2_f32_bf16 v27, v179, v179, v27
    s_waitcnt lgkmcnt(7)
    ds_read_b128 v[52:55], v8 offset:160
    v_dot2_f32_bf16 v24, v180, s67, v24
    v_dot2_f32_bf16 v26, v180, v180, v26
    v_dot2_f32_bf16 v25, v181, s67, v25
    v_dot2_f32_bf16 v27, v181, v181, v27
    v_dot2_f32_bf16 v24, v182, s67, v24
    v_dot2_f32_bf16 v26, v182, v182, v26
    v_dot2_f32_bf16 v25, v183, s67, v25
    v_dot2_f32_bf16 v27, v183, v183, v27
    s_waitcnt lgkmcnt(7)
    ds_read_b128 v[56:59], v8 offset:192
    v_dot2_f32_bf16 v24, v184, s67, v24
    v_dot2_f32_bf16 v26, v184, v184, v26
    v_dot2_f32_bf16 v25, v185, s67, v25
    v_dot2_f32_bf16 v27, v185, v185, v27
    v_dot2_f32_bf16 v24, v186, s67, v24
    v_dot2_f32_bf16 v26, v186, v186, v26
    v_dot2_f32_bf16 v25, v187, s67, v25
    v_dot2_f32_bf16 v27, v187, v187, v27
    s_waitcnt lgkmcnt(7)
    ds_read_b128 v[60:63], v8 offset:224
    v_dot2_f32_bf16 v24, v188, s67, v24
    v_dot2_f32_bf16 v26, v188, v188, v26
    v_dot2_f32_bf16 v25, v189, s67, v25
    v_dot2_f32_bf16 v27, v189, v189, v27
    v_dot2_f32_bf16 v24, v190, s67, v24
    v_dot2_f32_bf16 v26, v190, v190, v26
    v_dot2_f32_bf16 v25, v191, s67, v25
    v_dot2_f32_bf16 v27, v191, v191, v27
    v_lshl_add_u32 v14, s62, 5, v3
    v_lshlrev_b32 v14, 3, v14
    v_lshl_add_u32 v14, v4, 2, v14
    s_lshl_b32 s66, s63, 9
    s_add_u32 s66, s66, 158720
    v_add_u32 v14, s66, v14
    v_add_f32 v24, v24, v25
    v_add_f32 v26, v26, v27
    s_nop 1
    v_permlane32_swap_b32 v24, v26
    v_add_f32 v24, v24, v26
    ds_write_b32 v14, v24
    s_cmp_eq_u32 s81, 1
    s_cbranch_scc1 L_g_kv
    s_mov_b64 exec, 1
    ds_add_u32 v18, v17 offset:116
    s_mov_b64 exec, -1
    s_mov_b32 s70, 0
L_lw_2:
    ds_read_b32 v15, v18 offset:92
    s_add_u32 s70, s70, 1
    s_cmp_gt_u32 s70, 3200000
    s_cbranch_scc1 L_END
    s_waitcnt lgkmcnt(0)
    v_readfirstlane_b32 s68, v15
    s_nop 1
    s_cmp_ge_u32 s68, 4
    s_cbranch_scc0 L_lw_2
    ds_read_b64_tr_b16 v[64:65], v9 offset:0
    ds_read_b64_tr_b16 v[66:67], v9 offset:512
    ds_read_b64_tr_b16 v[68:69], v9 offset:2048
    ds_read_b64_tr_b16 v[70:71], v9 offset:2560
    ds_read_b64_tr_b16 v[72:73], v9 offset:4096
    ds_read_b64_tr_b16 v[74:75], v9 offset:4608
    ds_read_b64_tr_b16 v[76:77], v9 offset:6144
    ds_read_b64_tr_b16 v[78:79], v9 offset:6656
    s_waitcnt lgkmcnt(6)
    v_mfma_f32_32x32x16_bf16 v[96:111], v[64:67], v[32:35], 0
    ds_read_b64_tr_b16 v[80:81], v9 offset:8192
    ds_read_b64_tr_b16 v[82:83], v9 offset:8704
    ds_read_b32 v15, v18 offset:96
    v_mfma_f32_16x16x32_bf16 v[112:115], v[64:67], v[20:23], 0
    s_waitcnt lgkmcnt(6)
    v_mfma_f32_32x32x16_bf16 v[96:111], v[68:71], v[36:39], v[96:111]
    ds_read_b64_tr_b16 v[84:85], v9 offset:10240
    ds_read_b64_tr_b16 v[86:87], v9 offset:10752
    v_mfma_f32_16x16x32_bf16 v[112:115], v[68:71], v[20:23], v[112:115]
    s_waitcnt lgkmcnt(6)
    v_mfma_f32_32x32x16_bf16 v[96:111], v[72:75], v[40:43], v[96:111]
    ds_read_b64_tr_b16 v[88:89], v9 offset:12288
    ds_read_b64_tr_b16 v[90:91], v9 offset:12800
    v_mfma_f32_16x16x32_bf16 v[112:115], v[72:75], v[20:23], v[112:115]
    s_waitcnt lgkmcnt(6)
    v_mfma_f32_32x32x16_bf16 v[96:111], v[76:79], v[44:47], v[96:111]
    ds_read_b64_tr_b16 v[92:93], v9 offset:14336
    ds_read_b64_tr_b16 v[94:95], v9 offset:14848
    v_mfma_f32_16x16x32_bf16 v[112:115], v[76:79], v[20:23], v[112:115]
    s_waitcnt lgkmcnt(6)
    v_mfma_f32_32x32x16_bf16 v[96:111], v[80:83], v[48:51], v[96:111]
    v_readfirstlane_b32 s68, v15
    s_nop 1
    s_cmp_ge_u32 s68, 4
    s_cbranch_scc1 L_sw_3
    s_mov_b32 s70, 0
L_lw_4:
    ds_read_b32 v15, v18 offset:96
    s_add_u32 s70, s70, 1
    s_cmp_gt_u32 s70, 3200000
    s_cbranch_scc1 L_END
    s_waitcnt lgkmcnt(0)
    v_readfirstlane_b32 s68, v15
    s_nop 1
    s_cmp_ge_u32 s68, 4
    s_cbranch_scc0 L_lw_4
L_sw_3:
    ds_read_b64_tr_b16 v[64:65], v9 offset:16384
    ds_read_b64_tr_b16 v[66:67], v9 offset:16896
    ds_read_b128 v[32:35], v8 offset:256
    v_mfma_f32_16x16x32_bf16 v[112:115], v[80:83], v[20:23], v[112:115]
    s_waitcnt lgkmcnt(7)
    v_mfma_f32_32x32x16_bf16 v[96:111], v[84:87], v[52:55], v[96:111]
    ds_read_b64_tr_b16 v[68:69], v9 offset:18432
    ds_read_b64_tr_b16 v[70:71], v9 offset:18944
    ds_read_b128 v[36:39], v8 offset:288
    v_mfma_f32_16x16x32_bf16 v[112:115], v[84:87], v[20:23], v[112:115]
    s_waitcnt lgkmcnt(8)
    v_mfma_f32_32x32x16_bf16 v[96:111], v[88:91], v[56:59], v[96:111]
    ds_read_b64_tr_b16 v[72:73], v9 offset:20480
    ds_read_b64_tr_b16 v[74:75], v9 offset:20992
    ds_read_b128 v[40:43], v8 offset:320
    v_mfma_f32_16x16x32_bf16 v[112:115], v[88:91], v[20:23], v[112:115]
    s_waitcnt lgkmcnt(9)
    v_mfma_f32_32x32x16_bf16 v[96:111], v[92:95], v[60:63], v[96:111]
    ds_read_b64_tr_b16 v[76:77], v9 offset:22528
    ds_read_b64_tr_b16 v[78:79], v9 offset:23040
    ds_read_b128 v[44:47], v8 offset:352
    v_mfma_f32_16x16x32_bf16 v[112:115], v[92:95], v[20:23], v[112:115]
    s_waitcnt lgkmcnt(9)
    v_mfma_f32_32x32x16_bf16 v[96:111], v[64:67], v[32:35], v[96:111]
    ds_read_b64_tr_b16 v[80:81], v9 offset:24576
    ds_read_b64_tr_b16 v[82:83], v9 offset:25088
    ds_read_b128 v[48:51], v8 offset:384
    ds_read_b32 v15, v18 offset:100
    v_mfma_f32_16x16x32_bf16 v[112:115], v[64:67], v[20:23], v[112:115]
    s_mov_b64 exec, 1
    ds_add_u32 v18, v17 offset:108
    s_mov_b64 exec, -1
    s_waitcnt lgkmcnt(9)
    v_mfma_f32_32x32x16_bf16 v[96:111], v[68:71], v[36:39], v[96:111]
    ds_read_b64_tr_b16 v[84:85], v9 offset:26624
    ds_read_b64_tr_b16 v[86:87], v9 offset:27136
    ds_read_b128 v[52:55], v8 offset:416
    v_mfma_f32_16x16x32_bf16 v[112:115], v[68:71], v[20:23], v[112:115]
    s_waitcnt lgkmcnt(9)
    v_mfma_f32_32x32x16_bf16 v[96:111], v[72:75], v[40:43], v[96:111]
    ds_read_b64_tr_b16 v[88:89], v9 offset:28672
    ds_read_b64_tr_b16 v[90:91], v9 offset:29184
    ds_read_b128 v[56:59], v8 offset:448
    v_mfma_f32_16x16x32_bf16 v[112:115], v[72:75], v[20:23], v[112:115]
    s_waitcnt lgkmcnt(9)
    v_mfma_f32_32x32x16_bf16 v[96:111], v[76:79], v[44:47], v[96:111]
    ds_read_b64_tr_b16 v[92:93], v9 offset:30720
    ds_read_b64_tr_b16 v[94:95], v9 offset:31232
    ds_read_b128 v[60:63], v8 offset:480
    v_mfma_f32_16x16x32_bf16 v[112:115], v[76:79], v[20:23], v[112:115]
    s_waitcnt lgkmcnt(9)
    v_mfma_f32_32x32x16_bf16 v[96:111], v[80:83], v[48:51], v[96:111]
    v_readfirstlane_b32 s68, v15
    s_nop 1
    s_cmp_ge_u32 s68, 4
    s_cbranch_scc1 L_sw_5
    s_mov_b32 s70, 0
L_lw_6:
    ds_read_b32 v15, v18 offset:100
    s_add_u32 s70, s70, 1
    s_cmp_gt_u32 s70, 3200000
    s_cbranch_scc1 L_END
    s_waitcnt lgkmcnt(0)
    v_readfirstlane_b32 s68, v15
    s_nop 1
    s_cmp_ge_u32 s68, 4
    s_cbranch_scc0 L_lw_6
L_sw_5:
    ds_read_b64_tr_b16 v[64:65], v9 offset:32768
    ds_read_b64_tr_b16 v[66:67], v9 offset:33280
    ds_read_b128 v[32:35], v8 offset:512
    v_mfma_f32_16x16x32_bf16 v[112:115], v[80:83], v[20:23], v[112:115]
    s_waitcnt lgkmcnt(9)
    v_mfma_f32_32x32x16_bf16 v[96:111], v[84:87], v[52:55], v[96:111]
    ds_read_b64_tr_b16 v[68:69], v9 offset:34816
    ds_read_b64_tr_b16 v[70:71], v9 offset:35328
    ds_read_b128 v[36:39], v8 offset:544
    v_mfma_f32_16x16x32_bf16 v[112:115], v[84:87], v[20:23], v[112:115]
    s_waitcnt lgkmcnt(9)
    v_mfma_f32_32x32x16_bf16 v[96:111], v[88:91], v[56:59], v[96:111]
    ds_read_b64_tr_b16 v[72:73], v9 offset:36864
    ds_read_b64_tr_b16 v[74:75], v9 offset:37376
    ds_read_b128 v[40:43], v8 offset:576
    v_mfma_f32_16x16x32_bf16 v[112:115], v[88:91], v[20:23], v[112:115]
    s_waitcnt lgkmcnt(9)
    v_mfma_f32_32x32x16_bf16 v[96:111], v[92:95], v[60:63], v[96:111]
    ds_read_b64_tr_b16 v[76:77], v9 offset:38912
    ds_read_b64_tr_b16 v[78:79], v9 offset:39424
    ds_read_b128 v[44:47], v8 offset:608
    v_mfma_f32_16x16x32_bf16 v[112:115], v[92:95], v[20:23], v[112:115]
    s_waitcnt lgkmcnt(9)
    v_mfma_f32_32x32x16_bf16 v[96:111], v[64:67], v[32:35], v[96:111]
    ds_read_b64_tr_b16 v[80:81], v9 offset:40960
    ds_read_b64_tr_b16 v[82:83], v9 offset:41472
    ds_read_b128 v[48:51], v8 offset:640
    ds_read_b32 v15, v18 offset:104
    v_mfma_f32_16x16x32_bf16 v[112:115], v[64:67], v[20:23], v[112:115]
    s_mov_b64 exec, 1
    ds_add_u32 v18, v17 offset:112
    s_mov_b64 exec, -1
    s_waitcnt lgkmcnt(9)
    v_mfma_f32_32x32x16_bf16 v[96:111], v[68:71], v[36:39], v[96:111]
    ds_read_b64_tr_b16 v[84:85], v9 offset:43008
    ds_read_b64_tr_b16 v[86:87], v9 offset:43520
    ds_read_b128 v[52:55], v8 offset:672
    v_mfma_f32_16x16x32_bf16 v[112:115], v[68:71], v[20:23], v[112:115]
    s_waitcnt lgkmcnt(9)
    v_mfma_f32_32x32x16_bf16 v[96:111], v[72:75], v[40:43], v[96:111]
    ds_read_b64_tr_b16 v[88:89], v9 offset:45056
    ds_read_b64_tr_b16 v[90:91], v9 offset:45568
    ds_read_b128 v[56:59], v8 offset:704
    v_mfma_f32_16x16x32_bf16 v[112:115], v[72:75], v[20:23], v[112:115]
    s_waitcnt lgkmcnt(9)
    v_mfma_f32_32x32x16_bf16 v[96:111], v[76:79], v[44:47], v[96:111]
    ds_read_b64_tr_b16 v[92:93], v9 offset:47104
    ds_read_b64_tr_b16 v[94:95], v9 offset:47616
    ds_read_b128 v[60:63], v8 offset:736
    v_mfma_f32_16x16x32_bf16 v[112:115], v[76:79], v[20:23], v[112:115]
    s_waitcnt lgkmcnt(9)
    v_mfma_f32_32x32x16_bf16 v[96:111], v[80:83], v[48:51], v[96:111]
    v_readfirstlane_b32 s68, v15
    s_nop 1
    s_cmp_ge_u32 s68, 4
    s_cbranch_scc1 L_sw_7
    s_mov_b32 s70, 0
L_lw_8:
    ds_read_b32 v15, v18 offset:104
    s_add_u32 s70, s70, 1
    s_cmp_gt_u32 s70, 3200000
    s_cbranch_scc1 L_END
    s_waitcnt lgkmcnt(0)
    v_readfirstlane_b32 s68, v15
    s_nop 1
    s_cmp_ge_u32 s68, 4
    s_cbranch_scc0 L_lw_8
L_sw_7:
    ds_read_b64_tr_b16 v[64:65], v9 offset:49152
    ds_read_b64_tr_b16 v[66:67], v9 offset:49664
    ds_read_b128 v[32:35], v8 offset:768
    v_mfma_f32_16x16x32_bf16 v[112:115], v[80:83], v[20:23], v[112:115]
    s_waitcnt lgkmcnt(9)
    v_mfma_f32_32x32x16_bf16 v[96:111], v[84:87], v[52:55], v[96:111]
    ds_read_b64_tr_b16 v[68:69], v9 offset:51200
    ds_read_b64_tr_b16 v[70:71], v9 offset:51712
    ds_read_b128 v[36:39], v8 offset:800
    v_mfma_f32_16x16x32_bf16 v[112:115], v[84:87], v[20:23], v[112:115]
    s_mov_b32 s70, 0
L_lw_9:
    ds_read_b32 v16, v18 offset:116
    s_add_u32 s70, s70, 1
    s_cmp_gt_u32 s70, 3200000
    s_cbranch_scc1 L_END
    s_waitcnt lgkmcnt(0)
    v_readfirstlane_b32 s68, v16
    s_nop 1
    s_cmp_ge_u32 s68, 4
    s_cbranch_scc0 L_lw_9
    v_lshl_add_u32 v13, s62, 5, v3
    v_lshlrev_b32 v13, 3, v13
    v_add_u32 v13, 158720, v13
    ds_read_b64 v[136:137], v13
    ds_read_b64 v[138:139], v13 offset:512
    s_waitcnt lgkmcnt(9)
    v_mfma_f32_32x32x16_bf16 v[96:111], v[88:91], v[56:59], v[96:111]
    ds_read_b64_tr_b16 v[72:73], v9 offset:53248
    ds_read_b64_tr_b16 v[74:75], v9 offset:53760
    ds_read_b128 v[40:43], v8 offset:832
    v_mfma_f32_16x16x32_bf16 v[112:115], v[88:91], v[20:23], v[112:115]
    s_waitcnt lgkmcnt(9)
    v_mfma_f32_32x32x16_bf16 v[96:111], v[92:95], v[60:63], v[96:111]
    ds_read_b64_tr_b16 v[76:77], v9 offset:55296
    ds_read_b64_tr_b16 v[78:79], v9 offset:55808
    ds_read_b128 v[44:47], v8 offset:864
    v_mfma_f32_16x16x32_bf16 v[112:115], v[92:95], v[20:23], v[112:115]
    s_waitcnt lgkmcnt(9)
    v_mfma_f32_32x32x16_bf16 v[96:111], v[64:67], v[32:35], v[96:111]
    v_mfma_f32_16x16x32_bf16 v[112:115], v[64:67], v[20:23], v[112:115]
    s_waitcnt lgkmcnt(6)
    v_mfma_f32_32x32x16_bf16 v[96:111], v[68:71], v[36:39], v[96:111]
    v_mfma_f32_16x16x32_bf16 v[112:115], v[68:71], v[20:23], v[112:115]
    s_waitcnt lgkmcnt(3)
    v_mfma_f32_32x32x16_bf16 v[96:111], v[72:75], v[40:43], v[96:111]
    v_mfma_f32_16x16x32_bf16 v[112:115], v[72:75], v[20:23], v[112:115]
    v_add_f32 v136, v136, v138
    v_add_f32 v137, v137, v139
    v_mul_f32 v5, 0x3b124925, v136
    v_mul_f32 v137, 0x3b124925, v137
    v_fma_f32 v137, -v5, v5, v137
    v_max_f32 v137, 0, v137
    v_add_f32 v138, 0x3727c5ac, v137
    v_rsq_f32 v6, v138
    s_nop 0
    v_mul_f32 v137, v137, v6
    v_fmaak_f32 v137, v137, v6, 0x3727c5ac
    v_rsq_f32 v137, v137
    s_nop 0
    v_mul_f32 v7, v6, v137
    s_waitcnt lgkmcnt(0)
    v_mfma_f32_32x32x16_bf16 v[96:111], v[76:79], v[44:47], v[96:111]
    v_mfma_f32_16x16x32_bf16 v[112:115], v[76:79], v[20:23], v[112:115]
    v_lshlrev_b32 v13, 2, v3
    buffer_load_dword v30, v13, s[40:43], 0 offen offset:128 sc1
    s_lshl_b32 s65, s5, 1
    s_add_u32 s65, s65, s63
    s_lshl_b32 s66, s65, 6
    v_lshlrev_b32 v13, 3, v4
    v_sub_u32 v13, v8, v13
    v_add_u32 v13, s66, v13
    ds_read_b64 v[232:233], v13 offset:0
    ds_read_b64 v[234:235], v13 offset:16
    ds_read_b64 v[236:237], v13 offset:32
    ds_read_b64 v[238:239], v13 offset:48
    s_lshl_b32 s68, s3, 7
    s_add_u32 s68, s68, 160896
    v_and_b32 v13, 15, v1
    v_cmp_gt_u32 vcc, 2, v13
    v_lshlrev_b32 v13, 6, v13
    v_and_b32 v14, 48, v1
    v_add3_u32 v13, v13, v14, s68
    s_mov_b64 exec, vcc
    ds_write_b128 v13, v[112:115]
    s_mov_b64 exec, -1
    v_lshl_add_u32 v13, v4, 4, s68
    ds_read_b128 v[120:123], v13 offset:0
    ds_read_b128 v[124:127], v13 offset:32
    ds_read_b128 v[128:131], v13 offset:64
    ds_read_b128 v[132:135], v13 offset:96
    s_waitcnt lgkmcnt(0)
    s_mov_b64 exec, 1
    ds_add_u32 v18, v17 offset:0
    s_mov_b64 exec, -1
    v_fma_f32 v96, -v5, v120, v96
    v_fma_f32 v97, -v5, v121, v97
    v_fma_f32 v98, -v5, v122, v98
    v_fma_f32 v99, -v5, v123, v99
    v_fma_f32 v100, -v5, v124, v100
    v_fma_f32 v101, -v5, v125, v101
    v_fma_f32 v102, -v5, v126, v102
    v_fma_f32 v103, -v5, v127, v103
    v_fma_f32 v104, -v5, v128, v104
    v_fma_f32 v105, -v5, v129, v105
    v_fma_f32 v106, -v5, v130, v106
    v_fma_f32 v107, -v5, v131, v107
    v_fma_f32 v108, -v5, v132, v108
    v_fma_f32 v109, -v5, v133, v109
    v_fma_f32 v110, -v5, v134, v110
    v_fma_f32 v111, -v5, v135, v111
    v_mul_f32 v96, v96, v7
    v_mul_f32 v97, v97, v7
    v_mul_f32 v98, v98, v7
    v_mul_f32 v99, v99, v7
    v_mul_f32 v100, v100, v7
    v_mul_f32 v101, v101, v7
    v_mul_f32 v102, v102, v7
    v_mul_f32 v103, v103, v7
    v_mul_f32 v104, v104, v7
    v_mul_f32 v105, v105, v7
    v_mul_f32 v106, v106, v7
    v_mul_f32 v107, v107, v7
    v_mul_f32 v108, v108, v7
    v_mul_f32 v109, v109, v7
    v_mul_f32 v110, v110, v7
    v_mul_f32 v111, v111, v7
    v_mov_b32 v16, s86
    v_mul_f32 v136, v96, v96
    v_mul_f32 v137, v97, v97
    v_mul_f32 v138, v98, v98
    v_mul_f32 v139, v99, v99
    v_mul_f32 v140, v100, v100
    v_mul_f32 v141, v101, v101
    v_mul_f32 v142, v102, v102
    v_mul_f32 v143, v103, v103
    v_mul_f32 v144, v104, v104
    v_mul_f32 v145, v105, v105
    v_mul_f32 v146, v106, v106
    v_mul_f32 v147, v107, v107
    v_mul_f32 v148, v108, v108
    v_mul_f32 v149, v109, v109
    v_mul_f32 v150, v110, v110
    v_mul_f32 v151, v111, v111
    v_fma_f32 v136, v136, s87, v16
    v_fma_f32 v137, v137, s87, v16
    v_fma_f32 v138, v138, s87, v16
    v_fma_f32 v139, v139, s87, v16
    v_fma_f32 v140, v140, s87, v16
    v_fma_f32 v141, v141, s87, v16
    v_fma_f32 v142, v142, s87, v16
    v_fma_f32 v143, v143, s87, v16
    v_fma_f32 v144, v144, s87, v16
    v_fma_f32 v145, v145, s87, v16
    v_fma_f32 v146, v146, s87, v16
    v_fma_f32 v147, v147, s87, v16
    v_fma_f32 v148, v148, s87, v16
    v_fma_f32 v149, v149, s87, v16
    v_fma_f32 v150, v150, s87, v16
    v_fma_f32 v151, v151, s87, v16
    v_mul_f32 v136, v136, v96
    v_mul_f32 v137, v137, v97
    v_mul_f32 v138, v138, v98
    v_mul_f32 v139, v139, v99
    v_mul_f32 v140, v140, v100
    v_mul_f32 v141, v141, v101
    v_mul_f32 v142, v142, v102
    v_mul_f32 v143, v143, v103
    v_mul_f32 v144, v144, v104
    v_mul_f32 v145, v145, v105
    v_mul_f32 v146, v146, v106
    v_mul_f32 v147, v147, v107
    v_mul_f32 v148, v148, v108
    v_mul_f32 v149, v149, v109
    v_mul_f32 v150, v150, v110
    v_mul_f32 v151, v151, v111
    v_exp_f32 v136, v136
    v_exp_f32 v137, v137
    v_exp_f32 v138, v138
    v_exp_f32 v139, v139
    v_exp_f32 v140, v140
    v_exp_f32 v141, v141
    v_exp_f32 v142, v142
    v_exp_f32 v143, v143
    v_exp_f32 v144, v144
    v_exp_f32 v145, v145
    v_exp_f32 v146, v146
    v_exp_f32 v147, v147
    v_exp_f32 v148, v148
    v_exp_f32 v149, v149
    v_exp_f32 v150, v150
    v_exp_f32 v151, v151
    v_add_f32 v136, 1.0, v136
    v_add_f32 v137, 1.0, v137
    v_add_f32 v138, 1.0, v138
    v_add_f32 v139, 1.0, v139
    v_add_f32 v140, 1.0, v140
    v_add_f32 v141, 1.0, v141
    v_add_f32 v142, 1.0, v142
    v_add_f32 v143, 1.0, v143
    v_add_f32 v144, 1.0, v144
    v_add_f32 v145, 1.0, v145
    v_add_f32 v146, 1.0, v146
    v_add_f32 v147, 1.0, v147
    v_add_f32 v148, 1.0, v148
    v_add_f32 v149, 1.0, v149
    v_add_f32 v150, 1.0, v150
    v_add_f32 v151, 1.0, v151
    v_rcp_f32 v136, v136
    v_rcp_f32 v137, v137
    v_rcp_f32 v138, v138
    v_rcp_f32 v139, v139
    v_rcp_f32 v140, v140
    v_rcp_f32 v141, v141
    v_rcp_f32 v142, v142
    v_rcp_f32 v143, v143
    v_rcp_f32 v144, v144
    v_rcp_f32 v145, v145
    v_rcp_f32 v146, v146
    v_rcp_f32 v147, v147
    v_rcp_f32 v148, v148
    v_rcp_f32 v149, v149
    v_rcp_f32 v150, v150
    v_rcp_f32 v151, v151
    v_mul_f32 v96, v96, v136
    v_mul_f32 v97, v97, v137
    v_mul_f32 v98, v98, v138
    v_mul_f32 v99, v99, v139
    v_mul_f32 v100, v100, v140
    v_mul_f32 v101, v101, v141
    v_mul_f32 v102, v102, v142
    v_mul_f32 v103, v103, v143
    v_mul_f32 v104, v104, v144
    v_mul_f32 v105, v105, v145
    v_mul_f32 v106, v106, v146
    v_mul_f32 v107, v107, v147
    v_mul_f32 v108, v108, v148
    v_mul_f32 v109, v109, v149
    v_mul_f32 v110, v110, v150
    v_mul_f32 v111, v111, v151
    v_cvt_pk_bf16_f32 v136, v96, v97
    v_cvt_pk_bf16_f32 v137, v98, v99
    v_cvt_pk_bf16_f32 v138, v100, v101
    v_cvt_pk_bf16_f32 v139, v102, v103
    v_cvt_pk_bf16_f32 v140, v104, v105
    v_cvt_pk_bf16_f32 v141, v106, v107
    v_cvt_pk_bf16_f32 v142, v108, v109
    v_cvt_pk_bf16_f32 v143, v110, v111
    v_lshlrev_b32 v8, 4, v3
    v_lshl_add_u32 v8, v4, 10, v8
    s_lshl_b32 s65, s65, 12
    s_lshl_b32 s66, s62, 9
    s_add_u32 s65, s65, s66
    s_add_u32 s79, s65, s60
    v_permlane32_swap_b32 v136, v138
    v_permlane32_swap_b32 v137, v139
    v_permlane32_swap_b32 v140, v142
    v_permlane32_swap_b32 v141, v143
    s_add_u32 s65, s79, 0
    buffer_store_dwordx4 v[136:139], v8, s[44:47], s65 offen sc1
    buffer_store_dwordx4 v[140:143], v8, s[44:47], s65 offen offset:2048 sc1
    s_lshl_b32 s65, s4, 6
    s_lshl_b32 s66, s62, 5
    s_add_u32 s65, s65, s66
    s_add_u32 s66, s63, 1
    s_sub_u32 s67, s65, s66
    s_add_u32 s65, s65, s66
    s_mov_b32 s66, 524288
    v_add_u32 v14, s67, v3
    v_cmp_gt_u32 vcc, 2048, v14
    v_lshrrev_b32 v15, 6, v14
    v_and_b32 v14, 63, v14
    v_mul_lo_u32 v15, v15, s66
    v_lshl_add_u32 v15, v14, 4, v15
    v_lshl_add_u32 v15, v4, 10, v15
    v_mov_b32 v14, 1073741824
    v_cndmask_b32 v24, v14, v15, vcc
    v_add_u32 v14, s65, v3
    v_cmp_gt_u32 vcc, 2048, v14
    v_lshrrev_b32 v15, 6, v14
    v_and_b32 v14, 63, v14
    v_mul_lo_u32 v15, v15, s66
    v_lshl_add_u32 v15, v14, 4, v15
    v_lshl_add_u32 v15, v4, 10, v15
    v_mov_b32 v14, 1073741824
    v_cndmask_b32 v25, v14, v15, vcc
    v_lshrrev_b32 v13, 3, v1
    v_lshlrev_b32 v14, 2, v1
    v_and_b32 v14, 64, v14
    v_and_b32 v15, 7, v1
    v_lshlrev_b32 v15, 4, v15
    v_xor_b32 v14, v14, v15
    v_mul_u32_u24 v10, 3584, v13
    v_add_u32 v10, v10, v14
    s_getreg_b32 s82, hwreg(HW_REG_XCC_ID)
    s_and_b32 s82, s82, 15
    s_add_u32 s82, s82, 1
    v_lshlrev_b32 v13, 2, v3
    s_mov_b32 s70, 0
    s_waitcnt vmcnt(0)
L_dbg_10:
    v_cmp_eq_u32 vcc, 0, v30
    s_cbranch_vccz L_dbgok_11
    buffer_load_dword v30, v13, s[40:43], 0 offen offset:128 sc1
    s_waitcnt vmcnt(0)
    s_add_u32 s70, s70, 1
    s_cmp_gt_u32 s70, 400000
    s_cbranch_scc1 L_END
    s_branch L_dbg_10
L_dbgok_11:
    s_waitcnt vmcnt(0)
    s_mov_b64 exec, 1
    ds_add_rtn_u32 v13, v18, v17 offset:20
    s_lshl_b32 s67, s5, 7
    s_add_u32 s67, s67, s80
    s_add_u32 s67, s67, 0
    s_waitcnt lgkmcnt(0)
    v_readfirstlane_b32 s68, v13
    v_mov_b32 v13, 0
    s_nop 0
    s_cmp_eq_u32 s68, 3
    s_cbranch_scc0 L_sig_12
    v_mov_b32 v14, s82
    buffer_store_dword v14, v13, s[44:47], s67 offen sc1
L_sig_12:
    s_mov_b64 exec, -1
    s_setprio 0
    s_mul_i32 s74, s61, 24576
    s_add_u32 s74, s74, 57344
    s_lshl_b32 s72, s5, 2
    s_add_u32 s72, s72, s61
    s_lshl_b32 s72, s72, 7
    s_mov_b32 s70, 0
L_lw_13:
    ds_read_b32 v15, v18 offset:4
    s_add_u32 s70, s70, 1
    s_cmp_gt_u32 s70, 3200000
    s_cbranch_scc1 L_END
    s_waitcnt lgkmcnt(0)
    v_readfirstlane_b32 s68, v15
    s_nop 1
    s_cmp_ge_u32 s68, 12
    s_cbranch_scc0 L_lw_13
    s_lshl_b32 s64, s61, 10
    s_mul_i32 s66, s61, 7168
    s_lshl_b32 s65, s5, 7
    s_add_u32 s66, s66, s65
    s_add_u32 m0, s64, 8192
    s_add_u32 s65, s66, 57344
    buffer_load_dwordx4 v11, s[24:27], s65 offen lds
    s_add_u32 m0, s64, 12288
    s_add_u32 s65, s66, 86016
    buffer_load_dwordx4 v11, s[24:27], s65 offen lds
    s_add_u32 m0, s74, 8192
    s_add_u32 s69, s72, 28672
    buffer_load_dwordx4 v10, s[28:31], s72 offen lds
    s_add_u32 m0, m0, 1024
    s_add_u32 s72, s72, 57344
    buffer_load_dwordx4 v10, s[28:31], s69 offen lds
    s_add_u32 m0, s74, 10240
    s_add_u32 s69, s72, 28672
    buffer_load_dwordx4 v10, s[28:31], s72 offen lds
    s_add_u32 m0, m0, 1024
    s_add_u32 s72, s72, 57344
    buffer_load_dwordx4 v10, s[28:31], s69 offen lds
    s_add_u32 m0, s74, 12288
    s_add_u32 s69, s72, 28672
    buffer_load_dwordx4 v10, s[28:31], s72 offen lds
    s_add_u32 m0, m0, 1024
    s_add_u32 s72, s72, 57344
    buffer_load_dwordx4 v10, s[28:31], s69 offen lds
    s_add_u32 m0, s74, 14336
    s_add_u32 s69, s72, 28672
    buffer_load_dwordx4 v10, s[28:31], s72 offen lds
    s_add_u32 m0, m0, 1024
    s_add_u32 s72, s72, 57344
    buffer_load_dwordx4 v10, s[28:31], s69 offen lds
    s_add_u32 m0, s74, 16384
    s_add_u32 s69, s72, 28672
    buffer_load_dwordx4 v10, s[28:31], s72 offen lds
    s_add_u32 m0, m0, 1024
    s_add_u32 s72, s72, 57344
    buffer_load_dwordx4 v10, s[28:31], s69 offen lds
    s_add_u32 m0, s74, 18432
    s_add_u32 s69, s72, 28672
    buffer_load_dwordx4 v10, s[28:31], s72 offen lds
    s_add_u32 m0, m0, 1024
    s_add_u32 s72, s72, 57344
    buffer_load_dwordx4 v10, s[28:31], s69 offen lds
    s_add_u32 m0, s74, 20480
    s_add_u32 s69, s72, 28672
    buffer_load_dwordx4 v10, s[28:31], s72 offen lds
    s_add_u32 m0, m0, 1024
    s_add_u32 s72, s72, 57344
    buffer_load_dwordx4 v10, s[28:31], s69 offen lds
    s_add_u32 m0, s74, 22528
    s_add_u32 s69, s72, 28672
    buffer_load_dwordx4 v10, s[28:31], s72 offen lds
    s_add_u32 m0, m0, 1024
    s_add_u32 s72, s72, 57344
    buffer_load_dwordx4 v10, s[28:31], s69 offen lds
    v_mul_f32 v13, v5, v6
    v_lshlrev_b32 v240, 16, v232
    v_and_b32 v241, 0xffff0000, v232
    v_lshlrev_b32 v242, 16, v233
    v_and_b32 v243, 0xffff0000, v233
    v_lshlrev_b32 v244, 16, v234
    v_and_b32 v245, 0xffff0000, v234
    v_lshlrev_b32 v246, 16, v235
    v_and_b32 v247, 0xffff0000, v235
    v_lshlrev_b32 v248, 16, v236
    v_and_b32 v249, 0xffff0000, v236
    v_lshlrev_b32 v250, 16, v237
    v_and_b32 v251, 0xffff0000, v237
    v_lshlrev_b32 v252, 16, v238
    v_and_b32 v253, 0xffff0000, v238
    v_lshlrev_b32 v254, 16, v239
    v_and_b32 v255, 0xffff0000, v239
    v_fma_f32 v240, v240, v6, -v13
    v_fma_f32 v241, v241, v6, -v13
    v_fma_f32 v242, v242, v6, -v13
    v_fma_f32 v243, v243, v6, -v13
    v_fma_f32 v244, v244, v6, -v13
    v_fma_f32 v245, v245, v6, -v13
    v_fma_f32 v246, v246, v6, -v13
    v_fma_f32 v247, v247, v6, -v13
    v_fma_f32 v248, v248, v6, -v13
    v_fma_f32 v249, v249, v6, -v13
    v_fma_f32 v250, v250, v6, -v13
    v_fma_f32 v251, v251, v6, -v13
    v_fma_f32 v252, v252, v6, -v13
    v_fma_f32 v253, v253, v6, -v13
    v_fma_f32 v254, v254, v6, -v13
    v_fma_f32 v255, v255, v6, -v13
    s_mul_i32 s65, s63, 28672
    s_lshl_b32 s66, s63, 6
    v_xor_b32 v30, s66, v12
    v_xor_b32 v31, 64, v30
    v_add_u32 v30, s65, v30
    v_add_u32 v31, s65, v31
    v_add_u32 v27, s74, v12
    v_xor_b32 v28, 64, v27
    v_lshlrev_b32 v26, 4, v3
    v_lshl_add_u32 v26, v4, 11, v26
    s_lshr_b32 s76, s5, 1
    s_lshl_b32 s76, s76, 9
    s_and_b32 s66, s5, 1
    s_lshl_b32 s66, s66, 1
    s_add_u32 s66, s66, s63
    s_lshl_b32 s66, s66, 2
    s_add_u32 s76, s76, s66
    s_lshl_b32 s66, s62, 12
    s_add_u32 s76, s76, s66
    s_add_u32 s76, s76, s60
    s_add_u32 s76, s76, 172032
    s_lshl_b32 s83, s5, 2
    s_add_u32 s83, s83, s61
    s_mul_i32 s78, s83, 12288
    s_add_u32 s78, s78, 1920
    s_lshl_b32 s83, s83, 8
    s_add_u32 s83, s83, 458752
    v_mov_b32 v29, 0
    s_mul_i32 s64, s63, 28672
    s_add_u32 s64, s64, 1048576
    ds_read_b32 v15, v18 offset:68
    s_waitcnt vmcnt(16)
    s_mov_b64 exec, 1
    ds_add_u32 v18, v17 offset:52
    s_mov_b64 exec, -1
    s_waitcnt lgkmcnt(1)
    v_readfirstlane_b32 s68, v15
    s_nop 1
    s_cmp_eq_u32 s68, 1
    s_cbranch_scc1 L_hearly_14
    s_waitcnt vmcnt(0)
    ds_read_b64_tr_b16 v[136:137], v27 offset:8192
    ds_read_b64_tr_b16 v[138:139], v27 offset:8704
    ds_read_b64_tr_b16 v[140:141], v28 offset:8192
    ds_read_b64_tr_b16 v[142:143], v28 offset:8704
    ds_read_b64_tr_b16 v[144:145], v27 offset:10240
    ds_read_b64_tr_b16 v[146:147], v27 offset:10752
    ds_read_b64_tr_b16 v[148:149], v28 offset:10240
    ds_read_b64_tr_b16 v[150:151], v28 offset:10752
    s_waitcnt lgkmcnt(4)
    ds_read_b64_tr_b16 v[152:153], v27 offset:12288
    ds_read_b64_tr_b16 v[154:155], v27 offset:12800
    ds_read_b64_tr_b16 v[156:157], v28 offset:12288
    ds_read_b64_tr_b16 v[158:159], v28 offset:12800
    ds_read_b64_tr_b16 v[160:161], v27 offset:14336
    ds_read_b64_tr_b16 v[162:163], v27 offset:14848
    ds_read_b64_tr_b16 v[164:165], v28 offset:14336
    ds_read_b64_tr_b16 v[166:167], v28 offset:14848
    s_waitcnt lgkmcnt(4)
    ds_read_b64_tr_b16 v[168:169], v27 offset:16384
    ds_read_b64_tr_b16 v[170:171], v27 offset:16896
    ds_read_b64_tr_b16 v[172:173], v28 offset:16384
    ds_read_b64_tr_b16 v[174:175], v28 offset:16896
    ds_read_b64_tr_b16 v[176:177], v27 offset:18432
    ds_read_b64_tr_b16 v[178:179], v27 offset:18944
    ds_read_b64_tr_b16 v[180:181], v28 offset:18432
    ds_read_b64_tr_b16 v[182:183], v28 offset:18944
    s_waitcnt lgkmcnt(4)
    ds_read_b64_tr_b16 v[184:185], v27 offset:20480
    ds_read_b64_tr_b16 v[186:187], v27 offset:20992
    ds_read_b64_tr_b16 v[188:189], v28 offset:20480
    ds_read_b64_tr_b16 v[190:191], v28 offset:20992
    ds_read_b64_tr_b16 v[192:193], v27 offset:22528
    ds_read_b64_tr_b16 v[194:195], v27 offset:23040
    ds_read_b64_tr_b16 v[196:197], v28 offset:22528
    ds_read_b64_tr_b16 v[198:199], v28 offset:23040
    s_waitcnt lgkmcnt(4)
    s_waitcnt lgkmcnt(0)
    s_mov_b32 s70, 0
L_lw_16:
    ds_read_b32 v15, v18 offset:68
    s_add_u32 s70, s70, 1
    s_cmp_gt_u32 s70, 3200000
    s_cbranch_scc1 L_END
    s_waitcnt lgkmcnt(0)
    v_readfirstlane_b32 s68, v15
    s_nop 1
    s_cmp_ge_u32 s68, 1
    s_cbranch_scc0 L_lw_16
    s_bitcmp1_b32 s68, 0
    s_cbranch_scc1 L_take_17
    s_cmp_lg_u32 s61, 0
    s_cbranch_scc1 L_other_18
    v_lshrrev_b32 v15, 3, v1
    v_mul_u32_u24 v14, 3, v15
    v_lshrrev_b32 v14, 1, v14
    v_add_u32 v14, -3, v14
    v_cmp_eq_u32 vcc, 1, v15
    s_nop 1
    v_cndmask_b32 v14, v14, 0, vcc
    v_cmp_eq_u32 vcc, 2, v15
    s_nop 1
    v_cndmask_b32 v14, v14, -1, vcc
    v_add_u32 v14, s4, v14
    v_mov_b32 v16, s4
    v_cmp_gt_u32 vcc, 32, v14
    s_nop 1
    v_cndmask_b32 v14, v16, v14, vcc
    v_mul_u32_u24 v14, 12288, v14
    v_and_b32 v16, 7, v1
    v_lshl_add_u32 v14, v16, 7, v14
    v_mov_b32 v13, v14
    v_mov_b32 v16, s80
    v_cmp_eq_u32 vcc, 0, v15
    s_nop 1
    v_cndmask_b32 v13, v13, v16, vcc
    s_mov_b32 exec_lo, 0xffffffff
    s_mov_b32 exec_hi, 0
    s_mov_b32 s70, 0
L_poll_19:
    buffer_load_dword v14, v13, s[44:47], 0 offen sc1
    s_add_u32 s70, s70, 1
    s_cmp_gt_u32 s70, 400000
    s_cbranch_scc1 L_END
    s_waitcnt vmcnt(0)
    v_cmp_ne_u32 vcc, 0, v14
    s_nop 1
    s_cmp_eq_u64 vcc, exec
    s_cbranch_scc1 L_poll_19_ok
    s_branch L_poll_19
L_poll_19_ok:
    s_mov_b64 exec, -1
    s_mov_b64 exec, 0xff00
    v_cmp_ne_u32 vcc, s82, v14
    s_mov_b64 exec, -1
    s_nop 0
    s_cmp_eq_u64 vcc, 0
    s_cselect_b32 s82, 1, 0
    v_mov_b32 v15, s82
    ds_write_b32 v18, v15 offset:28
    s_mov_b64 exec, 1
    ds_add_u32 v18, v17 offset:68
    s_mov_b64 exec, -1
L_other_18:
    s_mov_b32 s70, 0
L_lw_20:
    ds_read_b32 v15, v18 offset:68
    s_add_u32 s70, s70, 1
    s_cmp_gt_u32 s70, 3200000
    s_cbranch_scc1 L_END
    s_waitcnt lgkmcnt(0)
    v_readfirstlane_b32 s68, v15
    s_nop 1
    s_cmp_ge_u32 s68, 257
    s_cbranch_scc0 L_lw_20
L_take_17:
    s_add_u32 s66, s64, 0
    buffer_load_dwordx4 v[32:35], v24, s[44:47], s66 offen sc1
    s_add_u32 s66, s64, 2048
    buffer_load_dwordx4 v[36:39], v24, s[44:47], s66 offen sc1
    s_add_u32 s66, s64, 4096
    buffer_load_dwordx4 v[40:43], v24, s[44:47], s66 offen sc1
    s_add_u32 s66, s64, 6144
    buffer_load_dwordx4 v[44:47], v24, s[44:47], s66 offen sc1
    s_add_u32 s66, s64, 8192
    buffer_load_dwordx4 v[48:51], v24, s[44:47], s66 offen sc1
    s_add_u32 s66, s64, 10240
    buffer_load_dwordx4 v[52:55], v24, s[44:47], s66 offen sc1
    s_add_u32 s66, s64, 12288
    buffer_load_dwordx4 v[56:59], v24, s[44:47], s66 offen sc1
    s_add_u32 s66, s64, 14336
    buffer_load_dwordx4 v[60:63], v25, s[44:47], s66 offen sc1
    s_branch L_hjoin_15
L_hearly_14:
    s_add_u32 s66, s64, 0
    buffer_load_dwordx4 v[32:35], v24, s[44:47], s66 offen sc1
    s_add_u32 s66, s64, 2048
    buffer_load_dwordx4 v[36:39], v24, s[44:47], s66 offen sc1
    s_add_u32 s66, s64, 4096
    buffer_load_dwordx4 v[40:43], v24, s[44:47], s66 offen sc1
    s_add_u32 s66, s64, 6144
    buffer_load_dwordx4 v[44:47], v24, s[44:47], s66 offen sc1
    s_add_u32 s66, s64, 8192
    buffer_load_dwordx4 v[48:51], v24, s[44:47], s66 offen sc1
    s_add_u32 s66, s64, 10240
    buffer_load_dwordx4 v[52:55], v24, s[44:47], s66 offen sc1
    s_add_u32 s66, s64, 12288
    buffer_load_dwordx4 v[56:59], v24, s[44:47], s66 offen sc1
    s_add_u32 s66, s64, 14336
    buffer_load_dwordx4 v[60:63], v25, s[44:47], s66 offen sc1
    s_waitcnt vmcnt(8)
    ds_read_b64_tr_b16 v[136:137], v27 offset:8192
    ds_read_b64_tr_b16 v[138:139], v27 offset:8704
    ds_read_b64_tr_b16 v[140:141], v28 offset:8192
    ds_read_b64_tr_b16 v[142:143], v28 offset:8704
    ds_read_b64_tr_b16 v[144:145], v27 offset:10240
    ds_read_b64_tr_b16 v[146:147], v27 offset:10752
    ds_read_b64_tr_b16 v[148:149], v28 offset:10240
    ds_read_b64_tr_b16 v[150:151], v28 offset:10752
    s_waitcnt lgkmcnt(4)
    ds_read_b64_tr_b16 v[152:153], v27 offset:12288
    ds_read_b64_tr_b16 v[154:155], v27 offset:12800
    ds_read_b64_tr_b16 v[156:157], v28 offset:12288
    ds_read_b64_tr_b16 v[158:159], v28 offset:12800
    ds_read_b64_tr_b16 v[160:161], v27 offset:14336
    ds_read_b64_tr_b16 v[162:163], v27 offset:14848
    ds_read_b64_tr_b16 v[164:165], v28 offset:14336
    ds_read_b64_tr_b16 v[166:167], v28 offset:14848
    s_waitcnt lgkmcnt(4)
    ds_read_b64_tr_b16 v[168:169], v27 offset:16384
    ds_read_b64_tr_b16 v[170:171], v27 offset:16896
    ds_read_b64_tr_b16 v[172:173], v28 offset:16384
    ds_read_b64_tr_b16 v[174:175], v28 offset:16896
    ds_read_b64_tr_b16 v[176:177], v27 offset:18432
    ds_read_b64_tr_b16 v[178:179], v27 offset:18944
    ds_read_b64_tr_b16 v[180:181], v28 offset:18432
    ds_read_b64_tr_b16 v[182:183], v28 offset:18944
    s_waitcnt lgkmcnt(4)
    ds_read_b64_tr_b16 v[184:185], v27 offset:20480
    ds_read_b64_tr_b16 v[186:187], v27 offset:20992
    ds_read_b64_tr_b16 v[188:189], v28 offset:20480
    ds_read_b64_tr_b16 v[190:191], v28 offset:20992
    ds_read_b64_tr_b16 v[192:193], v27 offset:22528
    ds_read_b64_tr_b16 v[194:195], v27 offset:23040
    ds_read_b64_tr_b16 v[196:197], v28 offset:22528
    ds_read_b64_tr_b16 v[198:199], v28 offset:23040
    s_waitcnt lgkmcnt(4)
    s_waitcnt lgkmcnt(0)
L_hjoin_15:
    s_setprio 2
    ds_read_b32 v14, v18 offset:28
    s_mov_b32 s70, 0
L_lw_21:
    ds_read_b32 v15, v18 offset:52
    s_add_u32 s70, s70, 1
    s_cmp_gt_u32 s70, 3200000
    s_cbranch_scc1 L_END
    s_waitcnt lgkmcnt(0)
    v_readfirstlane_b32 s68, v15
    s_nop 1
    s_cmp_ge_u32 s68, 8
    s_cbranch_scc0 L_lw_21
    v_readfirstlane_b32 s82, v14
    ds_read_b64_tr_b16 v[120:121], v30 offset:0
    ds_read_b64_tr_b16 v[122:123], v30 offset:512
    ds_read_b64_tr_b16 v[124:125], v31 offset:0
    ds_read_b64_tr_b16 v[126:127], v31 offset:512
    ds_read_b64_tr_b16 v[128:129], v30 offset:2048
    ds_read_b64_tr_b16 v[130:131], v30 offset:2560
    ds_read_b64_tr_b16 v[132:133], v31 offset:2048
    ds_read_b64_tr_b16 v[134:135], v31 offset:2560
    ds_read_b64_tr_b16 v[200:201], v30 offset:4096
    ds_read_b64_tr_b16 v[202:203], v30 offset:4608
    ds_read_b64_tr_b16 v[204:205], v31 offset:4096
    ds_read_b64_tr_b16 v[206:207], v31 offset:4608
    s_waitcnt vmcnt(7) lgkmcnt(8)
    v_mfma_f32_32x32x16_bf16 v[104:119], v[124:127], v[32:35], 0
    s_add_u32 s66, s64, 16384
    buffer_load_dwordx4 v[64:67], v25, s[44:47], s66 offen sc1
    v_mfma_f32_32x32x16_bf16 v[88:103], v[120:123], v[32:35], 0
    ds_read_b64_tr_b16 v[120:121], v30 offset:6144
    ds_read_b64_tr_b16 v[122:123], v30 offset:6656
    ds_read_b64_tr_b16 v[124:125], v31 offset:6144
    ds_read_b64_tr_b16 v[126:127], v31 offset:6656
    s_waitcnt vmcnt(7) lgkmcnt(8)
    v_mfma_f32_32x32x16_bf16 v[104:119], v[132:135], v[36:39], v[104:119]
    s_add_u32 s66, s64, 18432
    buffer_load_dwordx4 v[68:71], v25, s[44:47], s66 offen sc1
    v_mfma_f32_32x32x16_bf16 v[88:103], v[128:131], v[36:39], v[88:103]
    ds_read_b64_tr_b16 v[128:129], v30 offset:8192
    ds_read_b64_tr_b16 v[130:131], v30 offset:8704
    ds_read_b64_tr_b16 v[132:133], v31 offset:8192
    ds_read_b64_tr_b16 v[134:135], v31 offset:8704
    s_waitcnt vmcnt(7) lgkmcnt(8)
    v_mfma_f32_32x32x16_bf16 v[104:119], v[204:207], v[40:43], v[104:119]
    s_add_u32 s66, s64, 20480
    buffer_load_dwordx4 v[72:75], v25, s[44:47], s66 offen sc1
    v_mfma_f32_32x32x16_bf16 v[88:103], v[200:203], v[40:43], v[88:103]
    ds_read_b64_tr_b16 v[200:201], v30 offset:10240
    ds_read_b64_tr_b16 v[202:203], v30 offset:10752
    ds_read_b64_tr_b16 v[204:205], v31 offset:10240
    ds_read_b64_tr_b16 v[206:207], v31 offset:10752
    s_waitcnt vmcnt(7) lgkmcnt(8)
    v_mfma_f32_32x32x16_bf16 v[104:119], v[124:127], v[44:47], v[104:119]
    s_add_u32 s66, s64, 22528
    buffer_load_dwordx4 v[76:79], v25, s[44:47], s66 offen sc1
    v_mfma_f32_32x32x16_bf16 v[88:103], v[120:123], v[44:47], v[88:103]
    ds_read_b64_tr_b16 v[120:121], v30 offset:12288
    ds_read_b64_tr_b16 v[122:123], v30 offset:12800
    ds_read_b64_tr_b16 v[124:125], v31 offset:12288
    ds_read_b64_tr_b16 v[126:127], v31 offset:12800
    s_waitcnt vmcnt(7) lgkmcnt(8)
    v_mfma_f32_32x32x16_bf16 v[104:119], v[132:135], v[48:51], v[104:119]
    s_add_u32 s66, s64, 24576
    buffer_load_dwordx4 v[80:83], v25, s[44:47], s66 offen sc1
    v_mfma_f32_32x32x16_bf16 v[88:103], v[128:131], v[48:51], v[88:103]
    ds_read_b64_tr_b16 v[128:129], v30 offset:14336
    ds_read_b64_tr_b16 v[130:131], v30 offset:14848
    ds_read_b64_tr_b16 v[132:133], v31 offset:14336
    ds_read_b64_tr_b16 v[134:135], v31 offset:14848
    s_waitcnt vmcnt(7) lgkmcnt(8)
    v_mfma_f32_32x32x16_bf16 v[104:119], v[204:207], v[52:55], v[104:119]
    s_add_u32 s66, s64, 26624
    buffer_load_dwordx4 v[84:87], v25, s[44:47], s66 offen sc1
    v_mfma_f32_32x32x16_bf16 v[88:103], v[200:203], v[52:55], v[88:103]
    ds_read_b64_tr_b16 v[200:201], v30 offset:16384
    ds_read_b64_tr_b16 v[202:203], v30 offset:16896
    ds_read_b64_tr_b16 v[204:205], v31 offset:16384
    ds_read_b64_tr_b16 v[206:207], v31 offset:16896
    s_waitcnt vmcnt(7) lgkmcnt(8)
    v_mfma_f32_32x32x16_bf16 v[104:119], v[124:127], v[56:59], v[104:119]
    v_mfma_f32_32x32x16_bf16 v[88:103], v[120:123], v[56:59], v[88:103]
    ds_read_b64_tr_b16 v[120:121], v30 offset:18432
    ds_read_b64_tr_b16 v[122:123], v30 offset:18944
    ds_read_b64_tr_b16 v[124:125], v31 offset:18432
    ds_read_b64_tr_b16 v[126:127], v31 offset:18944
    s_waitcnt vmcnt(6) lgkmcnt(8)
    v_mfma_f32_32x32x16_bf16 v[104:119], v[132:135], v[60:63], v[104:119]
    v_mfma_f32_32x32x16_bf16 v[88:103], v[128:131], v[60:63], v[88:103]
    ds_read_b64_tr_b16 v[128:129], v30 offset:20480
    ds_read_b64_tr_b16 v[130:131], v30 offset:20992
    ds_read_b64_tr_b16 v[132:133], v31 offset:20480
    ds_read_b64_tr_b16 v[134:135], v31 offset:20992
    s_waitcnt vmcnt(5) lgkmcnt(8)
    v_mfma_f32_32x32x16_bf16 v[104:119], v[204:207], v[64:67], v[104:119]
    v_mfma_f32_32x32x16_bf16 v[88:103], v[200:203], v[64:67], v[88:103]
    ds_read_b64_tr_b16 v[200:201], v30 offset:22528
    ds_read_b64_tr_b16 v[202:203], v30 offset:23040
    ds_read_b64_tr_b16 v[204:205], v31 offset:22528
    ds_read_b64_tr_b16 v[206:207], v31 offset:23040
    s_waitcnt vmcnt(4) lgkmcnt(8)
    v_mfma_f32_32x32x16_bf16 v[104:119], v[124:127], v[68:71], v[104:119]
    v_mfma_f32_32x32x16_bf16 v[88:103], v[120:123], v[68:71], v[88:103]
    ds_read_b64_tr_b16 v[120:121], v30 offset:24576
    ds_read_b64_tr_b16 v[122:123], v30 offset:25088
    ds_read_b64_tr_b16 v[124:125], v31 offset:24576
    ds_read_b64_tr_b16 v[126:127], v31 offset:25088
    s_waitcnt vmcnt(3) lgkmcnt(8)
    v_mfma_f32_32x32x16_bf16 v[104:119], v[132:135], v[72:75], v[104:119]
    v_mfma_f32_32x32x16_bf16 v[88:103], v[128:131], v[72:75], v[88:103]
    ds_read_b64_tr_b16 v[128:129], v30 offset:26624
    ds_read_b64_tr_b16 v[130:131], v30 offset:27136
    ds_read_b64_tr_b16 v[132:133], v31 offset:26624
    ds_read_b64_tr_b16 v[134:135], v31 offset:27136
    s_waitcnt vmcnt(2) lgkmcnt(8)
    v_mfma_f32_32x32x16_bf16 v[104:119], v[204:207], v[76:79], v[104:119]
    v_mfma_f32_32x32x16_bf16 v[88:103], v[200:203], v[76:79], v[88:103]
    s_waitcnt vmcnt(1) lgkmcnt(4)
    v_mfma_f32_32x32x16_bf16 v[104:119], v[124:127], v[80:83], v[104:119]
    v_mfma_f32_32x32x16_bf16 v[88:103], v[120:123], v[80:83], v[88:103]
    s_waitcnt vmcnt(0) lgkmcnt(0)
    v_mfma_f32_32x32x16_bf16 v[104:119], v[132:135], v[84:87], v[104:119]
    v_mfma_f32_32x32x16_bf16 v[88:103], v[128:131], v[84:87], v[88:103]
    v_add_u32 v13, s74, v2
    s_xor_b32 s65, s61, 1
    s_mul_i32 s66, s65, 24576
    s_add_u32 s66, s66, 57344
    v_add_u32 v14, s66, v2
    v_lshl_add_u32 v15, s61, 2, v18
    v_lshl_add_u32 v16, s65, 2, v18
    s_add_u32 m0, s74, 8192
    s_add_u32 s69, s72, 28672
    buffer_load_dwordx4 v10, s[28:31], s72 offen lds
    s_add_u32 m0, s74, 9216
    s_add_u32 s72, s72, 57344
    buffer_load_dwordx4 v10, s[28:31], s69 offen lds
    ds_write_b128 v13, v[104:107] offset:0
    ds_write_b128 v13, v[108:111] offset:1024
    ds_write_b128 v13, v[112:115] offset:2048
    ds_write_b128 v13, v[116:119] offset:3072
    s_mov_b64 exec, 1
    ds_add_u32 v15, v17 offset:32
    s_mov_b64 exec, -1
    v_add_f32 v240, v240, v88
    v_add_f32 v241, v241, v89
    v_add_f32 v242, v242, v90
    v_add_f32 v243, v243, v91
    v_add_f32 v244, v244, v92
    v_add_f32 v245, v245, v93
    v_add_f32 v246, v246, v94
    v_add_f32 v247, v247, v95
    v_add_f32 v248, v248, v96
    v_add_f32 v249, v249, v97
    v_add_f32 v250, v250, v98
    v_add_f32 v251, v251, v99
    v_add_f32 v252, v252, v100
    v_add_f32 v253, v253, v101
    v_add_f32 v254, v254, v102
    v_add_f32 v255, v255, v103
    s_add_u32 m0, s74, 10240
    s_add_u32 s69, s72, 28672
    buffer_load_dwordx4 v10, s[28:31], s72 offen lds
    s_add_u32 m0, s74, 11264
    s_add_u32 s72, s72, 57344
    buffer_load_dwordx4 v10, s[28:31], s69 offen lds
    s_mov_b32 s70, 0
L_lw_22:
    ds_read_b32 v15, v16 offset:32
    s_add_u32 s70, s70, 1
    s_cmp_gt_u32 s70, 3200000
    s_cbranch_scc1 L_END
    s_waitcnt lgkmcnt(0)
    v_readfirstlane_b32 s68, v15
    s_nop 1
    s_cmp_ge_u32 s68, 1
    s_cbranch_scc0 L_lw_22
    ds_read_b128 v[104:107], v14 offset:0
    ds_read_b128 v[108:111], v14 offset:1024
    ds_read_b128 v[112:115], v14 offset:2048
    ds_read_b128 v[116:119], v14 offset:3072
    s_waitcnt lgkmcnt(3)
    v_add_f32 v240, v240, v104
    v_add_f32 v241, v241, v105
    v_add_f32 v242, v242, v106
    v_add_f32 v243, v243, v107
    s_waitcnt lgkmcnt(2)
    v_add_f32 v244, v244, v108
    v_add_f32 v245, v245, v109
    v_add_f32 v246, v246, v110
    v_add_f32 v247, v247, v111
    s_waitcnt lgkmcnt(1)
    v_add_f32 v248, v248, v112
    v_add_f32 v249, v249, v113
    v_add_f32 v250, v250, v114
    v_add_f32 v251, v251, v115
    s_waitcnt lgkmcnt(0)
    v_add_f32 v252, v252, v116
    v_add_f32 v253, v253, v117
    v_add_f32 v254, v254, v118
    v_add_f32 v255, v255, v119
    v_cvt_pk_bf16_f32 v200, v240, v241
    v_cvt_pk_bf16_f32 v201, v242, v243
    v_cvt_pk_bf16_f32 v202, v244, v245
    v_cvt_pk_bf16_f32 v203, v246, v247
    v_cvt_pk_bf16_f32 v204, v248, v249
    v_cvt_pk_bf16_f32 v205, v250, v251
    v_cvt_pk_bf16_f32 v206, v252, v253
    v_cvt_pk_bf16_f32 v207, v254, v255
    v_permlane32_swap_b32 v200, v202
    v_permlane32_swap_b32 v201, v203
    v_permlane32_swap_b32 v204, v206
    v_permlane32_swap_b32 v205, v207
    s_cmp_eq_u32 s82, 0
    s_cbranch_scc1 L_far_23
    s_add_u32 s65, s79, 57344
    buffer_store_dwordx4 v[200:203], v8, s[44:47], s65 offen
    buffer_store_dwordx4 v[204:207], v8, s[44:47], s65 offen offset:2048
    s_branch L_md_24
L_far_23:
    s_add_u32 s65, s79, 57344
    buffer_store_dwordx4 v[200:203], v8, s[44:47], s65 offen sc1
    buffer_store_dwordx4 v[204:207], v8, s[44:47], s65 offen offset:2048 sc1
L_md_24:
    v_add_f32 v13, v240, v241
    v_mul_f32 v14, v240, v240
    v_mul_f32 v15, v241, v241
    v_add_f32 v16, v242, v243
    v_fmac_f32 v14, v242, v242
    v_fmac_f32 v15, v243, v243
    v_add_f32 v13, v13, v244
    v_fmac_f32 v14, v244, v244
    v_add_f32 v16, v16, v245
    v_fmac_f32 v15, v245, v245
    v_add_f32 v13, v13, v246
    v_fmac_f32 v14, v246, v246
    v_add_f32 v16, v16, v247
    v_fmac_f32 v15, v247, v247
    v_add_f32 v13, v13, v248
    v_fmac_f32 v14, v248, v248
    v_add_f32 v16, v16, v249
    v_fmac_f32 v15, v249, v249
    v_add_f32 v13, v13, v250
    v_fmac_f32 v14, v250, v250
    v_add_f32 v16, v16, v251
    v_fmac_f32 v15, v251, v251
    v_add_f32 v13, v13, v252
    v_fmac_f32 v14, v252, v252
    v_add_f32 v16, v16, v253
    v_fmac_f32 v15, v253, v253
    v_add_f32 v13, v13, v254
    v_fmac_f32 v14, v254, v254
    v_add_f32 v16, v16, v255
    v_fmac_f32 v15, v255, v255
    v_add_f32 v13, v13, v16
    v_add_f32 v14, v14, v15
    s_nop 1
    v_permlane32_swap_b32 v13, v14
    v_add_f32 v13, v13, v14
    s_cmp_eq_u32 s82, 0
    s_cbranch_scc1 L_far_25
    buffer_store_dword v13, v26, s[44:47], s76 offen
    s_branch L_md_26
L_far_25:
    buffer_store_dword v13, v26, s[44:47], s76 offen sc1
L_md_26:
    s_add_u32 m0, s74, 12288
    s_add_u32 s69, s72, 28672
    buffer_load_dwordx4 v10, s[28:31], s72 offen lds
    s_add_u32 m0, s74, 13312
    s_add_u32 s72, s72, 57344
    buffer_load_dwordx4 v10, s[28:31], s69 offen lds
    s_add_u32 m0, s74, 14336
    s_add_u32 s69, s72, 28672
    buffer_load_dwordx4 v10, s[28:31], s72 offen lds
    s_waitcnt vmcnt(3)
    s_mov_b64 exec, 1
    ds_add_rtn_u32 v13, v18, v17 offset:8
    s_lshl_b32 s67, s5, 7
    s_add_u32 s67, s67, s80
    s_add_u32 s67, s67, 1024
    s_waitcnt lgkmcnt(0)
    v_readfirstlane_b32 s68, v13
    v_mov_b32 v13, 0
    s_nop 0
    s_cmp_eq_u32 s68, 3
    s_cbranch_scc0 L_sig_27
    s_cmp_eq_u32 s82, 0
    s_cbranch_scc1 L_far_28
    buffer_store_dword v17, v13, s[44:47], s67 offen
    s_branch L_md_29
L_far_28:
    buffer_store_dword v17, v13, s[44:47], s67 offen sc1
L_md_29:
L_sig_27:
    s_mov_b64 exec, -1
    s_add_u32 m0, s74, 15360
    s_add_u32 s72, s72, 57344
    buffer_load_dwordx4 v10, s[28:31], s69 offen lds
    s_add_u32 m0, s74, 16384
    s_add_u32 s69, s72, 28672
    buffer_load_dwordx4 v10, s[28:31], s72 offen lds
    s_add_u32 m0, s74, 17408
    s_add_u32 s72, s72, 57344
    buffer_load_dwordx4 v10, s[28:31], s69 offen lds
    s_add_u32 m0, s74, 18432
    s_add_u32 s69, s72, 28672
    buffer_load_dwordx4 v10, s[28:31], s72 offen lds
    s_add_u32 m0, s74, 19456
    s_add_u32 s72, s72, 57344
    buffer_load_dwordx4 v10, s[28:31], s69 offen lds
    s_mov_b32 s70, 0
L_lw_30:
    ds_read_b32 v15, v18 offset:4
    s_add_u32 s70, s70, 1
    s_cmp_gt_u32 s70, 3200000
    s_cbranch_scc1 L_END
    s_waitcnt lgkmcnt(0)
    v_readfirstlane_b32 s68, v15
    s_nop 1
    s_cmp_ge_u32 s68, 20
    s_cbranch_scc0 L_lw_30
    s_lshl_b32 s76, s62, 12
    s_lshl_b32 s66, s63, 10
    s_add_u32 s76, s76, s66
    s_add_u32 s76, s76, s60
    s_add_u32 s76, s76, 172032
    s_mul_i32 s64, s61, 7168
    s_add_u32 s75, s64, s60
    s_lshl_b32 s65, s61, 8
    s_add_u32 s65, s65, 158720
    v_lshl_add_u32 v16, v1, 2, s65
    s_cmp_lg_u32 s61, 0
    s_cbranch_scc1 L_np_31
    s_add_u32 s67, s80, 1024
    v_lshlrev_b32 v13, 7, v1
    s_mov_b32 exec_lo, 0x7f
    s_mov_b32 exec_hi, 0
    s_mov_b32 s70, 0
L_poll_33:
    buffer_load_dword v14, v13, s[44:47], s67 offen sc1
    s_add_u32 s70, s70, 1
    s_cmp_gt_u32 s70, 400000
    s_cbranch_scc1 L_END
    s_waitcnt vmcnt(0)
    v_cmp_ne_u32 vcc, 0, v14
    s_nop 1
    s_cmp_eq_u64 vcc, exec
    s_cbranch_scc1 L_poll_33_ok
    s_branch L_poll_33
L_poll_33_ok:
    s_mov_b64 exec, -1
    s_mov_b64 exec, 1
    ds_add_u32 v18, v17 offset:72
    s_mov_b64 exec, -1
    s_branch L_pd_32
L_np_31:
    s_mov_b32 s70, 0
L_lw_34:
    ds_read_b32 v15, v18 offset:72
    s_add_u32 s70, s70, 1
    s_cmp_gt_u32 s70, 3200000
    s_cbranch_scc1 L_END
    s_waitcnt lgkmcnt(0)
    v_readfirstlane_b32 s68, v15
    s_nop 1
    s_cmp_ge_u32 s68, 1
    s_cbranch_scc0 L_lw_34
L_pd_32:
    buffer_load_dwordx4 v[32:35], v26, s[44:47], s76 offen sc1
    buffer_load_dwordx4 v[36:39], v26, s[44:47], s76 offen offset:512 sc1
    s_add_u32 m0, s64, 0
    s_add_u32 s65, s75, 57344
    buffer_load_dwordx4 v2, s[44:47], s65 offen offset:0 sc1 lds
    buffer_load_dwordx4 v2, s[44:47], s65 offen offset:1024 sc1 lds
    buffer_load_dwordx4 v2, s[44:47], s65 offen offset:2048 sc1 lds
    buffer_load_dwordx4 v2, s[44:47], s65 offen offset:3072 sc1 lds
    s_add_u32 m0, s64, 4096
    s_add_u32 s65, s75, 61440
    buffer_load_dwordx4 v2, s[44:47], s65 offen offset:0 sc1 lds
    buffer_load_dwordx4 v2, s[44:47], s65 offen offset:1024 sc1 lds
    buffer_load_dwordx4 v2, s[44:47], s65 offen offset:2048 sc1 lds
    s_add_u32 m0, s64, 28672
    s_add_u32 s65, s75, 86016
    buffer_load_dwordx4 v2, s[44:47], s65 offen offset:0 sc1 lds
    buffer_load_dwordx4 v2, s[44:47], s65 offen offset:1024 sc1 lds
    buffer_load_dwordx4 v2, s[44:47], s65 offen offset:2048 sc1 lds
    s_waitcnt vmcnt(10)
    s_cmp_eq_u32 s63, 0
    s_cbranch_scc1 L_pq_35
    v_mov_b32 v38, 0
    v_mov_b32 v39, 0
L_pq_35:
    v_add_f32 v32, v32, v36
    v_add_f32 v33, v33, v37
    v_add_f32 v34, v34, v38
    v_add_f32 v35, v35, v39
    v_add_f32 v32, v32, v34
    v_add_f32 v33, v33, v35
    v_add_f32 v32, v32, v33
    ds_write_b32 v16, v32
    s_waitcnt vmcnt(3)
    s_mov_b64 exec, 1
    ds_add_u32 v18, v17 offset:0
    s_mov_b64 exec, -1
    buffer_load_dwordx4 v2, s[44:47], s65 offen offset:3072 sc1 lds
    s_add_u32 m0, s64, 32768
    s_add_u32 s65, s75, 90112
    buffer_load_dwordx4 v2, s[44:47], s65 offen offset:0 sc1 lds
    buffer_load_dwordx4 v2, s[44:47], s65 offen offset:1024 sc1 lds
    buffer_load_dwordx4 v2, s[44:47], s65 offen offset:2048 sc1 lds
    v_lshlrev_b32 v13, 2, v1
    v_add_u32 v13, 158720, v13
    s_mov_b32 s70, 0
L_lw_36:
    ds_read_b32 v15, v18 offset:0
    s_add_u32 s70, s70, 1
    s_cmp_gt_u32 s70, 3200000
    s_cbranch_scc1 L_END
    s_waitcnt lgkmcnt(0)
    v_readfirstlane_b32 s68, v15
    s_nop 1
    s_cmp_ge_u32 s68, 8
    s_cbranch_scc0 L_lw_36
    ds_read_b32 v128, v13 offset:0
    ds_read_b32 v129, v13 offset:256
    ds_read_b32 v130, v13 offset:512
    ds_read_b32 v131, v13 offset:768
    s_mul_i32 s75, s61, 57344
    s_lshl_b32 s65, s5, 7
    s_add_u32 s75, s75, s65
    s_mul_i32 s76, s61, 8192
    s_add_u32 s76, s76, s60
    s_add_u32 s76, s76, 180224
    s_add_u32 s65, s5, 1
    s_cmp_ge_u32 s65, 7
    s_cselect_b32 s68, 7, 0
    s_sub_u32 s65, s65, s68
    s_mul_i32 s48, s65, 229376
    s_add_u32 s48, s48, s75
    s_mul_i32 s54, s65, 32768
    s_add_u32 s54, s54, s76
    s_add_u32 s65, s5, 2
    s_cmp_ge_u32 s65, 7
    s_cselect_b32 s68, 7, 0
    s_sub_u32 s65, s65, s68
    s_mul_i32 s49, s65, 229376
    s_add_u32 s49, s49, s75
    s_mul_i32 s55, s65, 32768
    s_add_u32 s55, s55, s76
    s_add_u32 s65, s5, 3
    s_cmp_ge_u32 s65, 7
    s_cselect_b32 s68, 7, 0
    s_sub_u32 s65, s65, s68
    s_mul_i32 s50, s65, 229376
    s_add_u32 s50, s50, s75
    s_mul_i32 s56, s65, 32768
    s_add_u32 s56, s56, s76
    s_add_u32 s65, s5, 4
    s_cmp_ge_u32 s65, 7
    s_cselect_b32 s68, 7, 0
    s_sub_u32 s65, s65, s68
    s_mul_i32 s51, s65, 229376
    s_add_u32 s51, s51, s75
    s_mul_i32 s57, s65, 32768
    s_add_u32 s57, s57, s76
    s_add_u32 s65, s5, 5
    s_cmp_ge_u32 s65, 7
    s_cselect_b32 s68, 7, 0
    s_sub_u32 s65, s65, s68
    s_mul_i32 s52, s65, 229376
    s_add_u32 s52, s52, s75
    s_mul_i32 s58, s65, 32768
    s_add_u32 s58, s58, s76
    s_add_u32 s65, s5, 6
    s_cmp_ge_u32 s65, 7
    s_cselect_b32 s68, 7, 0
    s_sub_u32 s65, s65, s68
    s_mul_i32 s53, s65, 229376
    s_add_u32 s53, s53, s75
    s_mul_i32 s59, s65, 32768
    s_add_u32 s59, s59, s76
    s_mul_i32 s65, s5, 229376
    s_add_u32 s75, s75, s65
    s_mul_i32 s65, s5, 32768
    s_add_u32 s76, s76, s65
    s_setprio 2
    ds_read_b128 v[48:51], v8 offset:0
    ds_read_b128 v[52:55], v8 offset:512
    s_waitcnt lgkmcnt(0)
    v_mfma_f32_32x32x16_bf16 v[64:79], v[136:139], v[48:51], 0
    ds_read_b128 v[56:59], v8 offset:2048
    ds_read_b128 v[60:63], v8 offset:2560
    v_mfma_f32_32x32x16_bf16 v[80:95], v[136:139], v[52:55], 0
    v_mfma_f32_32x32x16_bf16 v[96:111], v[140:143], v[48:51], 0
    s_add_u32 m0, s74, 20480
    s_add_u32 s69, s72, 28672
    buffer_load_dwordx4 v10, s[28:31], s72 offen lds
    v_mfma_f32_32x32x16_bf16 v[112:127], v[140:143], v[52:55], 0
    s_add_u32 m0, s74, 21504
    s_add_u32 s72, s72, 57344
    buffer_load_dwordx4 v10, s[28:31], s69 offen lds
    s_waitcnt lgkmcnt(0)
    v_mfma_f32_32x32x16_bf16 v[64:79], v[144:147], v[56:59], v[64:79]
    ds_read_b128 v[48:51], v8 offset:4096
    ds_read_b128 v[52:55], v8 offset:4608
    v_mfma_f32_32x32x16_bf16 v[80:95], v[144:147], v[60:63], v[80:95]
    s_waitcnt vmcnt(2)
    s_mov_b64 exec, 1
    ds_add_u32 v18, v17 offset:0
    s_mov_b64 exec, -1
    v_mfma_f32_32x32x16_bf16 v[96:111], v[148:151], v[56:59], v[96:111]
    s_add_u32 m0, s74, 22528
    s_add_u32 s69, s72, 28672
    buffer_load_dwordx4 v10, s[28:31], s72 offen lds
    v_mfma_f32_32x32x16_bf16 v[112:127], v[148:151], v[60:63], v[112:127]
    s_add_u32 m0, s74, 23552
    s_add_u32 s72, s72, 57344
    buffer_load_dwordx4 v10, s[28:31], s69 offen lds
    s_waitcnt lgkmcnt(0)
    v_mfma_f32_32x32x16_bf16 v[64:79], v[152:155], v[48:51], v[64:79]
    ds_read_b128 v[56:59], v8 offset:6144
    ds_read_b128 v[60:63], v8 offset:6656
    v_mfma_f32_32x32x16_bf16 v[80:95], v[152:155], v[52:55], v[80:95]
    v_mfma_f32_32x32x16_bf16 v[96:111], v[156:159], v[48:51], v[96:111]
    s_add_u32 m0, s74, 0
    s_add_u32 s69, s72, 28672
    buffer_load_dwordx4 v10, s[28:31], s72 offen lds
    v_mfma_f32_32x32x16_bf16 v[112:127], v[156:159], v[52:55], v[112:127]
    s_add_u32 m0, s74, 1024
    s_add_u32 s72, s72, 57344
    buffer_load_dwordx4 v10, s[28:31], s69 offen lds
    v_add_f32 v128, v128, v129
    v_mul_f32 v128, 0x3b124925, v128
    v_mov_b32 v129, v128
    s_nop 1
    v_permlane32_swap_b32 v128, v129
    v_mov_b32 v24, v128
    v_fma_f32 v129, -v128, v128, v129
    v_max_f32 v129, 0, v129
    v_add_f32 v129, 0x3727c5ac, v129
    v_rsq_f32 v30, v129
    s_nop 0
    v_mul_f32 v5, s86, v30
    v_mul_f32 v128, v30, v30
    v_mul_f32 v128, v128, v30
    v_mul_f32 v7, s87, v128
    v_add_f32 v130, v130, v131
    v_mul_f32 v130, 0x3b124925, v130
    v_mov_b32 v131, v130
    s_nop 1
    v_permlane32_swap_b32 v130, v131
    v_mov_b32 v25, v130
    v_fma_f32 v131, -v130, v130, v131
    v_max_f32 v131, 0, v131
    v_add_f32 v131, 0x3727c5ac, v131
    v_rsq_f32 v31, v131
    s_nop 0
    v_mul_f32 v6, s86, v31
    v_mul_f32 v130, v31, v31
    v_mul_f32 v130, v130, v31
    v_mul_f32 v9, s87, v130
    s_waitcnt lgkmcnt(0)
    v_mfma_f32_32x32x16_bf16 v[64:79], v[160:163], v[56:59], v[64:79]
    ds_read_b128 v[48:51], v8 offset:8192
    ds_read_b128 v[52:55], v8 offset:8704
    v_mfma_f32_32x32x16_bf16 v[80:95], v[160:163], v[60:63], v[80:95]
    v_mfma_f32_32x32x16_bf16 v[96:111], v[164:167], v[56:59], v[96:111]
    s_add_u32 m0, s74, 2048
    s_add_u32 s69, s72, 28672
    buffer_load_dwordx4 v10, s[28:31], s72 offen lds
    v_mfma_f32_32x32x16_bf16 v[112:127], v[164:167], v[60:63], v[112:127]
    s_add_u32 m0, s74, 3072
    s_add_u32 s72, s72, 57344
    buffer_load_dwordx4 v10, s[28:31], s69 offen lds
    s_waitcnt lgkmcnt(0)
    v_mfma_f32_32x32x16_bf16 v[64:79], v[168:171], v[48:51], v[64:79]
    ds_read_b128 v[56:59], v8 offset:10240
    ds_read_b128 v[60:63], v8 offset:10752
    v_mfma_f32_32x32x16_bf16 v[80:95], v[168:171], v[52:55], v[80:95]
    v_mfma_f32_32x32x16_bf16 v[96:111], v[172:175], v[48:51], v[96:111]
    s_add_u32 m0, s74, 4096
    s_add_u32 s69, s72, 28672
    buffer_load_dwordx4 v10, s[28:31], s72 offen lds
    v_mfma_f32_32x32x16_bf16 v[112:127], v[172:175], v[52:55], v[112:127]
    s_add_u32 m0, s74, 5120
    s_add_u32 s72, s72, 57344
    buffer_load_dwordx4 v10, s[28:31], s69 offen lds
    s_waitcnt lgkmcnt(0)
    v_mfma_f32_32x32x16_bf16 v[64:79], v[176:179], v[56:59], v[64:79]
    ds_read_b128 v[48:51], v8 offset:12288
    ds_read_b128 v[52:55], v8 offset:12800
    v_mfma_f32_32x32x16_bf16 v[80:95], v[176:179], v[60:63], v[80:95]
    v_mfma_f32_32x32x16_bf16 v[96:111], v[180:183], v[56:59], v[96:111]
    s_add_u32 m0, s74, 6144
    s_add_u32 s69, s72, 28672
    buffer_load_dwordx4 v10, s[28:31], s72 offen lds
    v_mfma_f32_32x32x16_bf16 v[112:127], v[180:183], v[60:63], v[112:127]
    s_add_u32 m0, s74, 7168
    s_add_u32 s72, s72, 57344
    buffer_load_dwordx4 v10, s[28:31], s69 offen lds
    s_waitcnt lgkmcnt(0)
    v_mfma_f32_32x32x16_bf16 v[64:79], v[184:187], v[48:51], v[64:79]
    ds_read_b128 v[56:59], v8 offset:14336
    ds_read_b128 v[60:63], v8 offset:14848
    v_mfma_f32_32x32x16_bf16 v[80:95], v[184:187], v[52:55], v[80:95]
    v_mfma_f32_32x32x16_bf16 v[96:111], v[188:191], v[48:51], v[96:111]
    v_mfma_f32_32x32x16_bf16 v[112:127], v[188:191], v[52:55], v[112:127]
    s_waitcnt lgkmcnt(0)
    v_mfma_f32_32x32x16_bf16 v[64:79], v[192:195], v[56:59], v[64:79]
    ds_read_b64_tr_b16 v[32:33], v27 offset:8192
    ds_read_b64_tr_b16 v[34:35], v27 offset:8704
    ds_read_b64_tr_b16 v[36:37], v28 offset:8192
    v_mfma_f32_32x32x16_bf16 v[80:95], v[192:195], v[60:63], v[80:95]
    ds_read_b64_tr_b16 v[38:39], v28 offset:8704
    ds_read_b128 v[48:51], v8 offset:16384
    ds_read_b128 v[52:55], v8 offset:16896
    v_mfma_f32_32x32x16_bf16 v[96:111], v[196:199], v[56:59], v[96:111]
    v_mfma_f32_32x32x16_bf16 v[112:127], v[196:199], v[60:63], v[112:127]
    s_waitcnt lgkmcnt(0)
    v_mfma_f32_32x32x16_bf16 v[64:79], v[32:35], v[48:51], v[64:79]
    ds_read_b64_tr_b16 v[40:41], v27 offset:10240
    ds_read_b64_tr_b16 v[42:43], v27 offset:10752
    ds_read_b64_tr_b16 v[44:45], v28 offset:10240
    v_mfma_f32_32x32x16_bf16 v[80:95], v[32:35], v[52:55], v[80:95]
    ds_read_b64_tr_b16 v[46:47], v28 offset:10752
    ds_read_b128 v[56:59], v8 offset:18432
    ds_read_b128 v[60:63], v8 offset:18944
    v_mfma_f32_32x32x16_bf16 v[96:111], v[36:39], v[48:51], v[96:111]
    s_add_u32 m0, s74, 8192
    s_add_u32 s69, s72, 28672
    buffer_load_dwordx4 v10, s[28:31], s72 offen lds
    v_mfma_f32_32x32x16_bf16 v[112:127], v[36:39], v[52:55], v[112:127]
    s_add_u32 m0, s74, 9216
    s_add_u32 s72, s72, 57344
    buffer_load_dwordx4 v10, s[28:31], s69 offen lds
    s_waitcnt lgkmcnt(0)
    v_mfma_f32_32x32x16_bf16 v[64:79], v[40:43], v[56:59], v[64:79]
    ds_read_b64_tr_b16 v[32:33], v27 offset:12288
    ds_read_b64_tr_b16 v[34:35], v27 offset:12800
    ds_read_b64_tr_b16 v[36:37], v28 offset:12288
    v_mfma_f32_32x32x16_bf16 v[80:95], v[40:43], v[60:63], v[80:95]
    ds_read_b64_tr_b16 v[38:39], v28 offset:12800
    ds_read_b128 v[48:51], v8 offset:20480
    ds_read_b128 v[52:55], v8 offset:20992
    v_mfma_f32_32x32x16_bf16 v[96:111], v[44:47], v[56:59], v[96:111]
    s_add_u32 m0, s74, 10240
    s_add_u32 s69, s72, 28672
    buffer_load_dwordx4 v10, s[28:31], s72 offen lds
    v_mfma_f32_32x32x16_bf16 v[112:127], v[44:47], v[60:63], v[112:127]
    s_add_u32 m0, s74, 11264
    s_add_u32 s72, s72, 57344
    buffer_load_dwordx4 v10, s[28:31], s69 offen lds
    s_waitcnt lgkmcnt(0)
    v_mfma_f32_32x32x16_bf16 v[64:79], v[32:35], v[48:51], v[64:79]
    ds_read_b64_tr_b16 v[40:41], v27 offset:14336
    ds_read_b64_tr_b16 v[42:43], v27 offset:14848
    ds_read_b64_tr_b16 v[44:45], v28 offset:14336
    v_mfma_f32_32x32x16_bf16 v[80:95], v[32:35], v[52:55], v[80:95]
    ds_read_b64_tr_b16 v[46:47], v28 offset:14848
    ds_read_b128 v[56:59], v8 offset:22528
    ds_read_b128 v[60:63], v8 offset:23040
    v_mfma_f32_32x32x16_bf16 v[96:111], v[36:39], v[48:51], v[96:111]
    s_add_u32 m0, s74, 12288
    s_add_u32 s69, s72, 28672
    buffer_load_dwordx4 v10, s[28:31], s72 offen lds
    v_mfma_f32_32x32x16_bf16 v[112:127], v[36:39], v[52:55], v[112:127]
    s_add_u32 m0, s74, 13312
    s_add_u32 s72, s72, 57344
    buffer_load_dwordx4 v10, s[28:31], s69 offen lds
    s_waitcnt lgkmcnt(0)
    v_mfma_f32_32x32x16_bf16 v[64:79], v[40:43], v[56:59], v[64:79]
    ds_read_b64_tr_b16 v[32:33], v27 offset:16384
    ds_read_b64_tr_b16 v[34:35], v27 offset:16896
    ds_read_b64_tr_b16 v[36:37], v28 offset:16384
    v_mfma_f32_32x32x16_bf16 v[80:95], v[40:43], v[60:63], v[80:95]
    ds_read_b64_tr_b16 v[38:39], v28 offset:16896
    ds_read_b128 v[48:51], v8 offset:24576
    ds_read_b128 v[52:55], v8 offset:25088
    v_mfma_f32_32x32x16_bf16 v[96:111], v[44:47], v[56:59], v[96:111]
    s_add_u32 m0, s74, 14336
    s_add_u32 s69, s72, 28672
    buffer_load_dwordx4 v10, s[28:31], s72 offen lds
    v_mfma_f32_32x32x16_bf16 v[112:127], v[44:47], v[60:63], v[112:127]
    s_add_u32 m0, s74, 15360
    s_add_u32 s72, s72, 57344
    buffer_load_dwordx4 v10, s[28:31], s69 offen lds
    s_mov_b32 s70, 0
L_lw_37:
    ds_read_b32 v15, v18 offset:0
    s_add_u32 s70, s70, 1
    s_cmp_gt_u32 s70, 3200000
    s_cbranch_scc1 L_END
    s_waitcnt lgkmcnt(0)
    v_readfirstlane_b32 s68, v15
    s_nop 1
    s_cmp_ge_u32 s68, 12
    s_cbranch_scc0 L_lw_37
    s_waitcnt lgkmcnt(0)
    v_mfma_f32_32x32x16_bf16 v[64:79], v[32:35], v[48:51], v[64:79]
    ds_read_b64_tr_b16 v[40:41], v27 offset:18432
    ds_read_b64_tr_b16 v[42:43], v27 offset:18944
    ds_read_b64_tr_b16 v[44:45], v28 offset:18432
    v_mfma_f32_32x32x16_bf16 v[80:95], v[32:35], v[52:55], v[80:95]
    ds_read_b64_tr_b16 v[46:47], v28 offset:18944
    ds_read_b128 v[56:59], v8 offset:26624
    ds_read_b128 v[60:63], v8 offset:27136
    v_mfma_f32_32x32x16_bf16 v[96:111], v[36:39], v[48:51], v[96:111]
    s_add_u32 m0, s74, 16384
    s_add_u32 s69, s72, 28672
    buffer_load_dwordx4 v10, s[28:31], s72 offen lds
    v_mfma_f32_32x32x16_bf16 v[112:127], v[36:39], v[52:55], v[112:127]
    s_add_u32 m0, s74, 17408
    s_add_u32 s72, s72, 57344
    buffer_load_dwordx4 v10, s[28:31], s69 offen lds
    s_waitcnt vmcnt(20) lgkmcnt(0)
    v_mfma_f32_32x32x16_bf16 v[64:79], v[40:43], v[56:59], v[64:79]
    ds_read_b64_tr_b16 v[32:33], v27 offset:20480
    ds_read_b64_tr_b16 v[34:35], v27 offset:20992
    ds_read_b64_tr_b16 v[36:37], v28 offset:20480
    v_mfma_f32_32x32x16_bf16 v[80:95], v[40:43], v[60:63], v[80:95]
    ds_read_b64_tr_b16 v[38:39], v28 offset:20992
    ds_read_b128 v[48:51], v8 offset:28672
    ds_read_b128 v[52:55], v8 offset:29184
    v_mfma_f32_32x32x16_bf16 v[96:111], v[44:47], v[56:59], v[96:111]
    s_add_u32 m0, s74, 18432
    s_add_u32 s69, s72, 28672
    buffer_load_dwordx4 v10, s[28:31], s72 offen lds
    v_mfma_f32_32x32x16_bf16 v[112:127], v[44:47], v[60:63], v[112:127]
    s_add_u32 m0, s74, 19456
    s_add_u32 s72, s72, 57344
    buffer_load_dwordx4 v10, s[28:31], s69 offen lds
    s_waitcnt vmcnt(20) lgkmcnt(0)
    v_mfma_f32_32x32x16_bf16 v[64:79], v[32:35], v[48:51], v[64:79]
    ds_read_b64_tr_b16 v[40:41], v27 offset:22528
    ds_read_b64_tr_b16 v[42:43], v27 offset:23040
    ds_read_b64_tr_b16 v[44:45], v28 offset:22528
    v_mfma_f32_32x32x16_bf16 v[80:95], v[32:35], v[52:55], v[80:95]
    ds_read_b64_tr_b16 v[46:47], v28 offset:23040
    ds_read_b128 v[56:59], v8 offset:30720
    ds_read_b128 v[60:63], v8 offset:31232
    v_mfma_f32_32x32x16_bf16 v[96:111], v[36:39], v[48:51], v[96:111]
    s_add_u32 m0, s74, 20480
    s_add_u32 s69, s72, 28672
    buffer_load_dwordx4 v10, s[28:31], s72 offen lds
    v_mfma_f32_32x32x16_bf16 v[112:127], v[36:39], v[52:55], v[112:127]
    s_add_u32 m0, s74, 21504
    s_add_u32 s72, s72, 57344
    buffer_load_dwordx4 v10, s[28:31], s69 offen lds
    s_waitcnt vmcnt(20) lgkmcnt(0)
    v_mfma_f32_32x32x16_bf16 v[64:79], v[40:43], v[56:59], v[64:79]
    ds_read_b64_tr_b16 v[32:33], v27 offset:0
    ds_read_b64_tr_b16 v[34:35], v27 offset:512
    ds_read_b64_tr_b16 v[36:37], v28 offset:0
    v_mfma_f32_32x32x16_bf16 v[80:95], v[40:43], v[60:63], v[80:95]
    ds_read_b64_tr_b16 v[38:39], v28 offset:512
    ds_read_b128 v[48:51], v8 offset:32768
    ds_read_b128 v[52:55], v8 offset:33280
    v_mfma_f32_32x32x16_bf16 v[96:111], v[44:47], v[56:59], v[96:111]
    s_add_u32 m0, s74, 22528
    s_add_u32 s69, s72, 28672
    buffer_load_dwordx4 v10, s[28:31], s72 offen lds
    v_mfma_f32_32x32x16_bf16 v[112:127], v[44:47], v[60:63], v[112:127]
    s_add_u32 m0, s74, 23552
    s_add_u32 s72, s72, 57344
    buffer_load_dwordx4 v10, s[28:31], s69 offen lds
    s_waitcnt vmcnt(20) lgkmcnt(0)
    v_mfma_f32_32x32x16_bf16 v[64:79], v[32:35], v[48:51], v[64:79]
    ds_read_b64_tr_b16 v[40:41], v27 offset:2048
    ds_read_b64_tr_b16 v[42:43], v27 offset:2560
    ds_read_b64_tr_b16 v[44:45], v28 offset:2048
    v_mfma_f32_32x32x16_bf16 v[80:95], v[32:35], v[52:55], v[80:95]
    ds_read_b64_tr_b16 v[46:47], v28 offset:2560
    ds_read_b128 v[56:59], v8 offset:34816
    ds_read_b128 v[60:63], v8 offset:35328
    v_mfma_f32_32x32x16_bf16 v[96:111], v[36:39], v[48:51], v[96:111]
    s_add_u32 m0, s74, 0
    s_add_u32 s91, s75, 0
    buffer_load_dwordx4 v11, s[32:35], s91 offen lds
    v_mfma_f32_32x32x16_bf16 v[112:127], v[36:39], v[52:55], v[112:127]
    s_add_u32 m0, s74, 1024
    s_add_u32 s91, s75, 7168
    buffer_load_dwordx4 v11, s[32:35], s91 offen lds
    s_waitcnt vmcnt(20) lgkmcnt(0)
    v_mfma_f32_32x32x16_bf16 v[64:79], v[40:43], v[56:59], v[64:79]
    ds_read_b64_tr_b16 v[32:33], v27 offset:4096
    ds_read_b64_tr_b16 v[34:35], v27 offset:4608
    ds_read_b64_tr_b16 v[36:37], v28 offset:4096
    v_mfma_f32_32x32x16_bf16 v[80:95], v[40:43], v[60:63], v[80:95]
    ds_read_b64_tr_b16 v[38:39], v28 offset:4608
    ds_read_b128 v[48:51], v8 offset:36864
    ds_read_b128 v[52:55], v8 offset:37376
    v_mfma_f32_32x32x16_bf16 v[96:111], v[44:47], v[56:59], v[96:111]
    s_add_u32 m0, s74, 2048
    s_add_u32 s91, s75, 14336
    buffer_load_dwordx4 v11, s[32:35], s91 offen lds
    v_mfma_f32_32x32x16_bf16 v[112:127], v[44:47], v[60:63], v[112:127]
    s_add_u32 m0, s74, 3072
    s_add_u32 s91, s75, 21504
    buffer_load_dwordx4 v11, s[32:35], s91 offen lds
    s_waitcnt vmcnt(20) lgkmcnt(0)
    v_mfma_f32_32x32x16_bf16 v[64:79], v[32:35], v[48:51], v[64:79]
    ds_read_b64_tr_b16 v[40:41], v27 offset:6144
    ds_read_b64_tr_b16 v[42:43], v27 offset:6656
    ds_read_b64_tr_b16 v[44:45], v28 offset:6144
    v_mfma_f32_32x32x16_bf16 v[80:95], v[32:35], v[52:55], v[80:95]
    ds_read_b64_tr_b16 v[46:47], v28 offset:6656
    ds_read_b128 v[56:59], v8 offset:38912
    ds_read_b128 v[60:63], v8 offset:39424
    v_mfma_f32_32x32x16_bf16 v[96:111], v[36:39], v[48:51], v[96:111]
    s_add_u32 m0, s74, 4096
    s_add_u32 s91, s75, 28672
    buffer_load_dwordx4 v11, s[32:35], s91 offen lds
    v_mfma_f32_32x32x16_bf16 v[112:127], v[36:39], v[52:55], v[112:127]
    s_add_u32 m0, s74, 5120
    s_add_u32 s91, s75, 35840
    buffer_load_dwordx4 v11, s[32:35], s91 offen lds
    buffer_load_dword v19, v29, s[44:47], s78 offen sc1
    s_waitcnt vmcnt(21) lgkmcnt(0)
    v_mfma_f32_32x32x16_bf16 v[64:79], v[40:43], v[56:59], v[64:79]
    ds_read_b64_tr_b16 v[32:33], v27 offset:8192
    ds_read_b64_tr_b16 v[34:35], v27 offset:8704
    ds_read_b64_tr_b16 v[36:37], v28 offset:8192
    v_mfma_f32_32x32x16_bf16 v[80:95], v[40:43], v[60:63], v[80:95]
    ds_read_b64_tr_b16 v[38:39], v28 offset:8704
    ds_read_b128 v[48:51], v8 offset:40960
    ds_read_b128 v[52:55], v8 offset:41472
    v_mfma_f32_32x32x16_bf16 v[96:111], v[44:47], v[56:59], v[96:111]
    s_add_u32 m0, s74, 6144
    s_add_u32 s91, s75, 43008
    buffer_load_dwordx4 v11, s[32:35], s91 offen lds
    v_mfma_f32_32x32x16_bf16 v[112:127], v[44:47], v[60:63], v[112:127]
    s_add_u32 m0, s74, 7168
    s_add_u32 s91, s75, 50176
    buffer_load_dwordx4 v11, s[32:35], s91 offen lds
    s_waitcnt vmcnt(21) lgkmcnt(0)
    v_mfma_f32_32x32x16_bf16 v[64:79], v[32:35], v[48:51], v[64:79]
    ds_read_b64_tr_b16 v[40:41], v27 offset:10240
    ds_read_b64_tr_b16 v[42:43], v27 offset:10752
    ds_read_b64_tr_b16 v[44:45], v28 offset:10240
    v_mfma_f32_32x32x16_bf16 v[80:95], v[32:35], v[52:55], v[80:95]
    ds_read_b64_tr_b16 v[46:47], v28 offset:10752
    ds_read_b128 v[56:59], v8 offset:43008
    ds_read_b128 v[60:63], v8 offset:43520
    v_mfma_f32_32x32x16_bf16 v[96:111], v[36:39], v[48:51], v[96:111]
    s_add_u32 m0, s74, 8192
    s_add_u32 s91, s48, 0
    buffer_load_dwordx4 v11, s[32:35], s91 offen lds
    v_mfma_f32_32x32x16_bf16 v[112:127], v[36:39], v[52:55], v[112:127]
    s_add_u32 m0, s74, 9216
    s_add_u32 s91, s48, 7168
    buffer_load_dwordx4 v11, s[32:35], s91 offen lds
    s_waitcnt vmcnt(21) lgkmcnt(0)
    v_mfma_f32_32x32x16_bf16 v[64:79], v[40:43], v[56:59], v[64:79]
    ds_read_b64_tr_b16 v[32:33], v27 offset:12288
    ds_read_b64_tr_b16 v[34:35], v27 offset:12800
    ds_read_b64_tr_b16 v[36:37], v28 offset:12288
    v_mfma_f32_32x32x16_bf16 v[80:95], v[40:43], v[60:63], v[80:95]
    ds_read_b64_tr_b16 v[38:39], v28 offset:12800
    ds_read_b128 v[48:51], v8 offset:45056
    ds_read_b128 v[52:55], v8 offset:45568
    v_mfma_f32_32x32x16_bf16 v[96:111], v[44:47], v[56:59], v[96:111]
    s_add_u32 m0, s74, 10240
    s_add_u32 s91, s49, 0
    buffer_load_dwordx4 v11, s[32:35], s91 offen lds
    v_mfma_f32_32x32x16_bf16 v[112:127], v[44:47], v[60:63], v[112:127]
    s_add_u32 m0, s74, 11264
    s_add_u32 s91, s49, 7168
    buffer_load_dwordx4 v11, s[32:35], s91 offen lds
    s_waitcnt vmcnt(6)
    s_mov_b64 exec, 0x1
    v_cmp_gt_u32 vcc, 1, v19
    s_mov_b64 exec, -1
    s_add_u32 s67, s78, 0
    s_cbranch_vccz L_ok_38
    s_mov_b32 exec_lo, 0x1
    s_mov_b32 exec_hi, 0
    s_mov_b32 s70, 0
L_poll_39:
    buffer_load_dword v19, v29, s[44:47], s67 offen sc1
    s_add_u32 s70, s70, 1
    s_cmp_gt_u32 s70, 400000
    s_cbranch_scc1 L_END
    s_waitcnt vmcnt(0)
    v_cmp_ne_u32 vcc, 0, v19
    s_nop 1
    s_cmp_eq_u64 vcc, exec
    s_cbranch_scc1 L_poll_39_ok
    s_branch L_poll_39
L_poll_39_ok:
    s_mov_b64 exec, -1
L_ok_38:
    v_lshlrev_b32 v13, 4, v4
    buffer_load_dwordx4 v[200:203], v13, s[44:47], s83 offen offset:0 sc1
    buffer_load_dwordx4 v[204:207], v13, s[44:47], s83 offen offset:32 sc1
    s_waitcnt lgkmcnt(0)
    v_mfma_f32_32x32x16_bf16 v[64:79], v[32:35], v[48:51], v[64:79]
    ds_read_b64_tr_b16 v[40:41], v27 offset:14336
    ds_read_b64_tr_b16 v[42:43], v27 offset:14848
    ds_read_b64_tr_b16 v[44:45], v28 offset:14336
    v_mfma_f32_32x32x16_bf16 v[80:95], v[32:35], v[52:55], v[80:95]
    ds_read_b64_tr_b16 v[46:47], v28 offset:14848
    ds_read_b128 v[56:59], v8 offset:47104
    ds_read_b128 v[60:63], v8 offset:47616
    v_mfma_f32_32x32x16_bf16 v[96:111], v[36:39], v[48:51], v[96:111]
    s_add_u32 m0, s74, 12288
    s_add_u32 s91, s50, 0
    buffer_load_dwordx4 v11, s[32:35], s91 offen lds
    v_mfma_f32_32x32x16_bf16 v[112:127], v[36:39], v[52:55], v[112:127]
    s_add_u32 m0, s74, 13312
    s_add_u32 s91, s50, 7168
    buffer_load_dwordx4 v11, s[32:35], s91 offen lds
    buffer_load_dwordx4 v[208:211], v13, s[44:47], s83 offen offset:64 sc1
    buffer_load_dwordx4 v[212:215], v13, s[44:47], s83 offen offset:96 sc1
    s_waitcnt lgkmcnt(0)
    v_mfma_f32_32x32x16_bf16 v[64:79], v[40:43], v[56:59], v[64:79]
    ds_read_b64_tr_b16 v[32:33], v27 offset:16384
    ds_read_b64_tr_b16 v[34:35], v27 offset:16896
    ds_read_b64_tr_b16 v[36:37], v28 offset:16384
    v_mfma_f32_32x32x16_bf16 v[80:95], v[40:43], v[60:63], v[80:95]
    ds_read_b64_tr_b16 v[38:39], v28 offset:16896
    ds_read_b128 v[48:51], v8 offset:49152
    ds_read_b128 v[52:55], v8 offset:49664
    v_mfma_f32_32x32x16_bf16 v[96:111], v[44:47], v[56:59], v[96:111]
    s_add_u32 m0, s74, 14336
    s_add_u32 s91, s51, 0
    buffer_load_dwordx4 v11, s[32:35], s91 offen lds
    v_mfma_f32_32x32x16_bf16 v[112:127], v[44:47], v[60:63], v[112:127]
    s_add_u32 m0, s74, 15360
    s_add_u32 s91, s51, 7168
    buffer_load_dwordx4 v11, s[32:35], s91 offen lds
    buffer_load_dwordx4 v[216:219], v13, s[44:47], s83 offen offset:128 sc1
    buffer_load_dwordx4 v[220:223], v13, s[44:47], s83 offen offset:160 sc1
    s_waitcnt lgkmcnt(0)
    v_mfma_f32_32x32x16_bf16 v[64:79], v[32:35], v[48:51], v[64:79]
    ds_read_b64_tr_b16 v[40:41], v27 offset:18432
    ds_read_b64_tr_b16 v[42:43], v27 offset:18944
    ds_read_b64_tr_b16 v[44:45], v28 offset:18432
    v_mfma_f32_32x32x16_bf16 v[80:95], v[32:35], v[52:55], v[80:95]
    ds_read_b64_tr_b16 v[46:47], v28 offset:18944
    ds_read_b128 v[56:59], v8 offset:51200
    ds_read_b128 v[60:63], v8 offset:51712
    v_mfma_f32_32x32x16_bf16 v[96:111], v[36:39], v[48:51], v[96:111]
    s_add_u32 m0, s74, 16384
    s_add_u32 s91, s52, 0
    buffer_load_dwordx4 v11, s[32:35], s91 offen lds
    v_mfma_f32_32x32x16_bf16 v[112:127], v[36:39], v[52:55], v[112:127]
    s_add_u32 m0, s74, 17408
    s_add_u32 s91, s52, 7168
    buffer_load_dwordx4 v11, s[32:35], s91 offen lds
    buffer_load_dwordx4 v[224:227], v13, s[44:47], s83 offen offset:192 sc1
    buffer_load_dwordx4 v[228:231], v13, s[44:47], s83 offen offset:224 sc1
    s_waitcnt lgkmcnt(0)
    v_mfma_f32_32x32x16_bf16 v[64:79], v[40:43], v[56:59], v[64:79]
    ds_read_b64_tr_b16 v[32:33], v27 offset:20480
    ds_read_b64_tr_b16 v[34:35], v27 offset:20992
    ds_read_b64_tr_b16 v[36:37], v28 offset:20480
    v_mfma_f32_32x32x16_bf16 v[80:95], v[40:43], v[60:63], v[80:95]
    ds_read_b64_tr_b16 v[38:39], v28 offset:20992
    ds_read_b128 v[48:51], v8 offset:53248
    ds_read_b128 v[52:55], v8 offset:53760
    v_mfma_f32_32x32x16_bf16 v[96:111], v[44:47], v[56:59], v[96:111]
    s_add_u32 m0, s74, 18432
    s_add_u32 s91, s53, 0
    buffer_load_dwordx4 v11, s[32:35], s91 offen lds
    v_mfma_f32_32x32x16_bf16 v[112:127], v[44:47], v[60:63], v[112:127]
    s_add_u32 m0, s74, 19456
    s_add_u32 s91, s53, 7168
    buffer_load_dwordx4 v11, s[32:35], s91 offen lds
    s_waitcnt lgkmcnt(0)
    v_mfma_f32_32x32x16_bf16 v[64:79], v[32:35], v[48:51], v[64:79]
    ds_read_b64_tr_b16 v[40:41], v27 offset:22528
    ds_read_b64_tr_b16 v[42:43], v27 offset:23040
    ds_read_b64_tr_b16 v[44:45], v28 offset:22528
    v_mfma_f32_32x32x16_bf16 v[80:95], v[32:35], v[52:55], v[80:95]
    ds_read_b64_tr_b16 v[46:47], v28 offset:23040
    ds_read_b128 v[56:59], v8 offset:55296
    ds_read_b128 v[60:63], v8 offset:55808
    v_mfma_f32_32x32x16_bf16 v[96:111], v[36:39], v[48:51], v[96:111]
    s_add_u32 m0, s74, 20480
    s_add_u32 s91, s48, 14336
    buffer_load_dwordx4 v11, s[32:35], s91 offen lds
    v_mfma_f32_32x32x16_bf16 v[112:127], v[36:39], v[52:55], v[112:127]
    s_add_u32 m0, s74, 21504
    s_add_u32 s91, s48, 21504
    buffer_load_dwordx4 v11, s[32:35], s91 offen lds
    s_waitcnt lgkmcnt(0)
    v_mfma_f32_32x32x16_bf16 v[64:79], v[40:43], v[56:59], v[64:79]
    v_mfma_f32_32x32x16_bf16 v[80:95], v[40:43], v[60:63], v[80:95]
    v_mfma_f32_32x32x16_bf16 v[96:111], v[44:47], v[56:59], v[96:111]
    s_add_u32 m0, s74, 22528
    s_add_u32 s91, s49, 14336
    buffer_load_dwordx4 v11, s[32:35], s91 offen lds
    v_mfma_f32_32x32x16_bf16 v[112:127], v[44:47], v[60:63], v[112:127]
    s_add_u32 m0, s74, 23552
    s_add_u32 s91, s49, 21504
    buffer_load_dwordx4 v11, s[32:35], s91 offen lds
    s_mov_b64 exec, 1
    ds_add_u32 v18, v17 offset:64
    s_mov_b64 exec, -1
    s_setprio 2
    v_lshlrev_b32 v13, 9, v4
    v_sub_u32 v27, v27, v13
    v_xor_b32 v28, 64, v27
    s_lshl_b32 s78, s61, 7
    s_add_u32 s78, s78, s80
    s_add_u32 s78, s78, 2048
    v_lshlrev_b32 v29, 2, v1
    s_lshl_b32 s65, s5, 2
    v_mov_b32 v26, s65
    v_add_u32 v10, 4096, v2
    s_waitcnt vmcnt(6)
    s_lshl_b32 s64, s61, 10
    s_mul_i32 s66, s61, 7168
    s_lshl_b32 s65, s5, 7
    s_add_u32 s66, s66, s65
    v_fma_f32 v64, -v24, v200, v64
    v_fma_f32 v65, -v24, v201, v65
    v_fma_f32 v66, -v24, v202, v66
    v_fma_f32 v67, -v24, v203, v67
    v_fma_f32 v68, -v24, v204, v68
    v_fma_f32 v69, -v24, v205, v69
    v_fma_f32 v70, -v24, v206, v70
    v_fma_f32 v71, -v24, v207, v71
    s_mov_b32 s70, 0
L_lw_40:
    ds_read_b32 v15, v18 offset:64
    s_add_u32 s70, s70, 1
    s_cmp_gt_u32 s70, 3200000
    s_cbranch_scc1 L_END
    s_waitcnt lgkmcnt(0)
    v_readfirstlane_b32 s68, v15
    s_nop 1
    s_cmp_ge_u32 s68, 4
    s_cbranch_scc0 L_lw_40
    v_fma_f32 v80, -v25, v200, v80
    v_fma_f32 v81, -v25, v201, v81
    v_fma_f32 v82, -v25, v202, v82
    v_fma_f32 v83, -v25, v203, v83
    v_fma_f32 v84, -v25, v204, v84
    v_fma_f32 v85, -v25, v205, v85
    v_fma_f32 v86, -v25, v206, v86
    v_fma_f32 v87, -v25, v207, v87
    s_add_u32 m0, s64, 0
    s_add_u32 s65, s66, 0
    buffer_load_dwordx4 v11, s[16:19], s65 offen lds
    v_mul_f32 v32, v64, v64
    v_mul_f32 v33, v65, v65
    v_mul_f32 v34, v66, v66
    v_mul_f32 v35, v67, v67
    v_mul_f32 v36, v68, v68
    v_mul_f32 v37, v69, v69
    v_mul_f32 v38, v70, v70
    v_mul_f32 v39, v71, v71
    s_add_u32 m0, s64, 4096
    s_add_u32 s65, s66, 28672
    buffer_load_dwordx4 v11, s[16:19], s65 offen lds
    v_mul_f32 v40, v80, v80
    v_mul_f32 v41, v81, v81
    v_mul_f32 v42, v82, v82
    v_mul_f32 v43, v83, v83
    v_mul_f32 v44, v84, v84
    v_mul_f32 v45, v85, v85
    v_mul_f32 v46, v86, v86
    v_mul_f32 v47, v87, v87
    s_add_u32 m0, s64, 8192
    s_add_u32 s65, s66, 57344
    buffer_load_dwordx4 v11, s[16:19], s65 offen lds
    v_fma_f32 v32, v32, v7, v5
    v_fma_f32 v33, v33, v7, v5
    v_fma_f32 v34, v34, v7, v5
    v_fma_f32 v35, v35, v7, v5
    v_fma_f32 v36, v36, v7, v5
    v_fma_f32 v37, v37, v7, v5
    v_fma_f32 v38, v38, v7, v5
    v_fma_f32 v39, v39, v7, v5
    s_add_u32 m0, s64, 12288
    s_add_u32 s65, s66, 86016
    buffer_load_dwordx4 v11, s[16:19], s65 offen lds
    v_fma_f32 v40, v40, v9, v6
    v_fma_f32 v41, v41, v9, v6
    v_fma_f32 v42, v42, v9, v6
    v_fma_f32 v43, v43, v9, v6
    v_fma_f32 v44, v44, v9, v6
    v_fma_f32 v45, v45, v9, v6
    v_fma_f32 v46, v46, v9, v6
    v_fma_f32 v47, v47, v9, v6
    s_add_u32 m0, s64, 16384
    s_add_u32 s65, s66, 114688
    buffer_load_dwordx4 v11, s[16:19], s65 offen lds
    v_mul_f32 v32, v32, v64
    v_mul_f32 v33, v33, v65
    v_mul_f32 v34, v34, v66
    v_mul_f32 v35, v35, v67
    v_mul_f32 v36, v36, v68
    v_mul_f32 v37, v37, v69
    v_mul_f32 v38, v38, v70
    v_mul_f32 v39, v39, v71
    s_add_u32 m0, s64, 20480
    s_add_u32 s65, s66, 143360
    buffer_load_dwordx4 v11, s[16:19], s65 offen lds
    v_mul_f32 v40, v40, v80
    v_mul_f32 v41, v41, v81
    v_mul_f32 v42, v42, v82
    v_mul_f32 v43, v43, v83
    v_mul_f32 v44, v44, v84
    v_mul_f32 v45, v45, v85
    v_mul_f32 v46, v46, v86
    v_mul_f32 v47, v47, v87
    s_add_u32 m0, s64, 24576
    s_add_u32 s65, s66, 172032
    buffer_load_dwordx4 v11, s[16:19], s65 offen lds
    v_exp_f32 v32, v32
    v_exp_f32 v33, v33
    v_exp_f32 v34, v34
    v_exp_f32 v35, v35
    v_exp_f32 v36, v36
    v_exp_f32 v37, v37
    v_exp_f32 v38, v38
    v_exp_f32 v39, v39
    s_add_u32 m0, s64, 28672
    s_add_u32 s65, s66, 200704
    buffer_load_dwordx4 v11, s[16:19], s65 offen lds
    v_exp_f32 v40, v40
    v_exp_f32 v41, v41
    v_exp_f32 v42, v42
    v_exp_f32 v43, v43
    v_exp_f32 v44, v44
    v_exp_f32 v45, v45
    v_exp_f32 v46, v46
    v_exp_f32 v47, v47
    s_add_u32 m0, s64, 32768
    s_add_u32 s65, s66, 229376
    buffer_load_dwordx4 v11, s[16:19], s65 offen lds
    v_add_f32 v32, 1.0, v32
    v_add_f32 v33, 1.0, v33
    v_add_f32 v34, 1.0, v34
    v_add_f32 v35, 1.0, v35
    v_add_f32 v36, 1.0, v36
    v_add_f32 v37, 1.0, v37
    v_add_f32 v38, 1.0, v38
    v_add_f32 v39, 1.0, v39
    s_add_u32 m0, s64, 36864
    s_add_u32 s65, s66, 258048
    buffer_load_dwordx4 v11, s[16:19], s65 offen lds
    v_add_f32 v40, 1.0, v40
    v_add_f32 v41, 1.0, v41
    v_add_f32 v42, 1.0, v42
    v_add_f32 v43, 1.0, v43
    v_add_f32 v44, 1.0, v44
    v_add_f32 v45, 1.0, v45
    v_add_f32 v46, 1.0, v46
    v_add_f32 v47, 1.0, v47
    s_add_u32 m0, s64, 40960
    s_add_u32 s65, s66, 286720
    buffer_load_dwordx4 v11, s[16:19], s65 offen lds
    v_rcp_f32 v32, v32
    v_rcp_f32 v33, v33
    v_rcp_f32 v34, v34
    v_rcp_f32 v35, v35
    v_rcp_f32 v36, v36
    v_rcp_f32 v37, v37
    v_rcp_f32 v38, v38
    v_rcp_f32 v39, v39
    s_add_u32 m0, s64, 45056
    s_add_u32 s65, s66, 315392
    buffer_load_dwordx4 v11, s[16:19], s65 offen lds
    v_rcp_f32 v40, v40
    v_rcp_f32 v41, v41
    v_rcp_f32 v42, v42
    v_rcp_f32 v43, v43
    v_rcp_f32 v44, v44
    v_rcp_f32 v45, v45
    v_rcp_f32 v46, v46
    v_rcp_f32 v47, v47
    s_add_u32 m0, s64, 49152
    s_add_u32 s65, s66, 344064
    buffer_load_dwordx4 v11, s[16:19], s65 offen lds
    v_mul_f32 v64, v64, v32
    v_mul_f32 v65, v65, v33
    v_mul_f32 v66, v66, v34
    v_mul_f32 v67, v67, v35
    v_mul_f32 v68, v68, v36
    v_mul_f32 v69, v69, v37
    v_mul_f32 v70, v70, v38
    v_mul_f32 v71, v71, v39
    s_add_u32 m0, s64, 53248
    s_add_u32 s65, s66, 372736
    buffer_load_dwordx4 v11, s[16:19], s65 offen lds
    v_mul_f32 v80, v80, v40
    v_mul_f32 v81, v81, v41
    v_mul_f32 v82, v82, v42
    v_mul_f32 v83, v83, v43
    v_mul_f32 v84, v84, v44
    v_mul_f32 v85, v85, v45
    v_mul_f32 v86, v86, v46
    v_mul_f32 v87, v87, v47
    v_cvt_pk_bf16_f32 v200, v64, v65
    v_cvt_pk_bf16_f32 v201, v66, v67
    v_cvt_pk_bf16_f32 v202, v68, v69
    v_cvt_pk_bf16_f32 v203, v70, v71
    v_cvt_pk_bf16_f32 v204, v80, v81
    v_cvt_pk_bf16_f32 v205, v82, v83
    v_cvt_pk_bf16_f32 v206, v84, v85
    v_cvt_pk_bf16_f32 v207, v86, v87
    v_fma_f32 v72, -v24, v208, v72
    v_fma_f32 v73, -v24, v209, v73
    v_fma_f32 v74, -v24, v210, v74
    v_fma_f32 v75, -v24, v211, v75
    v_fma_f32 v76, -v24, v212, v76
    v_fma_f32 v77, -v24, v213, v77
    v_fma_f32 v78, -v24, v214, v78
    v_fma_f32 v79, -v24, v215, v79
    v_fma_f32 v88, -v25, v208, v88
    v_fma_f32 v89, -v25, v209, v89
    v_fma_f32 v90, -v25, v210, v90
    s_add_u32 s77, s76, 0
    buffer_store_dwordx4 v[200:203], v2, s[44:47], s77 offen offset:0 sc1
    v_fma_f32 v91, -v25, v211, v91
    v_fma_f32 v92, -v25, v212, v92
    v_fma_f32 v93, -v25, v213, v93
    v_fma_f32 v94, -v25, v214, v94
    v_fma_f32 v95, -v25, v215, v95
    v_mul_f32 v32, v72, v72
    v_mul_f32 v33, v73, v73
    v_mul_f32 v34, v74, v74
    v_mul_f32 v35, v75, v75
    v_mul_f32 v36, v76, v76
    v_mul_f32 v37, v77, v77
    buffer_store_dwordx4 v[204:207], v2, s[44:47], s77 offen offset:1024 sc1
    v_mul_f32 v38, v78, v78
    v_mul_f32 v39, v79, v79
    v_mul_f32 v40, v88, v88
    v_mul_f32 v41, v89, v89
    v_mul_f32 v42, v90, v90
    v_mul_f32 v43, v91, v91
    v_mul_f32 v44, v92, v92
    v_mul_f32 v45, v93, v93
    v_mul_f32 v46, v94, v94
    v_mul_f32 v47, v95, v95
    v_fma_f32 v32, v32, v7, v5
    v_fma_f32 v33, v33, v7, v5
    v_fma_f32 v34, v34, v7, v5
    v_fma_f32 v35, v35, v7, v5
    v_fma_f32 v36, v36, v7, v5
    v_fma_f32 v37, v37, v7, v5
    v_fma_f32 v38, v38, v7, v5
    v_fma_f32 v39, v39, v7, v5
    v_fma_f32 v40, v40, v9, v6
    v_fma_f32 v41, v41, v9, v6
    v_fma_f32 v42, v42, v9, v6
    v_fma_f32 v43, v43, v9, v6
    ds_read_b64_tr_b16 v[136:137], v27 offset:0
    ds_read_b64_tr_b16 v[138:139], v27 offset:1024
    ds_read_b64_tr_b16 v[140:141], v28 offset:0
    ds_read_b64_tr_b16 v[142:143], v28 offset:1024
    v_fma_f32 v44, v44, v9, v6
    v_fma_f32 v45, v45, v9, v6
    v_fma_f32 v46, v46, v9, v6
    v_fma_f32 v47, v47, v9, v6
    v_mul_f32 v32, v32, v72
    v_mul_f32 v33, v33, v73
    v_mul_f32 v34, v34, v74
    v_mul_f32 v35, v35, v75
    v_mul_f32 v36, v36, v76
    v_mul_f32 v37, v37, v77
    v_mul_f32 v38, v38, v78
    ds_read_b64_tr_b16 v[144:145], v27 offset:2048
    ds_read_b64_tr_b16 v[146:147], v27 offset:3072
    ds_read_b64_tr_b16 v[148:149], v28 offset:2048
    ds_read_b64_tr_b16 v[150:151], v28 offset:3072
    v_mul_f32 v39, v39, v79
    v_mul_f32 v40, v40, v88
    v_mul_f32 v41, v41, v89
    v_mul_f32 v42, v42, v90
    v_mul_f32 v43, v43, v91
    v_mul_f32 v44, v44, v92
    v_mul_f32 v45, v45, v93
    v_mul_f32 v46, v46, v94
    v_mul_f32 v47, v47, v95
    v_exp_f32 v32, v32
    v_exp_f32 v33, v33
    ds_read_b64_tr_b16 v[152:153], v27 offset:4096
    ds_read_b64_tr_b16 v[154:155], v27 offset:5120
    ds_read_b64_tr_b16 v[156:157], v28 offset:4096
    ds_read_b64_tr_b16 v[158:159], v28 offset:5120
    v_exp_f32 v34, v34
    v_exp_f32 v35, v35
    v_exp_f32 v36, v36
    v_exp_f32 v37, v37
    v_exp_f32 v38, v38
    v_exp_f32 v39, v39
    v_exp_f32 v40, v40
    v_exp_f32 v41, v41
    v_exp_f32 v42, v42
    v_exp_f32 v43, v43
    v_exp_f32 v44, v44
    ds_read_b64_tr_b16 v[160:161], v27 offset:6144
    ds_read_b64_tr_b16 v[162:163], v27 offset:7168
    ds_read_b64_tr_b16 v[164:165], v28 offset:6144
    ds_read_b64_tr_b16 v[166:167], v28 offset:7168
    v_exp_f32 v45, v45
    v_exp_f32 v46, v46
    v_exp_f32 v47, v47
    v_add_f32 v32, 1.0, v32
    v_add_f32 v33, 1.0, v33
    v_add_f32 v34, 1.0, v34
    v_add_f32 v35, 1.0, v35
    v_add_f32 v36, 1.0, v36
    v_add_f32 v37, 1.0, v37
    v_add_f32 v38, 1.0, v38
    v_add_f32 v39, 1.0, v39
    ds_read_b64_tr_b16 v[168:169], v27 offset:8192
    ds_read_b64_tr_b16 v[170:171], v27 offset:9216
    ds_read_b64_tr_b16 v[172:173], v28 offset:8192
    ds_read_b64_tr_b16 v[174:175], v28 offset:9216
    v_add_f32 v40, 1.0, v40
    v_add_f32 v41, 1.0, v41
    v_add_f32 v42, 1.0, v42
    v_add_f32 v43, 1.0, v43
    v_add_f32 v44, 1.0, v44
    v_add_f32 v45, 1.0, v45
    v_add_f32 v46, 1.0, v46
    v_add_f32 v47, 1.0, v47
    v_rcp_f32 v32, v32
    v_rcp_f32 v33, v33
    v_rcp_f32 v34, v34
    ds_read_b64_tr_b16 v[176:177], v27 offset:10240
    ds_read_b64_tr_b16 v[178:179], v27 offset:11264
    ds_read_b64_tr_b16 v[180:181], v28 offset:10240
    ds_read_b64_tr_b16 v[182:183], v28 offset:11264
    v_rcp_f32 v35, v35
    v_rcp_f32 v36, v36
    v_rcp_f32 v37, v37
    v_rcp_f32 v38, v38
    v_rcp_f32 v39, v39
    v_rcp_f32 v40, v40
    v_rcp_f32 v41, v41
    v_rcp_f32 v42, v42
    v_rcp_f32 v43, v43
    v_rcp_f32 v44, v44
    v_rcp_f32 v45, v45
    ds_read_b64_tr_b16 v[184:185], v27 offset:12288
    ds_read_b64_tr_b16 v[186:187], v27 offset:13312
    ds_read_b64_tr_b16 v[188:189], v28 offset:12288
    ds_read_b64_tr_b16 v[190:191], v28 offset:13312
    v_rcp_f32 v46, v46
    v_rcp_f32 v47, v47
    v_mul_f32 v72, v72, v32
    v_mul_f32 v73, v73, v33
    v_mul_f32 v74, v74, v34
    v_mul_f32 v75, v75, v35
    v_mul_f32 v76, v76, v36
    v_mul_f32 v77, v77, v37
    v_mul_f32 v78, v78, v38
    v_mul_f32 v79, v79, v39
    v_mul_f32 v88, v88, v40
    ds_read_b64_tr_b16 v[192:193], v27 offset:14336
    ds_read_b64_tr_b16 v[194:195], v27 offset:15360
    ds_read_b64_tr_b16 v[196:197], v28 offset:14336
    ds_read_b64_tr_b16 v[198:199], v28 offset:15360
    v_mul_f32 v89, v89, v41
    v_mul_f32 v90, v90, v42
    v_mul_f32 v91, v91, v43
    v_mul_f32 v92, v92, v44
    v_mul_f32 v93, v93, v45
    v_mul_f32 v94, v94, v46
    v_mul_f32 v95, v95, v47
    v_cvt_pk_bf16_f32 v208, v72, v73
    v_cvt_pk_bf16_f32 v209, v74, v75
    v_cvt_pk_bf16_f32 v210, v76, v77
    v_cvt_pk_bf16_f32 v211, v78, v79
    v_cvt_pk_bf16_f32 v212, v88, v89
    v_cvt_pk_bf16_f32 v213, v90, v91
    v_cvt_pk_bf16_f32 v214, v92, v93
    v_cvt_pk_bf16_f32 v215, v94, v95
    v_fma_f32 v96, -v24, v216, v96
    v_fma_f32 v97, -v24, v217, v97
    v_fma_f32 v98, -v24, v218, v98
    v_fma_f32 v99, -v24, v219, v99
    v_fma_f32 v100, -v24, v220, v100
    v_fma_f32 v101, -v24, v221, v101
    v_fma_f32 v102, -v24, v222, v102
    v_fma_f32 v103, -v24, v223, v103
    s_add_u32 s77, s76, 2048
    buffer_store_dwordx4 v[208:211], v2, s[44:47], s77 offen offset:0 sc1
    v_fma_f32 v112, -v25, v216, v112
    v_fma_f32 v113, -v25, v217, v113
    v_fma_f32 v114, -v25, v218, v114
    v_fma_f32 v115, -v25, v219, v115
    v_fma_f32 v116, -v25, v220, v116
    v_fma_f32 v117, -v25, v221, v117
    v_fma_f32 v118, -v25, v222, v118
    v_fma_f32 v119, -v25, v223, v119
    buffer_store_dwordx4 v[212:215], v2, s[44:47], s77 offen offset:1024 sc1
    v_mul_f32 v32, v96, v96
    v_mul_f32 v33, v97, v97
    v_mul_f32 v34, v98, v98
    v_mul_f32 v35, v99, v99
    v_mul_f32 v36, v100, v100
    v_mul_f32 v37, v101, v101
    v_mul_f32 v38, v102, v102
    v_mul_f32 v39, v103, v103
    s_waitcnt lgkmcnt(0)
    v_mul_f32 v40, v112, v112
    v_mul_f32 v41, v113, v113
    v_mul_f32 v42, v114, v114
    v_mul_f32 v43, v115, v115
    v_mul_f32 v44, v116, v116
    v_mul_f32 v45, v117, v117
    v_mul_f32 v46, v118, v118
    v_mul_f32 v47, v119, v119
    s_waitcnt vmcnt(2)
    v_mov_b32 v13, 1
    s_mov_b64 exec, 1
    s_cmp_eq_u32 s82, 0
    s_cbranch_scc1 L_far_41
    buffer_store_dword v13, v26, s[44:47], s78 offen
    s_branch L_md_42
L_far_41:
    buffer_store_dword v13, v26, s[44:47], s78 offen sc1
L_md_42:
    s_mov_b64 exec, -1
    v_fma_f32 v32, v32, v7, v5
    v_fma_f32 v33, v33, v7, v5
    v_fma_f32 v34, v34, v7, v5
    v_fma_f32 v35, v35, v7, v5
    v_fma_f32 v36, v36, v7, v5
    v_fma_f32 v37, v37, v7, v5
    v_fma_f32 v38, v38, v7, v5
    v_fma_f32 v39, v39, v7, v5
    s_mov_b64 exec, 1
    ds_add_u32 v18, v17 offset:88
    s_mov_b64 exec, -1
    v_fma_f32 v40, v40, v9, v6
    v_fma_f32 v41, v41, v9, v6
    v_fma_f32 v42, v42, v9, v6
    v_fma_f32 v43, v43, v9, v6
    v_fma_f32 v44, v44, v9, v6
    v_fma_f32 v45, v45, v9, v6
    v_fma_f32 v46, v46, v9, v6
    v_fma_f32 v47, v47, v9, v6
    s_add_u32 m0, s74, 0
    s_add_u32 s91, s50, 14336
    buffer_load_dwordx4 v11, s[32:35], s91 offen lds
    v_mul_f32 v32, v32, v96
    v_mul_f32 v33, v33, v97
    v_mul_f32 v34, v34, v98
    v_mul_f32 v35, v35, v99
    v_mul_f32 v36, v36, v100
    v_mul_f32 v37, v37, v101
    v_mul_f32 v38, v38, v102
    v_mul_f32 v39, v39, v103
    s_add_u32 m0, s74, 1024
    s_add_u32 s91, s50, 21504
    buffer_load_dwordx4 v11, s[32:35], s91 offen lds
    v_mul_f32 v40, v40, v112
    v_mul_f32 v41, v41, v113
    v_mul_f32 v42, v42, v114
    v_mul_f32 v43, v43, v115
    v_mul_f32 v44, v44, v116
    v_mul_f32 v45, v45, v117
    v_mul_f32 v46, v46, v118
    v_mul_f32 v47, v47, v119
    s_add_u32 m0, s74, 2048
    s_add_u32 s91, s51, 14336
    buffer_load_dwordx4 v11, s[32:35], s91 offen lds
    v_exp_f32 v32, v32
    v_exp_f32 v33, v33
    v_exp_f32 v34, v34
    v_exp_f32 v35, v35
    v_exp_f32 v36, v36
    v_exp_f32 v37, v37
    v_exp_f32 v38, v38
    v_exp_f32 v39, v39
    s_add_u32 m0, s74, 3072
    s_add_u32 s91, s51, 21504
    buffer_load_dwordx4 v11, s[32:35], s91 offen lds
    v_exp_f32 v40, v40
    v_exp_f32 v41, v41
    v_exp_f32 v42, v42
    v_exp_f32 v43, v43
    v_exp_f32 v44, v44
    v_exp_f32 v45, v45
    v_exp_f32 v46, v46
    v_exp_f32 v47, v47
    s_add_u32 m0, s74, 4096
    s_add_u32 s91, s52, 14336
    buffer_load_dwordx4 v11, s[32:35], s91 offen lds
    v_add_f32 v32, 1.0, v32
    v_add_f32 v33, 1.0, v33
    v_add_f32 v34, 1.0, v34
    v_add_f32 v35, 1.0, v35
    v_add_f32 v36, 1.0, v36
    v_add_f32 v37, 1.0, v37
    v_add_f32 v38, 1.0, v38
    v_add_f32 v39, 1.0, v39
    s_add_u32 m0, s74, 5120
    s_add_u32 s91, s52, 21504
    buffer_load_dwordx4 v11, s[32:35], s91 offen lds
    v_add_f32 v40, 1.0, v40
    v_add_f32 v41, 1.0, v41
    v_add_f32 v42, 1.0, v42
    v_add_f32 v43, 1.0, v43
    v_add_f32 v44, 1.0, v44
    v_add_f32 v45, 1.0, v45
    v_add_f32 v46, 1.0, v46
    v_add_f32 v47, 1.0, v47
    s_add_u32 m0, s74, 6144
    s_add_u32 s91, s53, 14336
    buffer_load_dwordx4 v11, s[32:35], s91 offen lds
    v_rcp_f32 v32, v32
    v_rcp_f32 v33, v33
    v_rcp_f32 v34, v34
    v_rcp_f32 v35, v35
    v_rcp_f32 v36, v36
    v_rcp_f32 v37, v37
    v_rcp_f32 v38, v38
    v_rcp_f32 v39, v39
    s_add_u32 m0, s74, 7168
    s_add_u32 s91, s53, 21504
    buffer_load_dwordx4 v11, s[32:35], s91 offen lds
    v_rcp_f32 v40, v40
    v_rcp_f32 v41, v41
    v_rcp_f32 v42, v42
    v_rcp_f32 v43, v43
    v_rcp_f32 v44, v44
    v_rcp_f32 v45, v45
    v_rcp_f32 v46, v46
    v_rcp_f32 v47, v47
    s_waitcnt vmcnt(9)
    v_mov_b32 v13, 2
    s_mov_b64 exec, 1
    s_cmp_eq_u32 s82, 0
    s_cbranch_scc1 L_far_43
    buffer_store_dword v13, v26, s[44:47], s78 offen
    s_branch L_md_44
L_far_43:
    buffer_store_dword v13, v26, s[44:47], s78 offen sc1
L_md_44:
    s_mov_b64 exec, -1
    v_mul_f32 v96, v96, v32
    v_mul_f32 v97, v97, v33
    v_mul_f32 v98, v98, v34
    v_mul_f32 v99, v99, v35
    v_mul_f32 v100, v100, v36
    v_mul_f32 v101, v101, v37
    v_mul_f32 v102, v102, v38
    v_mul_f32 v103, v103, v39
    s_mov_b64 exec, 0x7f
    buffer_load_dword v19, v29, s[44:47], s78 offen sc1
    s_mov_b64 exec, -1
    v_mul_f32 v112, v112, v40
    v_mul_f32 v113, v113, v41
    v_mul_f32 v114, v114, v42
    v_mul_f32 v115, v115, v43
    v_mul_f32 v116, v116, v44
    v_mul_f32 v117, v117, v45
    v_mul_f32 v118, v118, v46
    v_mul_f32 v119, v119, v47
    v_cvt_pk_bf16_f32 v216, v96, v97
    v_cvt_pk_bf16_f32 v217, v98, v99
    v_cvt_pk_bf16_f32 v218, v100, v101
    v_cvt_pk_bf16_f32 v219, v102, v103
    v_cvt_pk_bf16_f32 v220, v112, v113
    v_cvt_pk_bf16_f32 v221, v114, v115
    v_cvt_pk_bf16_f32 v222, v116, v117
    v_cvt_pk_bf16_f32 v223, v118, v119
    v_fma_f32 v104, -v24, v224, v104
    v_fma_f32 v105, -v24, v225, v105
    v_fma_f32 v106, -v24, v226, v106
    v_fma_f32 v107, -v24, v227, v107
    v_fma_f32 v108, -v24, v228, v108
    v_fma_f32 v109, -v24, v229, v109
    s_add_u32 s77, s76, 4096
    buffer_store_dwordx4 v[216:219], v2, s[44:47], s77 offen offset:0 sc1
    v_fma_f32 v110, -v24, v230, v110
    v_fma_f32 v111, -v24, v231, v111
    v_fma_f32 v120, -v25, v224, v120
    v_fma_f32 v121, -v25, v225, v121
    v_fma_f32 v122, -v25, v226, v122
    v_fma_f32 v123, -v25, v227, v123
    buffer_store_dwordx4 v[220:223], v2, s[44:47], s77 offen offset:1024 sc1
    v_fma_f32 v124, -v25, v228, v124
    v_fma_f32 v125, -v25, v229, v125
    v_fma_f32 v126, -v25, v230, v126
    v_fma_f32 v127, -v25, v231, v127
    v_mul_f32 v32, v104, v104
    v_mul_f32 v33, v105, v105
    s_add_u32 m0, s74, 8192
    s_add_u32 s91, s48, 28672
    buffer_load_dwordx4 v11, s[32:35], s91 offen lds
    v_mul_f32 v34, v106, v106
    v_mul_f32 v35, v107, v107
    v_mul_f32 v36, v108, v108
    v_mul_f32 v37, v109, v109
    v_mul_f32 v38, v110, v110
    v_mul_f32 v39, v111, v111
    s_add_u32 m0, s74, 9216
    s_add_u32 s91, s48, 35840
    buffer_load_dwordx4 v11, s[32:35], s91 offen lds
    v_mul_f32 v40, v120, v120
    v_mul_f32 v41, v121, v121
    v_mul_f32 v42, v122, v122
    v_mul_f32 v43, v123, v123
    v_mul_f32 v44, v124, v124
    v_mul_f32 v45, v125, v125
    s_waitcnt vmcnt(4)
    s_mov_b64 exec, 0x7f
    v_cmp_gt_u32 vcc, 1, v19
    s_mov_b64 exec, -1
    s_add_u32 s67, s78, 0
    s_cbranch_vccz L_ok_45
    s_mov_b32 exec_lo, 0x7f
    s_mov_b32 exec_hi, 0
    s_mov_b32 s70, 0
L_poll_46:
    buffer_load_dword v19, v29, s[44:47], s67 offen sc1
    s_add_u32 s70, s70, 1
    s_cmp_gt_u32 s70, 400000
    s_cbranch_scc1 L_END
    s_waitcnt vmcnt(0)
    v_cmp_ne_u32 vcc, 0, v19
    s_nop 1
    s_cmp_eq_u64 vcc, exec
    s_cbranch_scc1 L_poll_46_ok
    s_branch L_poll_46
L_poll_46_ok:
    s_mov_b64 exec, -1
L_ok_45:
    v_mul_f32 v46, v126, v126
    v_mul_f32 v47, v127, v127
    v_fma_f32 v32, v32, v7, v5
    v_fma_f32 v33, v33, v7, v5
    v_fma_f32 v34, v34, v7, v5
    v_fma_f32 v35, v35, v7, v5
    buffer_load_dwordx4 v[48:51], v2, s[44:47], s54 offen offset:0 sc1
    v_fma_f32 v36, v36, v7, v5
    v_fma_f32 v37, v37, v7, v5
    v_fma_f32 v38, v38, v7, v5
    v_fma_f32 v39, v39, v7, v5
    v_fma_f32 v40, v40, v9, v6
    v_fma_f32 v41, v41, v9, v6
    s_add_u32 m0, s74, 10240
    s_add_u32 s91, s49, 28672
    buffer_load_dwordx4 v11, s[32:35], s91 offen lds
    v_fma_f32 v42, v42, v9, v6
    v_fma_f32 v43, v43, v9, v6
    v_fma_f32 v44, v44, v9, v6
    v_fma_f32 v45, v45, v9, v6
    v_fma_f32 v46, v46, v9, v6
    v_fma_f32 v47, v47, v9, v6
    buffer_load_dwordx4 v[52:55], v2, s[44:47], s54 offen offset:1024 sc1
    v_mul_f32 v32, v32, v104
    v_mul_f32 v33, v33, v105
    v_mul_f32 v34, v34, v106
    v_mul_f32 v35, v35, v107
    v_mul_f32 v36, v36, v108
    v_mul_f32 v37, v37, v109
    s_add_u32 m0, s74, 11264
    s_add_u32 s91, s49, 35840
    buffer_load_dwordx4 v11, s[32:35], s91 offen lds
    v_mul_f32 v38, v38, v110
    v_mul_f32 v39, v39, v111
    v_mul_f32 v40, v40, v120
    v_mul_f32 v41, v41, v121
    v_mul_f32 v42, v42, v122
    v_mul_f32 v43, v43, v123
    buffer_load_dwordx4 v[56:59], v2, s[44:47], s55 offen offset:0 sc1
    v_mul_f32 v44, v44, v124
    v_mul_f32 v45, v45, v125
    v_mul_f32 v46, v46, v126
    v_mul_f32 v47, v47, v127
    v_exp_f32 v32, v32
    v_exp_f32 v33, v33
    s_add_u32 m0, s74, 12288
    s_add_u32 s91, s50, 28672
    buffer_load_dwordx4 v11, s[32:35], s91 offen lds
    v_exp_f32 v34, v34
    v_exp_f32 v35, v35
    v_exp_f32 v36, v36
    v_exp_f32 v37, v37
    v_exp_f32 v38, v38
    v_exp_f32 v39, v39
    buffer_load_dwordx4 v[60:63], v2, s[44:47], s55 offen offset:1024 sc1
    v_exp_f32 v40, v40
    v_exp_f32 v41, v41
    v_exp_f32 v42, v42
    v_exp_f32 v43, v43
    v_exp_f32 v44, v44
    v_exp_f32 v45, v45
    s_add_u32 m0, s74, 13312
    s_add_u32 s91, s50, 35840
    buffer_load_dwordx4 v11, s[32:35], s91 offen lds
    v_exp_f32 v46, v46
    v_exp_f32 v47, v47
    v_add_f32 v32, 1.0, v32
    v_add_f32 v33, 1.0, v33
    v_add_f32 v34, 1.0, v34
    v_add_f32 v35, 1.0, v35
    buffer_load_dwordx4 v[128:131], v2, s[44:47], s56 offen offset:0 sc1
    v_add_f32 v36, 1.0, v36
    v_add_f32 v37, 1.0, v37
    v_add_f32 v38, 1.0, v38
    v_add_f32 v39, 1.0, v39
    v_add_f32 v40, 1.0, v40
    v_add_f32 v41, 1.0, v41
    s_add_u32 m0, s74, 14336
    s_add_u32 s91, s51, 28672
    buffer_load_dwordx4 v11, s[32:35], s91 offen lds
    v_add_f32 v42, 1.0, v42
    v_add_f32 v43, 1.0, v43
    v_add_f32 v44, 1.0, v44
    v_add_f32 v45, 1.0, v45
    v_add_f32 v46, 1.0, v46
    v_add_f32 v47, 1.0, v47
    buffer_load_dwordx4 v[132:135], v2, s[44:47], s56 offen offset:1024 sc1
    v_rcp_f32 v32, v32
    v_rcp_f32 v33, v33
    v_rcp_f32 v34, v34
    v_rcp_f32 v35, v35
    v_rcp_f32 v36, v36
    v_rcp_f32 v37, v37
    s_add_u32 m0, s74, 15360
    s_add_u32 s91, s51, 35840
    buffer_load_dwordx4 v11, s[32:35], s91 offen lds
    v_rcp_f32 v38, v38
    v_rcp_f32 v39, v39
    v_rcp_f32 v40, v40
    v_rcp_f32 v41, v41
    v_rcp_f32 v42, v42
    v_rcp_f32 v43, v43
    s_waitcnt vmcnt(14)
    v_mov_b32 v13, 3
    s_mov_b64 exec, 1
    s_cmp_eq_u32 s82, 0
    s_cbranch_scc1 L_far_47
    buffer_store_dword v13, v26, s[44:47], s78 offen
    s_branch L_md_48
L_far_47:
    buffer_store_dword v13, v26, s[44:47], s78 offen sc1
L_md_48:
    s_mov_b64 exec, -1
    v_rcp_f32 v44, v44
    v_rcp_f32 v45, v45
    v_rcp_f32 v46, v46
    v_rcp_f32 v47, v47
    v_mul_f32 v104, v104, v32
    v_mul_f32 v105, v105, v33
    s_mov_b64 exec, 0x7f
    buffer_load_dword v19, v29, s[44:47], s78 offen sc1
    s_mov_b64 exec, -1
    v_mul_f32 v106, v106, v34
    v_mul_f32 v107, v107, v35
    v_mul_f32 v108, v108, v36
    v_mul_f32 v109, v109, v37
    v_mul_f32 v110, v110, v38
    v_mul_f32 v111, v111, v39
    v_mul_f32 v120, v120, v40
    v_mul_f32 v121, v121, v41
    v_mul_f32 v122, v122, v42
    v_mul_f32 v123, v123, v43
    v_mul_f32 v124, v124, v44
    v_mul_f32 v125, v125, v45
    v_mul_f32 v126, v126, v46
    v_mul_f32 v127, v127, v47
    v_cvt_pk_bf16_f32 v224, v104, v105
    v_cvt_pk_bf16_f32 v225, v106, v107
    v_cvt_pk_bf16_f32 v226, v108, v109
    v_cvt_pk_bf16_f32 v227, v110, v111
    v_cvt_pk_bf16_f32 v228, v120, v121
    v_cvt_pk_bf16_f32 v229, v122, v123
    v_cvt_pk_bf16_f32 v230, v124, v125
    v_cvt_pk_bf16_f32 v231, v126, v127
    s_setprio 0
    v_mfma_f32_32x32x16_bf16 v[64:79], v[136:139], v[200:203], 0
    s_add_u32 s77, s76, 6144
    buffer_store_dwordx4 v[224:227], v2, s[44:47], s77 offen offset:0 sc1
    v_mfma_f32_32x32x16_bf16 v[80:95], v[136:139], v[204:207], 0
    buffer_store_dwordx4 v[228:231], v2, s[44:47], s77 offen offset:1024 sc1
    v_mfma_f32_32x32x16_bf16 v[96:111], v[140:143], v[200:203], 0
    v_mfma_f32_32x32x16_bf16 v[112:127], v[140:143], v[204:207], 0
    v_mfma_f32_32x32x16_bf16 v[64:79], v[144:147], v[208:211], v[64:79]
    s_waitcnt vmcnt(2)
    s_mov_b64 exec, 0x7f
    v_cmp_gt_u32 vcc, 2, v19
    s_mov_b64 exec, -1
    s_add_u32 s67, s78, 0
    s_cbranch_vccz L_ok_49
    s_mov_b32 exec_lo, 0x7f
    s_mov_b32 exec_hi, 0
    s_mov_b32 s70, 0
L_poll_50:
    buffer_load_dword v19, v29, s[44:47], s67 offen sc1
    s_add_u32 s70, s70, 1
    s_cmp_gt_u32 s70, 400000
    s_cbranch_scc1 L_END
    s_waitcnt vmcnt(0)
    v_cmp_le_u32 vcc, 2, v19
    s_nop 1
    s_cmp_eq_u64 vcc, exec
    s_cbranch_scc1 L_poll_50_ok
    s_branch L_poll_50
L_poll_50_ok:
    s_mov_b64 exec, -1
L_ok_49:
    buffer_load_dwordx4 v[136:139], v2, s[44:47], s57 offen offset:0 sc1
    v_mfma_f32_32x32x16_bf16 v[80:95], v[144:147], v[212:215], v[80:95]
    buffer_load_dwordx4 v[140:143], v2, s[44:47], s57 offen offset:1024 sc1
    v_mfma_f32_32x32x16_bf16 v[96:111], v[148:151], v[208:211], v[96:111]
    buffer_load_dwordx4 v[200:203], v2, s[44:47], s58 offen offset:0 sc1
    v_mfma_f32_32x32x16_bf16 v[112:127], v[148:151], v[212:215], v[112:127]
    buffer_load_dwordx4 v[204:207], v2, s[44:47], s58 offen offset:1024 sc1
    v_mfma_f32_32x32x16_bf16 v[64:79], v[152:155], v[216:219], v[64:79]
    v_mfma_f32_32x32x16_bf16 v[80:95], v[152:155], v[220:223], v[80:95]
    v_mfma_f32_32x32x16_bf16 v[96:111], v[156:159], v[216:219], v[96:111]
    v_mfma_f32_32x32x16_bf16 v[112:127], v[156:159], v[220:223], v[112:127]
    v_mfma_f32_32x32x16_bf16 v[64:79], v[160:163], v[224:227], v[64:79]
    buffer_load_dwordx4 v[144:147], v2, s[44:47], s59 offen offset:0 sc1
    v_mfma_f32_32x32x16_bf16 v[80:95], v[160:163], v[228:231], v[80:95]
    buffer_load_dwordx4 v[148:151], v2, s[44:47], s59 offen offset:1024 sc1
    v_mfma_f32_32x32x16_bf16 v[96:111], v[164:167], v[224:227], v[96:111]
    v_mfma_f32_32x32x16_bf16 v[112:127], v[164:167], v[228:231], v[112:127]
    v_mfma_f32_32x32x16_bf16 v[64:79], v[168:171], v[48:51], v[64:79]
    s_waitcnt vmcnt(6)
    v_mov_b32 v13, 4
    s_mov_b64 exec, 1
    s_cmp_eq_u32 s82, 0
    s_cbranch_scc1 L_far_51
    buffer_store_dword v13, v26, s[44:47], s78 offen
    s_branch L_md_52
L_far_51:
    buffer_store_dword v13, v26, s[44:47], s78 offen sc1
L_md_52:
    s_mov_b64 exec, -1
    v_mfma_f32_32x32x16_bf16 v[80:95], v[168:171], v[52:55], v[80:95]
    buffer_load_dwordx4 v[208:211], v2, s[44:47], s54 offen offset:2048 sc1
    v_mfma_f32_32x32x16_bf16 v[96:111], v[172:175], v[48:51], v[96:111]
    buffer_load_dwordx4 v[212:215], v2, s[44:47], s54 offen offset:3072 sc1
    v_mfma_f32_32x32x16_bf16 v[112:127], v[172:175], v[52:55], v[112:127]
    v_mfma_f32_32x32x16_bf16 v[64:79], v[176:179], v[56:59], v[64:79]
    s_mov_b64 exec, 0x7f
    buffer_load_dword v19, v29, s[44:47], s78 offen sc1
    s_mov_b64 exec, -1
    v_mfma_f32_32x32x16_bf16 v[80:95], v[176:179], v[60:63], v[80:95]
    buffer_load_dwordx4 v[152:155], v2, s[44:47], s55 offen offset:2048 sc1
    v_mfma_f32_32x32x16_bf16 v[96:111], v[180:183], v[56:59], v[96:111]
    buffer_load_dwordx4 v[156:159], v2, s[44:47], s55 offen offset:3072 sc1
    v_mfma_f32_32x32x16_bf16 v[112:127], v[180:183], v[60:63], v[112:127]
    v_mfma_f32_32x32x16_bf16 v[64:79], v[184:187], v[128:131], v[64:79]
    buffer_load_dwordx4 v[216:219], v2, s[44:47], s56 offen offset:2048 sc1
    v_mfma_f32_32x32x16_bf16 v[80:95], v[184:187], v[132:135], v[80:95]
    buffer_load_dwordx4 v[220:223], v2, s[44:47], s56 offen offset:3072 sc1
    v_mfma_f32_32x32x16_bf16 v[96:111], v[188:191], v[128:131], v[96:111]
    v_mfma_f32_32x32x16_bf16 v[112:127], v[188:191], v[132:135], v[112:127]
    s_waitcnt vmcnt(12)
    v_mfma_f32_32x32x16_bf16 v[64:79], v[192:195], v[136:139], v[64:79]
    ds_read_b64_tr_b16 v[32:33], v27 offset:16384
    ds_read_b64_tr_b16 v[34:35], v27 offset:17408
    s_waitcnt vmcnt(4)
    s_mov_b64 exec, 0x7f
    v_cmp_gt_u32 vcc, 3, v19
    s_mov_b64 exec, -1
    s_add_u32 s67, s78, 0
    s_cbranch_vccz L_ok_53
    s_mov_b32 exec_lo, 0x7f
    s_mov_b32 exec_hi, 0
    s_mov_b32 s70, 0
L_poll_54:
    buffer_load_dword v19, v29, s[44:47], s67 offen sc1
    s_add_u32 s70, s70, 1
    s_cmp_gt_u32 s70, 400000
    s_cbranch_scc1 L_END
    s_waitcnt vmcnt(0)
    v_cmp_le_u32 vcc, 3, v19
    s_nop 1
    s_cmp_eq_u64 vcc, exec
    s_cbranch_scc1 L_poll_54_ok
    s_branch L_poll_54
L_poll_54_ok:
    s_mov_b64 exec, -1
L_ok_53:
    buffer_load_dwordx4 v[160:163], v2, s[44:47], s57 offen offset:2048 sc1
    v_mfma_f32_32x32x16_bf16 v[80:95], v[192:195], v[140:143], v[80:95]
    ds_read_b64_tr_b16 v[36:37], v28 offset:16384
    ds_read_b64_tr_b16 v[38:39], v28 offset:17408
    buffer_load_dwordx4 v[164:167], v2, s[44:47], s57 offen offset:3072 sc1
    v_mfma_f32_32x32x16_bf16 v[96:111], v[196:199], v[136:139], v[96:111]
    buffer_load_dwordx4 v[168:171], v2, s[44:47], s58 offen offset:2048 sc1
    v_mfma_f32_32x32x16_bf16 v[112:127], v[196:199], v[140:143], v[112:127]
    buffer_load_dwordx4 v[172:175], v2, s[44:47], s58 offen offset:3072 sc1
    s_waitcnt lgkmcnt(0)
    v_mfma_f32_32x32x16_bf16 v[64:79], v[32:35], v[200:203], v[64:79]
    ds_read_b64_tr_b16 v[40:41], v27 offset:18432
    ds_read_b64_tr_b16 v[42:43], v27 offset:19456
    s_add_u32 m0, s74, 16384
    s_add_u32 s91, s52, 28672
    buffer_load_dwordx4 v11, s[32:35], s91 offen lds
    v_mfma_f32_32x32x16_bf16 v[80:95], v[32:35], v[204:207], v[80:95]
    ds_read_b64_tr_b16 v[44:45], v28 offset:18432
    ds_read_b64_tr_b16 v[46:47], v28 offset:19456
    s_add_u32 m0, s74, 17408
    s_add_u32 s91, s52, 35840
    buffer_load_dwordx4 v11, s[32:35], s91 offen lds
    v_mfma_f32_32x32x16_bf16 v[96:111], v[36:39], v[200:203], v[96:111]
    v_mfma_f32_32x32x16_bf16 v[112:127], v[36:39], v[204:207], v[112:127]
    s_waitcnt lgkmcnt(0)
    v_mfma_f32_32x32x16_bf16 v[64:79], v[40:43], v[144:147], v[64:79]
    ds_read_b64_tr_b16 v[32:33], v27 offset:20480
    ds_read_b64_tr_b16 v[34:35], v27 offset:21504
    buffer_load_dwordx4 v[48:51], v2, s[44:47], s59 offen offset:2048 sc1
    v_mfma_f32_32x32x16_bf16 v[80:95], v[40:43], v[148:151], v[80:95]
    ds_read_b64_tr_b16 v[36:37], v28 offset:20480
    ds_read_b64_tr_b16 v[38:39], v28 offset:21504
    buffer_load_dwordx4 v[52:55], v2, s[44:47], s59 offen offset:3072 sc1
    v_mfma_f32_32x32x16_bf16 v[96:111], v[44:47], v[144:147], v[96:111]
    s_add_u32 m0, s74, 18432
    s_add_u32 s91, s53, 28672
    buffer_load_dwordx4 v11, s[32:35], s91 offen lds
    v_mfma_f32_32x32x16_bf16 v[112:127], v[44:47], v[148:151], v[112:127]
    s_add_u32 m0, s74, 19456
    s_add_u32 s91, s53, 35840
    buffer_load_dwordx4 v11, s[32:35], s91 offen lds
    s_waitcnt lgkmcnt(0)
    v_mfma_f32_32x32x16_bf16 v[64:79], v[32:35], v[208:211], v[64:79]
    ds_read_b64_tr_b16 v[40:41], v27 offset:22528
    ds_read_b64_tr_b16 v[42:43], v27 offset:23552
    buffer_load_dwordx4 v[224:227], v10, s[44:47], s54 offen offset:0 sc1
    v_mfma_f32_32x32x16_bf16 v[80:95], v[32:35], v[212:215], v[80:95]
    ds_read_b64_tr_b16 v[44:45], v28 offset:22528
    ds_read_b64_tr_b16 v[46:47], v28 offset:23552
    buffer_load_dwordx4 v[228:231], v10, s[44:47], s54 offen offset:1024 sc1
    v_mfma_f32_32x32x16_bf16 v[96:111], v[36:39], v[208:211], v[96:111]
    s_add_u32 m0, s74, 20480
    s_add_u32 s91, s48, 43008
    buffer_load_dwordx4 v11, s[32:35], s91 offen lds
    v_mfma_f32_32x32x16_bf16 v[112:127], v[36:39], v[212:215], v[112:127]
    s_add_u32 m0, s74, 21504
    s_add_u32 s91, s48, 50176
    buffer_load_dwordx4 v11, s[32:35], s91 offen lds
    s_waitcnt vmcnt(16) lgkmcnt(0)
    v_mfma_f32_32x32x16_bf16 v[64:79], v[40:43], v[152:155], v[64:79]
    ds_read_b64_tr_b16 v[32:33], v27 offset:0
    ds_read_b64_tr_b16 v[34:35], v27 offset:1024
    s_mov_b64 exec, 0x7f
    buffer_load_dword v19, v29, s[44:47], s78 offen sc1
    s_mov_b64 exec, -1
    v_mfma_f32_32x32x16_bf16 v[80:95], v[40:43], v[156:159], v[80:95]
    ds_read_b64_tr_b16 v[36:37], v28 offset:0
    ds_read_b64_tr_b16 v[38:39], v28 offset:1024
    buffer_load_dwordx4 v[176:179], v10, s[44:47], s55 offen offset:0 sc1
    v_mfma_f32_32x32x16_bf16 v[96:111], v[44:47], v[152:155], v[96:111]
    buffer_load_dwordx4 v[180:183], v10, s[44:47], s55 offen offset:1024 sc1
    v_mfma_f32_32x32x16_bf16 v[112:127], v[44:47], v[156:159], v[112:127]
    s_add_u32 m0, s74, 22528
    s_add_u32 s91, s49, 43008
    buffer_load_dwordx4 v11, s[32:35], s91 offen lds
    s_waitcnt vmcnt(18) lgkmcnt(0)
    v_mfma_f32_32x32x16_bf16 v[64:79], v[32:35], v[216:219], v[64:79]
    ds_read_b64_tr_b16 v[40:41], v27 offset:2048
    ds_read_b64_tr_b16 v[42:43], v27 offset:3072
    s_add_u32 m0, s74, 23552
    s_add_u32 s91, s49, 50176
    buffer_load_dwordx4 v11, s[32:35], s91 offen lds
    v_mfma_f32_32x32x16_bf16 v[80:95], v[32:35], v[220:223], v[80:95]
    ds_read_b64_tr_b16 v[44:45], v28 offset:2048
    ds_read_b64_tr_b16 v[46:47], v28 offset:3072
    buffer_load_dwordx4 v[56:59], v10, s[44:47], s56 offen offset:0 sc1
    v_mfma_f32_32x32x16_bf16 v[96:111], v[36:39], v[216:219], v[96:111]
    buffer_load_dwordx4 v[60:63], v10, s[44:47], s56 offen offset:1024 sc1
    v_mfma_f32_32x32x16_bf16 v[112:127], v[36:39], v[220:223], v[112:127]
    s_add_u32 m0, s74, 0
    s_add_u32 s91, s50, 43008
    buffer_load_dwordx4 v11, s[32:35], s91 offen lds
    s_waitcnt vmcnt(20) lgkmcnt(0)
    v_mfma_f32_32x32x16_bf16 v[64:79], v[40:43], v[160:163], v[64:79]
    ds_read_b64_tr_b16 v[32:33], v27 offset:4096
    ds_read_b64_tr_b16 v[34:35], v27 offset:5120
    s_waitcnt vmcnt(7)
    s_mov_b64 exec, 0x7f
    v_cmp_gt_u32 vcc, 4, v19
    s_mov_b64 exec, -1
    s_add_u32 s67, s78, 0
    s_cbranch_vccz L_ok_55
    s_mov_b32 exec_lo, 0x7f
    s_mov_b32 exec_hi, 0
    s_mov_b32 s70, 0
L_poll_56:
    buffer_load_dword v19, v29, s[44:47], s67 offen sc1
    s_add_u32 s70, s70, 1
    s_cmp_gt_u32 s70, 400000
    s_cbranch_scc1 L_END
    s_waitcnt vmcnt(0)
    v_cmp_le_u32 vcc, 4, v19
    s_nop 1
    s_cmp_eq_u64 vcc, exec
    s_cbranch_scc1 L_poll_56_ok
    s_branch L_poll_56
L_poll_56_ok:
    s_mov_b64 exec, -1
L_ok_55:
    s_add_u32 m0, s74, 1024
    s_add_u32 s91, s50, 50176
    buffer_load_dwordx4 v11, s[32:35], s91 offen lds
    v_mfma_f32_32x32x16_bf16 v[80:95], v[40:43], v[164:167], v[80:95]
    ds_read_b64_tr_b16 v[36:37], v28 offset:4096
    ds_read_b64_tr_b16 v[38:39], v28 offset:5120
    buffer_load_dwordx4 v[184:187], v10, s[44:47], s57 offen offset:0 sc1
    v_mfma_f32_32x32x16_bf16 v[96:111], v[44:47], v[160:163], v[96:111]
    buffer_load_dwordx4 v[188:191], v10, s[44:47], s57 offen offset:1024 sc1
    s_add_u32 m0, s74, 2048
    s_add_u32 s91, s51, 43008
    buffer_load_dwordx4 v11, s[32:35], s91 offen lds
    v_mfma_f32_32x32x16_bf16 v[112:127], v[44:47], v[164:167], v[112:127]
    s_add_u32 m0, s74, 3072
    s_add_u32 s91, s51, 50176
    buffer_load_dwordx4 v11, s[32:35], s91 offen lds
    buffer_load_dwordx4 v[128:131], v10, s[44:47], s58 offen offset:0 sc1
    s_waitcnt lgkmcnt(0)
    s_setprio 2
    v_mfma_f32_32x32x16_bf16 v[64:79], v[32:35], v[168:171], v[64:79]
    ds_read_b64_tr_b16 v[40:41], v27 offset:6144
    ds_read_b64_tr_b16 v[42:43], v27 offset:7168
    buffer_load_dwordx4 v[132:135], v10, s[44:47], s58 offen offset:1024 sc1
    v_mfma_f32_32x32x16_bf16 v[80:95], v[32:35], v[172:175], v[80:95]
    ds_read_b64_tr_b16 v[44:45], v28 offset:6144
    ds_read_b64_tr_b16 v[46:47], v28 offset:7168
    s_add_u32 m0, s74, 4096
    s_add_u32 s91, s52, 43008
    buffer_load_dwordx4 v11, s[32:35], s91 offen lds
    v_mfma_f32_32x32x16_bf16 v[96:111], v[36:39], v[168:171], v[96:111]
    s_add_u32 m0, s74, 5120
    s_add_u32 s91, s52, 50176
    buffer_load_dwordx4 v11, s[32:35], s91 offen lds
    v_mfma_f32_32x32x16_bf16 v[112:127], v[36:39], v[172:175], v[112:127]
    s_waitcnt lgkmcnt(0)
    v_mfma_f32_32x32x16_bf16 v[64:79], v[40:43], v[48:51], v[64:79]
    ds_read_b64_tr_b16 v[32:33], v27 offset:8192
    ds_read_b64_tr_b16 v[34:35], v27 offset:9216
    buffer_load_dwordx4 v[192:195], v10, s[44:47], s59 offen offset:0 sc1
    v_mfma_f32_32x32x16_bf16 v[80:95], v[40:43], v[52:55], v[80:95]
    ds_read_b64_tr_b16 v[36:37], v28 offset:8192
    ds_read_b64_tr_b16 v[38:39], v28 offset:9216
    buffer_load_dwordx4 v[196:199], v10, s[44:47], s59 offen offset:1024 sc1
    v_mfma_f32_32x32x16_bf16 v[96:111], v[44:47], v[48:51], v[96:111]
    s_add_u32 m0, s74, 6144
    s_add_u32 s91, s53, 43008
    buffer_load_dwordx4 v11, s[32:35], s91 offen lds
    v_mfma_f32_32x32x16_bf16 v[112:127], v[44:47], v[52:55], v[112:127]
    s_add_u32 m0, s74, 7168
    s_add_u32 s91, s53, 50176
    buffer_load_dwordx4 v11, s[32:35], s91 offen lds
    s_waitcnt lgkmcnt(0)
    v_mfma_f32_32x32x16_bf16 v[64:79], v[32:35], v[224:227], v[64:79]
    ds_read_b64_tr_b16 v[40:41], v27 offset:10240
    ds_read_b64_tr_b16 v[42:43], v27 offset:11264
    buffer_load_dwordx4 v[136:139], v10, s[44:47], s54 offen offset:2048 sc1
    v_mfma_f32_32x32x16_bf16 v[80:95], v[32:35], v[228:231], v[80:95]
    ds_read_b64_tr_b16 v[44:45], v28 offset:10240
    ds_read_b64_tr_b16 v[46:47], v28 offset:11264
    buffer_load_dwordx4 v[140:143], v10, s[44:47], s54 offen offset:3072 sc1
    v_mfma_f32_32x32x16_bf16 v[96:111], v[36:39], v[224:227], v[96:111]
    v_mfma_f32_32x32x16_bf16 v[112:127], v[36:39], v[228:231], v[112:127]
    s_waitcnt vmcnt(20) lgkmcnt(0)
    v_mfma_f32_32x32x16_bf16 v[64:79], v[40:43], v[176:179], v[64:79]
    ds_read_b64_tr_b16 v[32:33], v27 offset:12288
    ds_read_b64_tr_b16 v[34:35], v27 offset:13312
    buffer_load_dwordx4 v[200:203], v10, s[44:47], s55 offen offset:2048 sc1
    v_mfma_f32_32x32x16_bf16 v[80:95], v[40:43], v[180:183], v[80:95]
    ds_read_b64_tr_b16 v[36:37], v28 offset:12288
    ds_read_b64_tr_b16 v[38:39], v28 offset:13312
    buffer_load_dwordx4 v[204:207], v10, s[44:47], s55 offen offset:3072 sc1
    v_mfma_f32_32x32x16_bf16 v[96:111], v[44:47], v[176:179], v[96:111]
    v_mfma_f32_32x32x16_bf16 v[112:127], v[44:47], v[180:183], v[112:127]
    s_waitcnt vmcnt(18) lgkmcnt(0)
    v_mfma_f32_32x32x16_bf16 v[64:79], v[32:35], v[56:59], v[64:79]
    ds_read_b64_tr_b16 v[40:41], v27 offset:14336
    ds_read_b64_tr_b16 v[42:43], v27 offset:15360
    buffer_load_dwordx4 v[144:147], v10, s[44:47], s56 offen offset:2048 sc1
    v_mfma_f32_32x32x16_bf16 v[80:95], v[32:35], v[60:63], v[80:95]
    ds_read_b64_tr_b16 v[44:45], v28 offset:14336
    ds_read_b64_tr_b16 v[46:47], v28 offset:15360
    buffer_load_dwordx4 v[148:151], v10, s[44:47], s56 offen offset:3072 sc1
    v_mfma_f32_32x32x16_bf16 v[96:111], v[36:39], v[56:59], v[96:111]
    v_mfma_f32_32x32x16_bf16 v[112:127], v[36:39], v[60:63], v[112:127]
    s_waitcnt vmcnt(16) lgkmcnt(0)
    v_mfma_f32_32x32x16_bf16 v[64:79], v[40:43], v[184:187], v[64:79]
    ds_read_b64_tr_b16 v[32:33], v27 offset:16384
    ds_read_b64_tr_b16 v[34:35], v27 offset:17408
    buffer_load_dwordx4 v[208:211], v10, s[44:47], s57 offen offset:2048 sc1
    v_mfma_f32_32x32x16_bf16 v[80:95], v[40:43], v[188:191], v[80:95]
    ds_read_b64_tr_b16 v[36:37], v28 offset:16384
    ds_read_b64_tr_b16 v[38:39], v28 offset:17408
    buffer_load_dwordx4 v[212:215], v10, s[44:47], s57 offen offset:3072 sc1
    v_mfma_f32_32x32x16_bf16 v[96:111], v[44:47], v[184:187], v[96:111]
    v_mfma_f32_32x32x16_bf16 v[112:127], v[44:47], v[188:191], v[112:127]
    s_waitcnt vmcnt(14) lgkmcnt(0)
    v_mfma_f32_32x32x16_bf16 v[64:79], v[32:35], v[128:131], v[64:79]
    ds_read_b64_tr_b16 v[40:41], v27 offset:18432
    ds_read_b64_tr_b16 v[42:43], v27 offset:19456
    buffer_load_dwordx4 v[152:155], v10, s[44:47], s58 offen offset:2048 sc1
    v_mfma_f32_32x32x16_bf16 v[80:95], v[32:35], v[132:135], v[80:95]
    ds_read_b64_tr_b16 v[44:45], v28 offset:18432
    ds_read_b64_tr_b16 v[46:47], v28 offset:19456
    buffer_load_dwordx4 v[156:159], v10, s[44:47], s58 offen offset:3072 sc1
    v_mfma_f32_32x32x16_bf16 v[96:111], v[36:39], v[128:131], v[96:111]
    v_mfma_f32_32x32x16_bf16 v[112:127], v[36:39], v[132:135], v[112:127]
    s_waitcnt vmcnt(12) lgkmcnt(0)
    v_mfma_f32_32x32x16_bf16 v[64:79], v[40:43], v[192:195], v[64:79]
    ds_read_b64_tr_b16 v[32:33], v27 offset:20480
    ds_read_b64_tr_b16 v[34:35], v27 offset:21504
    buffer_load_dwordx4 v[216:219], v10, s[44:47], s59 offen offset:2048 sc1
    v_mfma_f32_32x32x16_bf16 v[80:95], v[40:43], v[196:199], v[80:95]
    ds_read_b64_tr_b16 v[36:37], v28 offset:20480
    ds_read_b64_tr_b16 v[38:39], v28 offset:21504
    buffer_load_dwordx4 v[220:223], v10, s[44:47], s59 offen offset:3072 sc1
    v_mfma_f32_32x32x16_bf16 v[96:111], v[44:47], v[192:195], v[96:111]
    v_mfma_f32_32x32x16_bf16 v[112:127], v[44:47], v[196:199], v[112:127]
    s_waitcnt vmcnt(10) lgkmcnt(0)
    v_mfma_f32_32x32x16_bf16 v[64:79], v[32:35], v[136:139], v[64:79]
    ds_read_b64_tr_b16 v[40:41], v27 offset:22528
    ds_read_b64_tr_b16 v[42:43], v27 offset:23552
    v_mfma_f32_32x32x16_bf16 v[80:95], v[32:35], v[140:143], v[80:95]
    ds_read_b64_tr_b16 v[44:45], v28 offset:22528
    ds_read_b64_tr_b16 v[46:47], v28 offset:23552
    v_mfma_f32_32x32x16_bf16 v[96:111], v[36:39], v[136:139], v[96:111]
    v_mfma_f32_32x32x16_bf16 v[112:127], v[36:39], v[140:143], v[112:127]
    s_waitcnt vmcnt(8) lgkmcnt(0)
    v_mfma_f32_32x32x16_bf16 v[64:79], v[40:43], v[200:203], v[64:79]
    ds_read_b64_tr_b16 v[32:33], v27 offset:0
    ds_read_b64_tr_b16 v[34:35], v27 offset:1024
    v_mfma_f32_32x32x16_bf16 v[80:95], v[40:43], v[204:207], v[80:95]
    ds_read_b64_tr_b16 v[36:37], v28 offset:0
    ds_read_b64_tr_b16 v[38:39], v28 offset:1024
    v_mfma_f32_32x32x16_bf16 v[96:111], v[44:47], v[200:203], v[96:111]
    v_mfma_f32_32x32x16_bf16 v[112:127], v[44:47], v[204:207], v[112:127]
    s_waitcnt vmcnt(6) lgkmcnt(0)
    v_mfma_f32_32x32x16_bf16 v[64:79], v[32:35], v[144:147], v[64:79]
    ds_read_b64_tr_b16 v[40:41], v27 offset:2048
    ds_read_b64_tr_b16 v[42:43], v27 offset:3072
    v_mfma_f32_32x32x16_bf16 v[80:95], v[32:35], v[148:151], v[80:95]
    ds_read_b64_tr_b16 v[44:45], v28 offset:2048
    ds_read_b64_tr_b16 v[46:47], v28 offset:3072
    v_mfma_f32_32x32x16_bf16 v[96:111], v[36:39], v[144:147], v[96:111]
    v_mfma_f32_32x32x16_bf16 v[112:127], v[36:39], v[148:151], v[112:127]
    s_waitcnt vmcnt(4) lgkmcnt(0)
    v_mfma_f32_32x32x16_bf16 v[64:79], v[40:43], v[208:211], v[64:79]
    ds_read_b64_tr_b16 v[32:33], v27 offset:4096
    ds_read_b64_tr_b16 v[34:35], v27 offset:5120
    v_mfma_f32_32x32x16_bf16 v[80:95], v[40:43], v[212:215], v[80:95]
    ds_read_b64_tr_b16 v[36:37], v28 offset:4096
    ds_read_b64_tr_b16 v[38:39], v28 offset:5120
    v_mfma_f32_32x32x16_bf16 v[96:111], v[44:47], v[208:211], v[96:111]
    v_mfma_f32_32x32x16_bf16 v[112:127], v[44:47], v[212:215], v[112:127]
    s_waitcnt vmcnt(2) lgkmcnt(0)
    v_mfma_f32_32x32x16_bf16 v[64:79], v[32:35], v[152:155], v[64:79]
    ds_read_b64_tr_b16 v[40:41], v27 offset:6144
    ds_read_b64_tr_b16 v[42:43], v27 offset:7168
    v_mfma_f32_32x32x16_bf16 v[80:95], v[32:35], v[156:159], v[80:95]
    ds_read_b64_tr_b16 v[44:45], v28 offset:6144
    ds_read_b64_tr_b16 v[46:47], v28 offset:7168
    v_mfma_f32_32x32x16_bf16 v[96:111], v[36:39], v[152:155], v[96:111]
    v_mfma_f32_32x32x16_bf16 v[112:127], v[36:39], v[156:159], v[112:127]
    s_waitcnt vmcnt(0) lgkmcnt(0)
    v_mfma_f32_32x32x16_bf16 v[64:79], v[40:43], v[216:219], v[64:79]
    v_mfma_f32_32x32x16_bf16 v[80:95], v[40:43], v[220:223], v[80:95]
    v_mfma_f32_32x32x16_bf16 v[96:111], v[44:47], v[216:219], v[96:111]
    v_mfma_f32_32x32x16_bf16 v[112:127], v[44:47], v[220:223], v[112:127]
    v_add_u32 v13, s74, v2
    s_nop 9
L_gr_57:
    s_cmp_lg_u32 s61, 0
    s_cbranch_scc1 L_gr_58
    ds_write_b128 v13, v[96:99] offset:4096
    ds_write_b128 v13, v[100:103] offset:5120
    ds_write_b128 v13, v[104:107] offset:6144
    ds_write_b128 v13, v[108:111] offset:7168
    ds_write_b128 v13, v[80:83] offset:8192
    ds_write_b128 v13, v[84:87] offset:9216
    ds_write_b128 v13, v[88:91] offset:10240
    ds_write_b128 v13, v[92:95] offset:11264
    ds_write_b128 v13, v[112:115] offset:12288
    ds_write_b128 v13, v[116:119] offset:13312
    ds_write_b128 v13, v[120:123] offset:14336
    ds_write_b128 v13, v[124:127] offset:15360
    v_mov_b32 v136, v64
    v_mov_b32 v137, v65
    v_mov_b32 v138, v66
    v_mov_b32 v139, v67
    v_mov_b32 v140, v68
    v_mov_b32 v141, v69
    v_mov_b32 v142, v70
    v_mov_b32 v143, v71
    v_mov_b32 v144, v72
    v_mov_b32 v145, v73
    v_mov_b32 v146, v74
    v_mov_b32 v147, v75
    v_mov_b32 v148, v76
    v_mov_b32 v149, v77
    v_mov_b32 v150, v78
    v_mov_b32 v151, v79
    v_mov_b32 v16, v30
    s_branch L_grd_61
L_gr_58:
    s_cmp_lg_u32 s61, 1
    s_cbranch_scc1 L_gr_59
    ds_write_b128 v13, v[64:67] offset:0
    ds_write_b128 v13, v[68:71] offset:1024
    ds_write_b128 v13, v[72:75] offset:2048
    ds_write_b128 v13, v[76:79] offset:3072
    ds_write_b128 v13, v[80:83] offset:8192
    ds_write_b128 v13, v[84:87] offset:9216
    ds_write_b128 v13, v[88:91] offset:10240
    ds_write_b128 v13, v[92:95] offset:11264
    ds_write_b128 v13, v[112:115] offset:12288
    ds_write_b128 v13, v[116:119] offset:13312
    ds_write_b128 v13, v[120:123] offset:14336
    ds_write_b128 v13, v[124:127] offset:15360
    v_mov_b32 v136, v96
    v_mov_b32 v137, v97
    v_mov_b32 v138, v98
    v_mov_b32 v139, v99
    v_mov_b32 v140, v100
    v_mov_b32 v141, v101
    v_mov_b32 v142, v102
    v_mov_b32 v143, v103
    v_mov_b32 v144, v104
    v_mov_b32 v145, v105
    v_mov_b32 v146, v106
    v_mov_b32 v147, v107
    v_mov_b32 v148, v108
    v_mov_b32 v149, v109
    v_mov_b32 v150, v110
    v_mov_b32 v151, v111
    v_mov_b32 v16, v30
    s_branch L_grd_61
L_gr_59:
    s_cmp_lg_u32 s61, 2
    s_cbranch_scc1 L_gr_60
    ds_write_b128 v13, v[64:67] offset:0
    ds_write_b128 v13, v[68:71] offset:1024
    ds_write_b128 v13, v[72:75] offset:2048
    ds_write_b128 v13, v[76:79] offset:3072
    ds_write_b128 v13, v[96:99] offset:4096
    ds_write_b128 v13, v[100:103] offset:5120
    ds_write_b128 v13, v[104:107] offset:6144
    ds_write_b128 v13, v[108:111] offset:7168
    ds_write_b128 v13, v[112:115] offset:12288
    ds_write_b128 v13, v[116:119] offset:13312
    ds_write_b128 v13, v[120:123] offset:14336
    ds_write_b128 v13, v[124:127] offset:15360
    v_mov_b32 v136, v80
    v_mov_b32 v137, v81
    v_mov_b32 v138, v82
    v_mov_b32 v139, v83
    v_mov_b32 v140, v84
    v_mov_b32 v141, v85
    v_mov_b32 v142, v86
    v_mov_b32 v143, v87
    v_mov_b32 v144, v88
    v_mov_b32 v145, v89
    v_mov_b32 v146, v90
    v_mov_b32 v147, v91
    v_mov_b32 v148, v92
    v_mov_b32 v149, v93
    v_mov_b32 v150, v94
    v_mov_b32 v151, v95
    v_mov_b32 v16, v31
    s_branch L_grd_61
L_gr_60:
    ds_write_b128 v13, v[64:67] offset:0
    ds_write_b128 v13, v[68:71] offset:1024
    ds_write_b128 v13, v[72:75] offset:2048
    ds_write_b128 v13, v[76:79] offset:3072
    ds_write_b128 v13, v[96:99] offset:4096
    ds_write_b128 v13, v[100:103] offset:5120
    ds_write_b128 v13, v[104:107] offset:6144
    ds_write_b128 v13, v[108:111] offset:7168
    ds_write_b128 v13, v[80:83] offset:8192
    ds_write_b128 v13, v[84:87] offset:9216
    ds_write_b128 v13, v[88:91] offset:10240
    ds_write_b128 v13, v[92:95] offset:11264
    v_mov_b32 v136, v112
    v_mov_b32 v137, v113
    v_mov_b32 v138, v114
    v_mov_b32 v139, v115
    v_mov_b32 v140, v116
    v_mov_b32 v141, v117
    v_mov_b32 v142, v118
    v_mov_b32 v143, v119
    v_mov_b32 v144, v120
    v_mov_b32 v145, v121
    v_mov_b32 v146, v122
    v_mov_b32 v147, v123
    v_mov_b32 v148, v124
    v_mov_b32 v149, v125
    v_mov_b32 v150, v126
    v_mov_b32 v151, v127
    v_mov_b32 v16, v31
L_grd_61:
    s_mov_b64 exec, 1
    ds_add_u32 v18, v17 offset:0
    s_mov_b64 exec, -1
    s_add_u32 s65, s61, 1
    s_and_b32 s65, s65, 3
    s_mul_i32 s65, s65, 24576
    s_lshl_b32 s66, s61, 12
    s_add_u32 s65, s65, s66
    s_add_u32 s65, s65, 57344
    v_add_u32 v24, s65, v2
    s_add_u32 s65, s61, 2
    s_and_b32 s65, s65, 3
    s_mul_i32 s65, s65, 24576
    s_lshl_b32 s66, s61, 12
    s_add_u32 s65, s65, s66
    s_add_u32 s65, s65, 57344
    v_add_u32 v25, s65, v2
    s_add_u32 s65, s61, 3
    s_and_b32 s65, s65, 3
    s_mul_i32 s65, s65, 24576
    s_lshl_b32 s66, s61, 12
    s_add_u32 s65, s65, s66
    s_add_u32 s65, s65, 57344
    v_add_u32 v26, s65, v2
    v_lshlrev_b32 v152, 16, v232
    v_and_b32 v153, 0xffff0000, v232
    v_lshlrev_b32 v154, 16, v233
    v_and_b32 v155, 0xffff0000, v233
    v_lshlrev_b32 v156, 16, v234
    v_and_b32 v157, 0xffff0000, v234
    v_lshlrev_b32 v158, 16, v235
    v_and_b32 v159, 0xffff0000, v235
    v_lshlrev_b32 v160, 16, v236
    v_and_b32 v161, 0xffff0000, v236
    v_lshlrev_b32 v162, 16, v237
    v_and_b32 v163, 0xffff0000, v237
    v_lshlrev_b32 v164, 16, v238
    v_and_b32 v165, 0xffff0000, v238
    v_lshlrev_b32 v166, 16, v239
    v_and_b32 v167, 0xffff0000, v239
    s_mov_b32 s70, 0
L_lw_62:
    ds_read_b32 v15, v18 offset:0
    s_add_u32 s70, s70, 1
    s_cmp_gt_u32 s70, 3200000
    s_cbranch_scc1 L_END
    s_waitcnt lgkmcnt(0)
    v_readfirstlane_b32 s68, v15
    s_nop 1
    s_cmp_ge_u32 s68, 16
    s_cbranch_scc0 L_lw_62
    ds_read_b128 v[168:171], v24 offset:0
    ds_read_b128 v[172:175], v24 offset:1024
    ds_read_b128 v[176:179], v24 offset:2048
    ds_read_b128 v[180:183], v24 offset:3072
    ds_read_b128 v[184:187], v25 offset:0
    ds_read_b128 v[188:191], v25 offset:1024
    ds_read_b128 v[192:195], v25 offset:2048
    ds_read_b128 v[196:199], v25 offset:3072
    ds_read_b128 v[200:203], v26 offset:0
    ds_read_b128 v[204:207], v26 offset:1024
    ds_read_b128 v[208:211], v26 offset:2048
    ds_read_b128 v[212:215], v26 offset:3072
    s_waitcnt lgkmcnt(11)
    v_add_f32 v136, v136, v168
    v_add_f32 v137, v137, v169
    v_add_f32 v138, v138, v170
    v_add_f32 v139, v139, v171
    s_waitcnt lgkmcnt(10)
    v_add_f32 v140, v140, v172
    v_add_f32 v141, v141, v173
    v_add_f32 v142, v142, v174
    v_add_f32 v143, v143, v175
    s_waitcnt lgkmcnt(9)
    v_add_f32 v144, v144, v176
    v_add_f32 v145, v145, v177
    v_add_f32 v146, v146, v178
    v_add_f32 v147, v147, v179
    s_waitcnt lgkmcnt(8)
    v_add_f32 v148, v148, v180
    v_add_f32 v149, v149, v181
    v_add_f32 v150, v150, v182
    v_add_f32 v151, v151, v183
    s_waitcnt lgkmcnt(7)
    v_add_f32 v136, v136, v184
    v_add_f32 v137, v137, v185
    v_add_f32 v138, v138, v186
    v_add_f32 v139, v139, v187
    s_waitcnt lgkmcnt(6)
    v_add_f32 v140, v140, v188
    v_add_f32 v141, v141, v189
    v_add_f32 v142, v142, v190
    v_add_f32 v143, v143, v191
    s_waitcnt lgkmcnt(5)
    v_add_f32 v144, v144, v192
    v_add_f32 v145, v145, v193
    v_add_f32 v146, v146, v194
    v_add_f32 v147, v147, v195
    s_waitcnt lgkmcnt(4)
    v_add_f32 v148, v148, v196
    v_add_f32 v149, v149, v197
    v_add_f32 v150, v150, v198
    v_add_f32 v151, v151, v199
    s_waitcnt lgkmcnt(3)
    v_add_f32 v136, v136, v200
    v_add_f32 v137, v137, v201
    v_add_f32 v138, v138, v202
    v_add_f32 v139, v139, v203
    s_waitcnt lgkmcnt(2)
    v_add_f32 v140, v140, v204
    v_add_f32 v141, v141, v205
    v_add_f32 v142, v142, v206
    v_add_f32 v143, v143, v207
    s_waitcnt lgkmcnt(1)
    v_add_f32 v144, v144, v208
    v_add_f32 v145, v145, v209
    v_add_f32 v146, v146, v210
    v_add_f32 v147, v147, v211
    s_waitcnt lgkmcnt(0)
    v_add_f32 v148, v148, v212
    v_add_f32 v149, v149, v213
    v_add_f32 v150, v150, v214
    v_add_f32 v151, v151, v215
    v_fma_f32 v240, v136, v16, v240
    v_fma_f32 v241, v137, v16, v241
    v_fma_f32 v242, v138, v16, v242
    v_fma_f32 v243, v139, v16, v243
    v_fma_f32 v244, v140, v16, v244
    v_fma_f32 v245, v141, v16, v245
    v_fma_f32 v246, v142, v16, v246
    v_fma_f32 v247, v143, v16, v247
    v_fma_f32 v248, v144, v16, v248
    v_fma_f32 v249, v145, v16, v249
    v_fma_f32 v250, v146, v16, v250
    v_fma_f32 v251, v147, v16, v251
    v_fma_f32 v252, v148, v16, v252
    v_fma_f32 v253, v149, v16, v253
    v_fma_f32 v254, v150, v16, v254
    v_fma_f32 v255, v151, v16, v255
    v_mul_f32 v64, 0xbfb8aa3b, v240
    v_mul_f32 v65, 0xbfb8aa3b, v241
    v_mul_f32 v66, 0xbfb8aa3b, v242
    v_mul_f32 v67, 0xbfb8aa3b, v243
    v_mul_f32 v68, 0xbfb8aa3b, v244
    v_mul_f32 v69, 0xbfb8aa3b, v245
    v_mul_f32 v70, 0xbfb8aa3b, v246
    v_mul_f32 v71, 0xbfb8aa3b, v247
    v_mul_f32 v72, 0xbfb8aa3b, v248
    v_mul_f32 v73, 0xbfb8aa3b, v249
    v_mul_f32 v74, 0xbfb8aa3b, v250
    v_mul_f32 v75, 0xbfb8aa3b, v251
    v_mul_f32 v76, 0xbfb8aa3b, v252
    v_mul_f32 v77, 0xbfb8aa3b, v253
    v_mul_f32 v78, 0xbfb8aa3b, v254
    v_mul_f32 v79, 0xbfb8aa3b, v255
    v_exp_f32 v64, v64
    v_exp_f32 v65, v65
    v_exp_f32 v66, v66
    v_exp_f32 v67, v67
    v_exp_f32 v68, v68
    v_exp_f32 v69, v69
    v_exp_f32 v70, v70
    v_exp_f32 v71, v71
    v_exp_f32 v72, v72
    v_exp_f32 v73, v73
    v_exp_f32 v74, v74
    v_exp_f32 v75, v75
    v_exp_f32 v76, v76
    v_exp_f32 v77, v77
    v_exp_f32 v78, v78
    v_exp_f32 v79, v79
    v_add_f32 v64, 1.0, v64
    v_add_f32 v65, 1.0, v65
    v_add_f32 v66, 1.0, v66
    v_add_f32 v67, 1.0, v67
    v_add_f32 v68, 1.0, v68
    v_add_f32 v69, 1.0, v69
    v_add_f32 v70, 1.0, v70
    v_add_f32 v71, 1.0, v71
    v_add_f32 v72, 1.0, v72
    v_add_f32 v73, 1.0, v73
    v_add_f32 v74, 1.0, v74
    v_add_f32 v75, 1.0, v75
    v_add_f32 v76, 1.0, v76
    v_add_f32 v77, 1.0, v77
    v_add_f32 v78, 1.0, v78
    v_add_f32 v79, 1.0, v79
    v_rcp_f32 v64, v64
    v_rcp_f32 v65, v65
    v_rcp_f32 v66, v66
    v_rcp_f32 v67, v67
    v_rcp_f32 v68, v68
    v_rcp_f32 v69, v69
    v_rcp_f32 v70, v70
    v_rcp_f32 v71, v71
    v_rcp_f32 v72, v72
    v_rcp_f32 v73, v73
    v_rcp_f32 v74, v74
    v_rcp_f32 v75, v75
    v_rcp_f32 v76, v76
    v_rcp_f32 v77, v77
    v_rcp_f32 v78, v78
    v_rcp_f32 v79, v79
    v_mul_f32 v240, v240, v64
    v_mul_f32 v241, v241, v65
    v_mul_f32 v242, v242, v66
    v_mul_f32 v243, v243, v67
    v_mul_f32 v244, v244, v68
    v_mul_f32 v245, v245, v69
    v_mul_f32 v246, v246, v70
    v_mul_f32 v247, v247, v71
    v_mul_f32 v248, v248, v72
    v_mul_f32 v249, v249, v73
    v_mul_f32 v250, v250, v74
    v_mul_f32 v251, v251, v75
    v_mul_f32 v252, v252, v76
    v_mul_f32 v253, v253, v77
    v_mul_f32 v254, v254, v78
    v_mul_f32 v255, v255, v79
    s_lshl_b32 s65, s61, 13
    v_add_u32 v13, s65, v2
    v_mul_u32_u24 v14, 896, v3
    v_lshl_add_u32 v14, v4, 4, v14
    s_lshl_b32 s65, s4, 1
    s_add_u32 s65, s65, s62
    s_mul_i32 s65, s65, 28672
    s_lshl_b32 s66, s5, 1
    s_add_u32 s66, s66, s63
    s_lshl_b32 s66, s66, 6
    s_add_u32 s65, s65, s66
    s_mov_b32 s70, 0
L_lw_63:
    ds_read_b32 v15, v18 offset:56
    s_add_u32 s70, s70, 1
    s_cmp_gt_u32 s70, 3200000
    s_cbranch_scc1 L_END
    s_waitcnt lgkmcnt(0)
    v_readfirstlane_b32 s68, v15
    s_nop 1
    s_cmp_ge_u32 s68, 4
    s_cbranch_scc0 L_lw_63
    ds_read_b128 v[32:35], v13 offset:0
    ds_read_b128 v[48:51], v13 offset:4096
    ds_read_b128 v[36:39], v13 offset:1024
    ds_read_b128 v[52:55], v13 offset:5120
    ds_read_b128 v[40:43], v13 offset:2048
    ds_read_b128 v[56:59], v13 offset:6144
    ds_read_b128 v[44:47], v13 offset:3072
    ds_read_b128 v[60:63], v13 offset:7168
    s_waitcnt lgkmcnt(6)
    v_add_f32 v32, v32, v48
    v_add_f32 v33, v33, v49
    v_add_f32 v34, v34, v50
    v_add_f32 v35, v35, v51
    v_fma_f32 v240, v240, v32, v152
    v_fma_f32 v241, v241, v33, v153
    v_fma_f32 v242, v242, v34, v154
    v_fma_f32 v243, v243, v35, v155
    s_waitcnt lgkmcnt(4)
    v_add_f32 v36, v36, v52
    v_add_f32 v37, v37, v53
    v_add_f32 v38, v38, v54
    v_add_f32 v39, v39, v55
    v_fma_f32 v244, v244, v36, v156
    v_fma_f32 v245, v245, v37, v157
    v_fma_f32 v246, v246, v38, v158
    v_fma_f32 v247, v247, v39, v159
    s_waitcnt lgkmcnt(2)
    v_add_f32 v40, v40, v56
    v_add_f32 v41, v41, v57
    v_add_f32 v42, v42, v58
    v_add_f32 v43, v43, v59
    v_fma_f32 v248, v248, v40, v160
    v_fma_f32 v249, v249, v41, v161
    v_fma_f32 v250, v250, v42, v162
    v_fma_f32 v251, v251, v43, v163
    s_waitcnt lgkmcnt(0)
    v_add_f32 v44, v44, v60
    v_add_f32 v45, v45, v61
    v_add_f32 v46, v46, v62
    v_add_f32 v47, v47, v63
    v_fma_f32 v252, v252, v44, v164
    v_fma_f32 v253, v253, v45, v165
    v_fma_f32 v254, v254, v46, v166
    v_fma_f32 v255, v255, v47, v167
    v_cvt_pk_bf16_f32 v64, v240, v241
    v_cvt_pk_bf16_f32 v65, v242, v243
    v_cvt_pk_bf16_f32 v66, v244, v245
    v_cvt_pk_bf16_f32 v67, v246, v247
    v_cvt_pk_bf16_f32 v68, v248, v249
    v_cvt_pk_bf16_f32 v69, v250, v251
    v_cvt_pk_bf16_f32 v70, v252, v253
    v_cvt_pk_bf16_f32 v71, v254, v255
    v_permlane32_swap_b32 v64, v66
    v_permlane32_swap_b32 v65, v67
    v_permlane32_swap_b32 v68, v70
    v_permlane32_swap_b32 v69, v71
    buffer_store_dwordx4 v[64:67], v14, s[36:39], s65 offen nt
    buffer_store_dwordx4 v[68:71], v14, s[36:39], s65 offen offset:32 nt
    s_endpgm
L_g_kv:
    s_mul_i32 s65, s63, 25088
    s_add_u32 s65, s65, 0
    v_add_u32 v9, s65, v10
    s_lshl_b32 s79, s4, 1
    s_add_u32 s79, s79, s62
    s_lshl_b32 s79, s79, 12
    s_add_u32 s79, s79, 524288
    s_cmp_eq_u32 s63, 1
    s_cbranch_scc1 L_g_v
    s_mov_b64 exec, 1
    ds_add_u32 v18, v17 offset:116
    s_mov_b64 exec, -1
    s_mov_b32 s70, 0
L_lw_64:
    ds_read_b32 v15, v18 offset:92
    s_add_u32 s70, s70, 1
    s_cmp_gt_u32 s70, 3200000
    s_cbranch_scc1 L_END
    s_waitcnt lgkmcnt(0)
    v_readfirstlane_b32 s68, v15
    s_nop 1
    s_cmp_ge_u32 s68, 4
    s_cbranch_scc0 L_lw_64
    ds_read_b64_tr_b16 v[64:65], v9 offset:0
    ds_read_b64_tr_b16 v[66:67], v9 offset:224
    ds_read_b64_tr_b16 v[68:69], v9 offset:896
    ds_read_b64_tr_b16 v[70:71], v9 offset:1120
    ds_read_b64_tr_b16 v[72:73], v9 offset:1792
    ds_read_b64_tr_b16 v[74:75], v9 offset:2016
    ds_read_b64_tr_b16 v[76:77], v9 offset:2688
    ds_read_b64_tr_b16 v[78:79], v9 offset:2912
    s_waitcnt lgkmcnt(6)
    v_mfma_f32_32x32x16_bf16 v[96:111], v[64:67], v[32:35], 0
    ds_read_b64_tr_b16 v[80:81], v9 offset:3584
    ds_read_b64_tr_b16 v[82:83], v9 offset:3808
    ds_read_b32 v15, v18 offset:96
    v_mfma_f32_16x16x32_bf16 v[112:115], v[64:67], v[20:23], 0
    s_waitcnt lgkmcnt(6)
    v_mfma_f32_32x32x16_bf16 v[96:111], v[68:71], v[36:39], v[96:111]
    ds_read_b64_tr_b16 v[84:85], v9 offset:4480
    ds_read_b64_tr_b16 v[86:87], v9 offset:4704
    v_mfma_f32_16x16x32_bf16 v[112:115], v[68:71], v[20:23], v[112:115]
    s_waitcnt lgkmcnt(6)
    v_mfma_f32_32x32x16_bf16 v[96:111], v[72:75], v[40:43], v[96:111]
    ds_read_b64_tr_b16 v[88:89], v9 offset:5376
    ds_read_b64_tr_b16 v[90:91], v9 offset:5600
    v_mfma_f32_16x16x32_bf16 v[112:115], v[72:75], v[20:23], v[112:115]
    s_waitcnt lgkmcnt(6)
    v_mfma_f32_32x32x16_bf16 v[96:111], v[76:79], v[44:47], v[96:111]
    ds_read_b64_tr_b16 v[92:93], v9 offset:6272
    ds_read_b64_tr_b16 v[94:95], v9 offset:6496
    v_mfma_f32_16x16x32_bf16 v[112:115], v[76:79], v[20:23], v[112:115]
    s_waitcnt lgkmcnt(6)
    v_mfma_f32_32x32x16_bf16 v[96:111], v[80:83], v[48:51], v[96:111]
    v_readfirstlane_b32 s68, v15
    s_nop 1
    s_cmp_ge_u32 s68, 4
    s_cbranch_scc1 L_sw_65
    s_mov_b32 s70, 0
L_lw_66:
    ds_read_b32 v15, v18 offset:96
    s_add_u32 s70, s70, 1
    s_cmp_gt_u32 s70, 3200000
    s_cbranch_scc1 L_END
    s_waitcnt lgkmcnt(0)
    v_readfirstlane_b32 s68, v15
    s_nop 1
    s_cmp_ge_u32 s68, 4
    s_cbranch_scc0 L_lw_66
L_sw_65:
    ds_read_b64_tr_b16 v[64:65], v9 offset:7168
    ds_read_b64_tr_b16 v[66:67], v9 offset:7392
    ds_read_b128 v[32:35], v8 offset:256
    v_mfma_f32_16x16x32_bf16 v[112:115], v[80:83], v[20:23], v[112:115]
    s_waitcnt lgkmcnt(7)
    v_mfma_f32_32x32x16_bf16 v[96:111], v[84:87], v[52:55], v[96:111]
    ds_read_b64_tr_b16 v[68:69], v9 offset:8064
    ds_read_b64_tr_b16 v[70:71], v9 offset:8288
    ds_read_b128 v[36:39], v8 offset:288
    v_mfma_f32_16x16x32_bf16 v[112:115], v[84:87], v[20:23], v[112:115]
    s_waitcnt lgkmcnt(8)
    v_mfma_f32_32x32x16_bf16 v[96:111], v[88:91], v[56:59], v[96:111]
    ds_read_b64_tr_b16 v[72:73], v9 offset:8960
    ds_read_b64_tr_b16 v[74:75], v9 offset:9184
    ds_read_b128 v[40:43], v8 offset:320
    v_mfma_f32_16x16x32_bf16 v[112:115], v[88:91], v[20:23], v[112:115]
    s_waitcnt lgkmcnt(9)
    v_mfma_f32_32x32x16_bf16 v[96:111], v[92:95], v[60:63], v[96:111]
    ds_read_b64_tr_b16 v[76:77], v9 offset:9856
    ds_read_b64_tr_b16 v[78:79], v9 offset:10080
    ds_read_b128 v[44:47], v8 offset:352
    v_mfma_f32_16x16x32_bf16 v[112:115], v[92:95], v[20:23], v[112:115]
    s_waitcnt lgkmcnt(9)
    v_mfma_f32_32x32x16_bf16 v[96:111], v[64:67], v[32:35], v[96:111]
    ds_read_b64_tr_b16 v[80:81], v9 offset:10752
    ds_read_b64_tr_b16 v[82:83], v9 offset:10976
    ds_read_b128 v[48:51], v8 offset:384
    ds_read_b32 v15, v18 offset:100
    v_mfma_f32_16x16x32_bf16 v[112:115], v[64:67], v[20:23], v[112:115]
    s_mov_b64 exec, 1
    ds_add_u32 v18, v17 offset:108
    s_mov_b64 exec, -1
    s_waitcnt lgkmcnt(9)
    v_mfma_f32_32x32x16_bf16 v[96:111], v[68:71], v[36:39], v[96:111]
    ds_read_b64_tr_b16 v[84:85], v9 offset:11648
    ds_read_b64_tr_b16 v[86:87], v9 offset:11872
    ds_read_b128 v[52:55], v8 offset:416
    v_mfma_f32_16x16x32_bf16 v[112:115], v[68:71], v[20:23], v[112:115]
    s_waitcnt lgkmcnt(9)
    v_mfma_f32_32x32x16_bf16 v[96:111], v[72:75], v[40:43], v[96:111]
    ds_read_b64_tr_b16 v[88:89], v9 offset:12544
    ds_read_b64_tr_b16 v[90:91], v9 offset:12768
    ds_read_b128 v[56:59], v8 offset:448
    v_mfma_f32_16x16x32_bf16 v[112:115], v[72:75], v[20:23], v[112:115]
    s_waitcnt lgkmcnt(9)
    v_mfma_f32_32x32x16_bf16 v[96:111], v[76:79], v[44:47], v[96:111]
    ds_read_b64_tr_b16 v[92:93], v9 offset:13440
    ds_read_b64_tr_b16 v[94:95], v9 offset:13664
    ds_read_b128 v[60:63], v8 offset:480
    v_mfma_f32_16x16x32_bf16 v[112:115], v[76:79], v[20:23], v[112:115]
    s_waitcnt lgkmcnt(9)
    v_mfma_f32_32x32x16_bf16 v[96:111], v[80:83], v[48:51], v[96:111]
    v_readfirstlane_b32 s68, v15
    s_nop 1
    s_cmp_ge_u32 s68, 4
    s_cbranch_scc1 L_sw_67
    s_mov_b32 s70, 0
L_lw_68:
    ds_read_b32 v15, v18 offset:100
    s_add_u32 s70, s70, 1
    s_cmp_gt_u32 s70, 3200000
    s_cbranch_scc1 L_END
    s_waitcnt lgkmcnt(0)
    v_readfirstlane_b32 s68, v15
    s_nop 1
    s_cmp_ge_u32 s68, 4
    s_cbranch_scc0 L_lw_68
L_sw_67:
    ds_read_b64_tr_b16 v[64:65], v9 offset:14336
    ds_read_b64_tr_b16 v[66:67], v9 offset:14560
    ds_read_b128 v[32:35], v8 offset:512
    v_mfma_f32_16x16x32_bf16 v[112:115], v[80:83], v[20:23], v[112:115]
    s_waitcnt lgkmcnt(9)
    v_mfma_f32_32x32x16_bf16 v[96:111], v[84:87], v[52:55], v[96:111]
    ds_read_b64_tr_b16 v[68:69], v9 offset:15232
    ds_read_b64_tr_b16 v[70:71], v9 offset:15456
    ds_read_b128 v[36:39], v8 offset:544
    v_mfma_f32_16x16x32_bf16 v[112:115], v[84:87], v[20:23], v[112:115]
    s_waitcnt lgkmcnt(9)
    v_mfma_f32_32x32x16_bf16 v[96:111], v[88:91], v[56:59], v[96:111]
    ds_read_b64_tr_b16 v[72:73], v9 offset:16128
    ds_read_b64_tr_b16 v[74:75], v9 offset:16352
    ds_read_b128 v[40:43], v8 offset:576
    v_mfma_f32_16x16x32_bf16 v[112:115], v[88:91], v[20:23], v[112:115]
    s_waitcnt lgkmcnt(9)
    v_mfma_f32_32x32x16_bf16 v[96:111], v[92:95], v[60:63], v[96:111]
    ds_read_b64_tr_b16 v[76:77], v9 offset:17024
    ds_read_b64_tr_b16 v[78:79], v9 offset:17248
    ds_read_b128 v[44:47], v8 offset:608
    v_mfma_f32_16x16x32_bf16 v[112:115], v[92:95], v[20:23], v[112:115]
    s_waitcnt lgkmcnt(9)
    v_mfma_f32_32x32x16_bf16 v[96:111], v[64:67], v[32:35], v[96:111]
    ds_read_b64_tr_b16 v[80:81], v9 offset:17920
    ds_read_b64_tr_b16 v[82:83], v9 offset:18144
    ds_read_b128 v[48:51], v8 offset:640
    ds_read_b32 v15, v18 offset:104
    v_mfma_f32_16x16x32_bf16 v[112:115], v[64:67], v[20:23], v[112:115]
    s_mov_b64 exec, 1
    ds_add_u32 v18, v17 offset:112
    s_mov_b64 exec, -1
    s_waitcnt lgkmcnt(9)
    v_mfma_f32_32x32x16_bf16 v[96:111], v[68:71], v[36:39], v[96:111]
    ds_read_b64_tr_b16 v[84:85], v9 offset:18816
    ds_read_b64_tr_b16 v[86:87], v9 offset:19040
    ds_read_b128 v[52:55], v8 offset:672
    v_mfma_f32_16x16x32_bf16 v[112:115], v[68:71], v[20:23], v[112:115]
    s_waitcnt lgkmcnt(9)
    v_mfma_f32_32x32x16_bf16 v[96:111], v[72:75], v[40:43], v[96:111]
    ds_read_b64_tr_b16 v[88:89], v9 offset:19712
    ds_read_b64_tr_b16 v[90:91], v9 offset:19936
    ds_read_b128 v[56:59], v8 offset:704
    v_mfma_f32_16x16x32_bf16 v[112:115], v[72:75], v[20:23], v[112:115]
    s_waitcnt lgkmcnt(9)
    v_mfma_f32_32x32x16_bf16 v[96:111], v[76:79], v[44:47], v[96:111]
    ds_read_b64_tr_b16 v[92:93], v9 offset:20608
    ds_read_b64_tr_b16 v[94:95], v9 offset:20832
    ds_read_b128 v[60:63], v8 offset:736
    v_mfma_f32_16x16x32_bf16 v[112:115], v[76:79], v[20:23], v[112:115]
    s_waitcnt lgkmcnt(9)
    v_mfma_f32_32x32x16_bf16 v[96:111], v[80:83], v[48:51], v[96:111]
    v_readfirstlane_b32 s68, v15
    s_nop 1
    s_cmp_ge_u32 s68, 4
    s_cbranch_scc1 L_sw_69
    s_mov_b32 s70, 0
L_lw_70:
    ds_read_b32 v15, v18 offset:104
    s_add_u32 s70, s70, 1
    s_cmp_gt_u32 s70, 3200000
    s_cbranch_scc1 L_END
    s_waitcnt lgkmcnt(0)
    v_readfirstlane_b32 s68, v15
    s_nop 1
    s_cmp_ge_u32 s68, 4
    s_cbranch_scc0 L_lw_70
L_sw_69:
    ds_read_b64_tr_b16 v[64:65], v9 offset:21504
    ds_read_b64_tr_b16 v[66:67], v9 offset:21728
    ds_read_b128 v[32:35], v8 offset:768
    v_mfma_f32_16x16x32_bf16 v[112:115], v[80:83], v[20:23], v[112:115]
    s_waitcnt lgkmcnt(9)
    v_mfma_f32_32x32x16_bf16 v[96:111], v[84:87], v[52:55], v[96:111]
    ds_read_b64_tr_b16 v[68:69], v9 offset:22400
    ds_read_b64_tr_b16 v[70:71], v9 offset:22624
    ds_read_b128 v[36:39], v8 offset:800
    v_mfma_f32_16x16x32_bf16 v[112:115], v[84:87], v[20:23], v[112:115]
    s_mov_b32 s70, 0
L_lw_71:
    ds_read_b32 v16, v18 offset:116
    s_add_u32 s70, s70, 1
    s_cmp_gt_u32 s70, 3200000
    s_cbranch_scc1 L_END
    s_waitcnt lgkmcnt(0)
    v_readfirstlane_b32 s68, v16
    s_nop 1
    s_cmp_ge_u32 s68, 4
    s_cbranch_scc0 L_lw_71
    v_lshl_add_u32 v13, s62, 5, v3
    v_lshlrev_b32 v13, 3, v13
    v_add_u32 v13, 158720, v13
    ds_read_b64 v[136:137], v13
    ds_read_b64 v[138:139], v13 offset:512
    s_waitcnt lgkmcnt(9)
    v_mfma_f32_32x32x16_bf16 v[96:111], v[88:91], v[56:59], v[96:111]
    ds_read_b64_tr_b16 v[72:73], v9 offset:23296
    ds_read_b64_tr_b16 v[74:75], v9 offset:23520
    ds_read_b128 v[40:43], v8 offset:832
    v_mfma_f32_16x16x32_bf16 v[112:115], v[88:91], v[20:23], v[112:115]
    s_waitcnt lgkmcnt(9)
    v_mfma_f32_32x32x16_bf16 v[96:111], v[92:95], v[60:63], v[96:111]
    ds_read_b64_tr_b16 v[76:77], v9 offset:24192
    ds_read_b64_tr_b16 v[78:79], v9 offset:24416
    ds_read_b128 v[44:47], v8 offset:864
    v_mfma_f32_16x16x32_bf16 v[112:115], v[92:95], v[20:23], v[112:115]
    s_waitcnt lgkmcnt(9)
    v_mfma_f32_32x32x16_bf16 v[96:111], v[64:67], v[32:35], v[96:111]
    v_mfma_f32_16x16x32_bf16 v[112:115], v[64:67], v[20:23], v[112:115]
    s_waitcnt lgkmcnt(6)
    v_mfma_f32_32x32x16_bf16 v[96:111], v[68:71], v[36:39], v[96:111]
    v_mfma_f32_16x16x32_bf16 v[112:115], v[68:71], v[20:23], v[112:115]
    s_waitcnt lgkmcnt(3)
    v_mfma_f32_32x32x16_bf16 v[96:111], v[72:75], v[40:43], v[96:111]
    v_mfma_f32_16x16x32_bf16 v[112:115], v[72:75], v[20:23], v[112:115]
    v_add_f32 v136, v136, v138
    v_add_f32 v137, v137, v139
    v_mul_f32 v5, 0x3b124925, v136
    v_mul_f32 v137, 0x3b124925, v137
    v_fma_f32 v137, -v5, v5, v137
    v_max_f32 v137, 0, v137
    v_add_f32 v138, 0x3727c5ac, v137
    v_rsq_f32 v6, v138
    s_nop 0
    v_mul_f32 v137, v137, v6
    v_fmaak_f32 v137, v137, v6, 0x3727c5ac
    v_rsq_f32 v137, v137
    s_nop 0
    v_mul_f32 v7, v6, v137
    s_waitcnt lgkmcnt(0)
    v_mfma_f32_32x32x16_bf16 v[96:111], v[76:79], v[44:47], v[96:111]
    v_mfma_f32_16x16x32_bf16 v[112:115], v[76:79], v[20:23], v[112:115]
    v_lshlrev_b32 v13, 2, v3
    buffer_load_dword v30, v13, s[40:43], 0 offen offset:128 sc1
    s_lshl_b32 s68, s3, 7
    s_add_u32 s68, s68, 160896
    v_and_b32 v13, 15, v1
    v_cmp_gt_u32 vcc, 2, v13
    v_lshlrev_b32 v13, 6, v13
    v_and_b32 v14, 48, v1
    v_add3_u32 v13, v13, v14, s68
    s_mov_b64 exec, vcc
    ds_write_b128 v13, v[112:115]
    s_mov_b64 exec, -1
    v_lshl_add_u32 v13, v4, 4, s68
    ds_read_b128 v[120:123], v13 offset:0
    ds_read_b128 v[124:127], v13 offset:32
    ds_read_b128 v[128:131], v13 offset:64
    ds_read_b128 v[132:135], v13 offset:96
    s_waitcnt lgkmcnt(0)
    v_fma_f32 v96, -v5, v120, v96
    v_fma_f32 v97, -v5, v121, v97
    v_fma_f32 v98, -v5, v122, v98
    v_fma_f32 v99, -v5, v123, v99
    v_fma_f32 v100, -v5, v124, v100
    v_fma_f32 v101, -v5, v125, v101
    v_fma_f32 v102, -v5, v126, v102
    v_fma_f32 v103, -v5, v127, v103
    v_fma_f32 v104, -v5, v128, v104
    v_fma_f32 v105, -v5, v129, v105
    v_fma_f32 v106, -v5, v130, v106
    v_fma_f32 v107, -v5, v131, v107
    v_fma_f32 v108, -v5, v132, v108
    v_fma_f32 v109, -v5, v133, v109
    v_fma_f32 v110, -v5, v134, v110
    v_fma_f32 v111, -v5, v135, v111
    v_mul_f32 v96, v96, v6
    v_mul_f32 v97, v97, v6
    v_mul_f32 v98, v98, v6
    v_mul_f32 v99, v99, v6
    v_mul_f32 v100, v100, v6
    v_mul_f32 v101, v101, v6
    v_mul_f32 v102, v102, v6
    v_mul_f32 v103, v103, v6
    v_mul_f32 v104, v104, v6
    v_mul_f32 v105, v105, v6
    v_mul_f32 v106, v106, v6
    v_mul_f32 v107, v107, v6
    v_mul_f32 v108, v108, v6
    v_mul_f32 v109, v109, v6
    v_mul_f32 v110, v110, v6
    v_mul_f32 v111, v111, v6
    s_mov_b32 exec_lo, 0
    s_mov_b32 exec_hi, -1
    v_mov_b32 v108, 0
    v_mov_b32 v109, 0
    v_mov_b32 v110, 0
    v_mov_b32 v111, 0
    s_mov_b64 exec, -1
    v_cvt_pk_bf16_f32 v136, v96, v97
    v_cvt_pk_bf16_f32 v137, v98, v99
    v_cvt_pk_bf16_f32 v138, v100, v101
    v_cvt_pk_bf16_f32 v139, v102, v103
    v_cvt_pk_bf16_f32 v140, v104, v105
    v_cvt_pk_bf16_f32 v141, v106, v107
    v_cvt_pk_bf16_f32 v142, v108, v109
    v_cvt_pk_bf16_f32 v143, v110, v111
    s_mov_b32 exec_lo, 0
    s_mov_b32 exec_hi, -1
    v_mov_b32 v142, 1065369472
    v_mov_b32 v143, 0x3f80
    s_mov_b64 exec, -1
    buffer_store_dwordx4 v[136:139], v2, s[44:47], s79 offen sc1
    buffer_store_dwordx4 v[140:143], v2, s[44:47], s79 offen offset:1024 sc1
    v_mul_f32 v13, v96, v96
    v_mul_f32 v14, v97, v97
    v_fmac_f32 v13, v98, v98
    v_fmac_f32 v14, v99, v99
    v_fmac_f32 v13, v100, v100
    v_fmac_f32 v14, v101, v101
    v_fmac_f32 v13, v102, v102
    v_fmac_f32 v14, v103, v103
    v_fmac_f32 v13, v104, v104
    v_fmac_f32 v14, v105, v105
    v_fmac_f32 v13, v106, v106
    v_fmac_f32 v14, v107, v107
    v_fmac_f32 v13, v108, v108
    v_fmac_f32 v14, v109, v109
    v_fmac_f32 v13, v110, v110
    v_fmac_f32 v14, v111, v111
    v_add_f32 v13, v13, v14
    v_mov_b32 v14, v13
    s_nop 1
    v_permlane32_swap_b32 v13, v14
    v_add_f32 v13, v13, v14
    s_nop 1
    v_max_f32_dpp v13, v13, v13 row_shr:1 row_mask:0xf bank_mask:0xf
    s_nop 1
    v_max_f32_dpp v13, v13, v13 row_shr:2 row_mask:0xf bank_mask:0xf
    s_nop 1
    v_max_f32_dpp v13, v13, v13 row_shr:4 row_mask:0xf bank_mask:0xf
    s_nop 1
    v_max_f32_dpp v13, v13, v13 row_shr:8 row_mask:0xf bank_mask:0xf
    s_mov_b64 exec, 0x80008000
    ds_max_u32 v18, v13 offset:48
    s_mov_b64 exec, -1
    s_branch L_g_kvpub
L_g_v:
    s_mov_b64 exec, 1
    ds_add_u32 v18, v17 offset:116
    s_mov_b64 exec, -1
    s_mov_b32 s70, 0
L_lw_72:
    ds_read_b32 v15, v18 offset:92
    s_add_u32 s70, s70, 1
    s_cmp_gt_u32 s70, 3200000
    s_cbranch_scc1 L_END
    s_waitcnt lgkmcnt(0)
    v_readfirstlane_b32 s68, v15
    s_nop 1
    s_cmp_ge_u32 s68, 4
    s_cbranch_scc0 L_lw_72
    ds_read_b64_tr_b16 v[64:65], v9 offset:0
    ds_read_b64_tr_b16 v[66:67], v9 offset:224
    ds_read_b64_tr_b16 v[68:69], v9 offset:896
    ds_read_b64_tr_b16 v[70:71], v9 offset:1120
    ds_read_b64_tr_b16 v[72:73], v9 offset:1792
    ds_read_b64_tr_b16 v[74:75], v9 offset:2016
    ds_read_b64_tr_b16 v[76:77], v9 offset:2688
    ds_read_b64_tr_b16 v[78:79], v9 offset:2912
    s_waitcnt lgkmcnt(6)
    v_mfma_f32_32x32x16_bf16 v[96:111], v[32:35], v[64:67], 0
    ds_read_b64_tr_b16 v[80:81], v9 offset:3584
    ds_read_b64_tr_b16 v[82:83], v9 offset:3808
    ds_read_b32 v15, v18 offset:96
    v_mfma_f32_16x16x32_bf16 v[112:115], v[20:23], v[64:67], 0
    s_waitcnt lgkmcnt(6)
    v_mfma_f32_32x32x16_bf16 v[96:111], v[36:39], v[68:71], v[96:111]
    ds_read_b64_tr_b16 v[84:85], v9 offset:4480
    ds_read_b64_tr_b16 v[86:87], v9 offset:4704
    v_mfma_f32_16x16x32_bf16 v[112:115], v[20:23], v[68:71], v[112:115]
    s_waitcnt lgkmcnt(6)
    v_mfma_f32_32x32x16_bf16 v[96:111], v[40:43], v[72:75], v[96:111]
    ds_read_b64_tr_b16 v[88:89], v9 offset:5376
    ds_read_b64_tr_b16 v[90:91], v9 offset:5600
    v_mfma_f32_16x16x32_bf16 v[112:115], v[20:23], v[72:75], v[112:115]
    s_waitcnt lgkmcnt(6)
    v_mfma_f32_32x32x16_bf16 v[96:111], v[44:47], v[76:79], v[96:111]
    ds_read_b64_tr_b16 v[92:93], v9 offset:6272
    ds_read_b64_tr_b16 v[94:95], v9 offset:6496
    v_mfma_f32_16x16x32_bf16 v[112:115], v[20:23], v[76:79], v[112:115]
    s_waitcnt lgkmcnt(6)
    v_mfma_f32_32x32x16_bf16 v[96:111], v[48:51], v[80:83], v[96:111]
    v_readfirstlane_b32 s68, v15
    s_nop 1
    s_cmp_ge_u32 s68, 4
    s_cbranch_scc1 L_sw_73
    s_mov_b32 s70, 0
L_lw_74:
    ds_read_b32 v15, v18 offset:96
    s_add_u32 s70, s70, 1
    s_cmp_gt_u32 s70, 3200000
    s_cbranch_scc1 L_END
    s_waitcnt lgkmcnt(0)
    v_readfirstlane_b32 s68, v15
    s_nop 1
    s_cmp_ge_u32 s68, 4
    s_cbranch_scc0 L_lw_74
L_sw_73:
    ds_read_b64_tr_b16 v[64:65], v9 offset:7168
    ds_read_b64_tr_b16 v[66:67], v9 offset:7392
    ds_read_b128 v[32:35], v8 offset:256
    v_mfma_f32_16x16x32_bf16 v[112:115], v[20:23], v[80:83], v[112:115]
    s_waitcnt lgkmcnt(7)
    v_mfma_f32_32x32x16_bf16 v[96:111], v[52:55], v[84:87], v[96:111]
    ds_read_b64_tr_b16 v[68:69], v9 offset:8064
    ds_read_b64_tr_b16 v[70:71], v9 offset:8288
    ds_read_b128 v[36:39], v8 offset:288
    v_mfma_f32_16x16x32_bf16 v[112:115], v[20:23], v[84:87], v[112:115]
    s_waitcnt lgkmcnt(8)
    v_mfma_f32_32x32x16_bf16 v[96:111], v[56:59], v[88:91], v[96:111]
    ds_read_b64_tr_b16 v[72:73], v9 offset:8960
    ds_read_b64_tr_b16 v[74:75], v9 offset:9184
    ds_read_b128 v[40:43], v8 offset:320
    v_mfma_f32_16x16x32_bf16 v[112:115], v[20:23], v[88:91], v[112:115]
    s_waitcnt lgkmcnt(9)
    v_mfma_f32_32x32x16_bf16 v[96:111], v[60:63], v[92:95], v[96:111]
    ds_read_b64_tr_b16 v[76:77], v9 offset:9856
    ds_read_b64_tr_b16 v[78:79], v9 offset:10080
    ds_read_b128 v[44:47], v8 offset:352
    v_mfma_f32_16x16x32_bf16 v[112:115], v[20:23], v[92:95], v[112:115]
    s_waitcnt lgkmcnt(9)
    v_mfma_f32_32x32x16_bf16 v[96:111], v[32:35], v[64:67], v[96:111]
    ds_read_b64_tr_b16 v[80:81], v9 offset:10752
    ds_read_b64_tr_b16 v[82:83], v9 offset:10976
    ds_read_b128 v[48:51], v8 offset:384
    ds_read_b32 v15, v18 offset:100
    v_mfma_f32_16x16x32_bf16 v[112:115], v[20:23], v[64:67], v[112:115]
    s_mov_b64 exec, 1
    ds_add_u32 v18, v17 offset:108
    s_mov_b64 exec, -1
    s_waitcnt lgkmcnt(9)
    v_mfma_f32_32x32x16_bf16 v[96:111], v[36:39], v[68:71], v[96:111]
    ds_read_b64_tr_b16 v[84:85], v9 offset:11648
    ds_read_b64_tr_b16 v[86:87], v9 offset:11872
    ds_read_b128 v[52:55], v8 offset:416
    v_mfma_f32_16x16x32_bf16 v[112:115], v[20:23], v[68:71], v[112:115]
    s_waitcnt lgkmcnt(9)
    v_mfma_f32_32x32x16_bf16 v[96:111], v[40:43], v[72:75], v[96:111]
    ds_read_b64_tr_b16 v[88:89], v9 offset:12544
    ds_read_b64_tr_b16 v[90:91], v9 offset:12768
    ds_read_b128 v[56:59], v8 offset:448
    v_mfma_f32_16x16x32_bf16 v[112:115], v[20:23], v[72:75], v[112:115]
    s_waitcnt lgkmcnt(9)
    v_mfma_f32_32x32x16_bf16 v[96:111], v[44:47], v[76:79], v[96:111]
    ds_read_b64_tr_b16 v[92:93], v9 offset:13440
    ds_read_b64_tr_b16 v[94:95], v9 offset:13664
    ds_read_b128 v[60:63], v8 offset:480
    v_mfma_f32_16x16x32_bf16 v[112:115], v[20:23], v[76:79], v[112:115]
    s_waitcnt lgkmcnt(9)
    v_mfma_f32_32x32x16_bf16 v[96:111], v[48:51], v[80:83], v[96:111]
    v_readfirstlane_b32 s68, v15
    s_nop 1
    s_cmp_ge_u32 s68, 4
    s_cbranch_scc1 L_sw_75
    s_mov_b32 s70, 0
L_lw_76:
    ds_read_b32 v15, v18 offset:100
    s_add_u32 s70, s70, 1
    s_cmp_gt_u32 s70, 3200000
    s_cbranch_scc1 L_END
    s_waitcnt lgkmcnt(0)
    v_readfirstlane_b32 s68, v15
    s_nop 1
    s_cmp_ge_u32 s68, 4
    s_cbranch_scc0 L_lw_76
L_sw_75:
    ds_read_b64_tr_b16 v[64:65], v9 offset:14336
    ds_read_b64_tr_b16 v[66:67], v9 offset:14560
    ds_read_b128 v[32:35], v8 offset:512
    v_mfma_f32_16x16x32_bf16 v[112:115], v[20:23], v[80:83], v[112:115]
    s_waitcnt lgkmcnt(9)
    v_mfma_f32_32x32x16_bf16 v[96:111], v[52:55], v[84:87], v[96:111]
    ds_read_b64_tr_b16 v[68:69], v9 offset:15232
    ds_read_b64_tr_b16 v[70:71], v9 offset:15456
    ds_read_b128 v[36:39], v8 offset:544
    v_mfma_f32_16x16x32_bf16 v[112:115], v[20:23], v[84:87], v[112:115]
    s_waitcnt lgkmcnt(9)
    v_mfma_f32_32x32x16_bf16 v[96:111], v[56:59], v[88:91], v[96:111]
    ds_read_b64_tr_b16 v[72:73], v9 offset:16128
    ds_read_b64_tr_b16 v[74:75], v9 offset:16352
    ds_read_b128 v[40:43], v8 offset:576
    v_mfma_f32_16x16x32_bf16 v[112:115], v[20:23], v[88:91], v[112:115]
    s_waitcnt lgkmcnt(9)
    v_mfma_f32_32x32x16_bf16 v[96:111], v[60:63], v[92:95], v[96:111]
    ds_read_b64_tr_b16 v[76:77], v9 offset:17024
    ds_read_b64_tr_b16 v[78:79], v9 offset:17248
    ds_read_b128 v[44:47], v8 offset:608
    v_mfma_f32_16x16x32_bf16 v[112:115], v[20:23], v[92:95], v[112:115]
    s_waitcnt lgkmcnt(9)
    v_mfma_f32_32x32x16_bf16 v[96:111], v[32:35], v[64:67], v[96:111]
    ds_read_b64_tr_b16 v[80:81], v9 offset:17920
    ds_read_b64_tr_b16 v[82:83], v9 offset:18144
    ds_read_b128 v[48:51], v8 offset:640
    ds_read_b32 v15, v18 offset:104
    v_mfma_f32_16x16x32_bf16 v[112:115], v[20:23], v[64:67], v[112:115]
    s_mov_b64 exec, 1
    ds_add_u32 v18, v17 offset:112
    s_mov_b64 exec, -1
    s_waitcnt lgkmcnt(9)
    v_mfma_f32_32x32x16_bf16 v[96:111], v[36:39], v[68:71], v[96:111]
    ds_read_b64_tr_b16 v[84:85], v9 offset:18816
    ds_read_b64_tr_b16 v[86:87], v9 offset:19040
    ds_read_b128 v[52:55], v8 offset:672
    v_mfma_f32_16x16x32_bf16 v[112:115], v[20:23], v[68:71], v[112:115]
    s_waitcnt lgkmcnt(9)
    v_mfma_f32_32x32x16_bf16 v[96:111], v[40:43], v[72:75], v[96:111]
    ds_read_b64_tr_b16 v[88:89], v9 offset:19712
    ds_read_b64_tr_b16 v[90:91], v9 offset:19936
    ds_read_b128 v[56:59], v8 offset:704
    v_mfma_f32_16x16x32_bf16 v[112:115], v[20:23], v[72:75], v[112:115]
    s_waitcnt lgkmcnt(9)
    v_mfma_f32_32x32x16_bf16 v[96:111], v[44:47], v[76:79], v[96:111]
    ds_read_b64_tr_b16 v[92:93], v9 offset:20608
    ds_read_b64_tr_b16 v[94:95], v9 offset:20832
    ds_read_b128 v[60:63], v8 offset:736
    v_mfma_f32_16x16x32_bf16 v[112:115], v[20:23], v[76:79], v[112:115]
    s_waitcnt lgkmcnt(9)
    v_mfma_f32_32x32x16_bf16 v[96:111], v[48:51], v[80:83], v[96:111]
    v_readfirstlane_b32 s68, v15
    s_nop 1
    s_cmp_ge_u32 s68, 4
    s_cbranch_scc1 L_sw_77
    s_mov_b32 s70, 0
L_lw_78:
    ds_read_b32 v15, v18 offset:104
    s_add_u32 s70, s70, 1
    s_cmp_gt_u32 s70, 3200000
    s_cbranch_scc1 L_END
    s_waitcnt lgkmcnt(0)
    v_readfirstlane_b32 s68, v15
    s_nop 1
    s_cmp_ge_u32 s68, 4
    s_cbranch_scc0 L_lw_78
L_sw_77:
    ds_read_b64_tr_b16 v[64:65], v9 offset:21504
    ds_read_b64_tr_b16 v[66:67], v9 offset:21728
    ds_read_b128 v[32:35], v8 offset:768
    v_mfma_f32_16x16x32_bf16 v[112:115], v[20:23], v[80:83], v[112:115]
    s_waitcnt lgkmcnt(9)
    v_mfma_f32_32x32x16_bf16 v[96:111], v[52:55], v[84:87], v[96:111]
    ds_read_b64_tr_b16 v[68:69], v9 offset:22400
    ds_read_b64_tr_b16 v[70:71], v9 offset:22624
    ds_read_b128 v[36:39], v8 offset:800
    v_mfma_f32_16x16x32_bf16 v[112:115], v[20:23], v[84:87], v[112:115]
    s_mov_b32 s70, 0
L_lw_79:
    ds_read_b32 v16, v18 offset:116
    s_add_u32 s70, s70, 1
    s_cmp_gt_u32 s70, 3200000
    s_cbranch_scc1 L_END
    s_waitcnt lgkmcnt(0)
    v_readfirstlane_b32 s68, v16
    s_nop 1
    s_cmp_ge_u32 s68, 4
    s_cbranch_scc0 L_lw_79
    v_lshl_add_u32 v13, s62, 5, v3
    v_lshlrev_b32 v13, 3, v13
    v_add_u32 v13, 158720, v13
    ds_read_b64 v[136:137], v13
    ds_read_b64 v[138:139], v13 offset:512
    s_waitcnt lgkmcnt(9)
    v_mfma_f32_32x32x16_bf16 v[96:111], v[56:59], v[88:91], v[96:111]
    ds_read_b64_tr_b16 v[72:73], v9 offset:23296
    ds_read_b64_tr_b16 v[74:75], v9 offset:23520
    ds_read_b128 v[40:43], v8 offset:832
    v_mfma_f32_16x16x32_bf16 v[112:115], v[20:23], v[88:91], v[112:115]
    s_waitcnt lgkmcnt(9)
    v_mfma_f32_32x32x16_bf16 v[96:111], v[60:63], v[92:95], v[96:111]
    ds_read_b64_tr_b16 v[76:77], v9 offset:24192
    ds_read_b64_tr_b16 v[78:79], v9 offset:24416
    ds_read_b128 v[44:47], v8 offset:864
    v_mfma_f32_16x16x32_bf16 v[112:115], v[20:23], v[92:95], v[112:115]
    s_waitcnt lgkmcnt(9)
    v_mfma_f32_32x32x16_bf16 v[96:111], v[32:35], v[64:67], v[96:111]
    v_mfma_f32_16x16x32_bf16 v[112:115], v[20:23], v[64:67], v[112:115]
    s_waitcnt lgkmcnt(6)
    v_mfma_f32_32x32x16_bf16 v[96:111], v[36:39], v[68:71], v[96:111]
    v_mfma_f32_16x16x32_bf16 v[112:115], v[20:23], v[68:71], v[112:115]
    s_waitcnt lgkmcnt(3)
    v_mfma_f32_32x32x16_bf16 v[96:111], v[40:43], v[72:75], v[96:111]
    v_mfma_f32_16x16x32_bf16 v[112:115], v[20:23], v[72:75], v[112:115]
    v_add_f32 v136, v136, v138
    v_add_f32 v137, v137, v139
    v_mul_f32 v5, 0x3b124925, v136
    v_mul_f32 v137, 0x3b124925, v137
    v_fma_f32 v137, -v5, v5, v137
    v_max_f32 v137, 0, v137
    v_add_f32 v138, 0x3727c5ac, v137
    v_rsq_f32 v6, v138
    s_nop 0
    v_mul_f32 v137, v137, v6
    v_fmaak_f32 v137, v137, v6, 0x3727c5ac
    v_rsq_f32 v137, v137
    s_nop 0
    v_mul_f32 v7, v6, v137
    s_waitcnt lgkmcnt(0)
    v_mfma_f32_32x32x16_bf16 v[96:111], v[44:47], v[76:79], v[96:111]
    v_mfma_f32_16x16x32_bf16 v[112:115], v[20:23], v[76:79], v[112:115]
    v_lshlrev_b32 v13, 2, v3
    buffer_load_dword v30, v13, s[40:43], 0 offen offset:128 sc1
    v_mul_f32 v13, v5, v6
    v_cmp_eq_u32 vcc, 0, v4
    s_lshl_b32 s65, s62, 8
    s_add_u32 s65, s65, 160256
    v_lshl_add_u32 v14, v1, 2, s65
    v_cndmask_b32 v13, v13, v6, vcc
    ds_write_b32 v14, v13
    v_lshl_add_u32 v14, v4, 4, s65
    ds_read_b128 v[120:123], v14 offset:0
    ds_read_b128 v[136:139], v14 offset:128
    ds_read_b128 v[124:127], v14 offset:32
    ds_read_b128 v[140:143], v14 offset:160
    ds_read_b128 v[128:131], v14 offset:64
    ds_read_b128 v[144:147], v14 offset:192
    ds_read_b128 v[132:135], v14 offset:96
    ds_read_b128 v[148:151], v14 offset:224
    v_and_b32 v13, 16, v1
    v_cmp_eq_u32 vcc, 0, v13
    s_nop 1
    v_cndmask_b32 v13, v113, v112, vcc
    s_waitcnt lgkmcnt(0)
    v_mul_f32 v136, v136, v13
    v_mul_f32 v137, v137, v13
    v_mul_f32 v138, v138, v13
    v_mul_f32 v139, v139, v13
    v_mul_f32 v140, v140, v13
    v_mul_f32 v141, v141, v13
    v_mul_f32 v142, v142, v13
    v_mul_f32 v143, v143, v13
    v_mul_f32 v144, v144, v13
    v_mul_f32 v145, v145, v13
    v_mul_f32 v146, v146, v13
    v_mul_f32 v147, v147, v13
    v_mul_f32 v148, v148, v13
    v_mul_f32 v149, v149, v13
    v_mul_f32 v150, v150, v13
    v_mul_f32 v151, v151, v13
    v_fma_f32 v96, v96, v120, -v136
    v_fma_f32 v97, v97, v121, -v137
    v_fma_f32 v98, v98, v122, -v138
    v_fma_f32 v99, v99, v123, -v139
    v_fma_f32 v100, v100, v124, -v140
    v_fma_f32 v101, v101, v125, -v141
    v_fma_f32 v102, v102, v126, -v142
    v_fma_f32 v103, v103, v127, -v143
    v_fma_f32 v104, v104, v128, -v144
    v_fma_f32 v105, v105, v129, -v145
    v_fma_f32 v106, v106, v130, -v146
    v_fma_f32 v107, v107, v131, -v147
    v_fma_f32 v108, v108, v132, -v148
    v_fma_f32 v109, v109, v133, -v149
    v_fma_f32 v110, v110, v134, -v150
    v_fma_f32 v111, v111, v135, -v151
    v_cvt_pk_bf16_f32 v136, v96, v97
    v_cvt_pk_bf16_f32 v137, v98, v99
    v_cvt_pk_bf16_f32 v138, v100, v101
    v_cvt_pk_bf16_f32 v139, v102, v103
    v_cvt_pk_bf16_f32 v140, v104, v105
    v_cvt_pk_bf16_f32 v141, v106, v107
    v_cvt_pk_bf16_f32 v142, v108, v109
    v_cvt_pk_bf16_f32 v143, v110, v111
    v_cmp_eq_u32 vcc, 28, v3
    v_mov_b32 v13, 1065369472
    s_nop 0
    v_cndmask_b32 v136, v136, v13, vcc
    v_cndmask_b32 v137, v137, v13, vcc
    v_cndmask_b32 v138, v138, v13, vcc
    v_cndmask_b32 v139, v139, v13, vcc
    v_cndmask_b32 v140, v140, v13, vcc
    v_cndmask_b32 v141, v141, v13, vcc
    v_cndmask_b32 v142, v142, v13, vcc
    v_cndmask_b32 v143, v143, v13, vcc
    buffer_store_dwordx4 v[136:139], v2, s[44:47], s79 offen offset:2048 sc1
    buffer_store_dwordx4 v[140:143], v2, s[44:47], s79 offen offset:3072 sc1
L_g_kvpub:
    s_mov_b64 exec, 1
    ds_add_u32 v18, v17 offset:0
    s_mov_b64 exec, -1
    s_getreg_b32 s82, hwreg(HW_REG_XCC_ID)
    s_and_b32 s82, s82, 15
    s_add_u32 s82, s82, 1
    v_lshlrev_b32 v13, 2, v3
    s_mov_b32 s70, 0
    s_waitcnt vmcnt(0)
L_dbg_80:
    v_cmp_eq_u32 vcc, 0, v30
    s_cbranch_vccz L_dbgok_81
    buffer_load_dword v30, v13, s[40:43], 0 offen offset:128 sc1
    s_waitcnt vmcnt(0)
    s_add_u32 s70, s70, 1
    s_cmp_gt_u32 s70, 400000
    s_cbranch_scc1 L_END
    s_branch L_dbg_80
L_dbgok_81:
    s_waitcnt vmcnt(0)
    s_mov_b64 exec, 1
    ds_add_rtn_u32 v13, v18, v17 offset:20
    s_lshl_b32 s67, s5, 7
    s_add_u32 s67, s67, s80
    s_add_u32 s67, s67, 0
    s_waitcnt lgkmcnt(0)
    v_readfirstlane_b32 s68, v13
    v_mov_b32 v13, 0
    s_nop 0
    s_cmp_eq_u32 s68, 3
    s_cbranch_scc0 L_sig_82
    ds_read_b32 v15, v18 offset:48
    s_waitcnt lgkmcnt(0)
    v_or_b32 v15, 1, v15
    buffer_store_dword v15, v13, s[44:47], s67 offen offset:3200 sc1
    v_mov_b32 v14, s82
    buffer_store_dword v14, v13, s[44:47], s67 offen sc1
L_sig_82:
    s_mov_b64 exec, -1
    s_cmp_lg_u32 s61, 0
    s_cbranch_scc1 L_np_83
    s_add_u32 s67, s80, 0
    v_lshlrev_b32 v13, 7, v1
    s_mov_b32 exec_lo, 0xff
    s_mov_b32 exec_hi, 0
    s_mov_b32 s70, 0
L_poll_85:
    buffer_load_dword v14, v13, s[44:47], s67 offen sc1
    s_add_u32 s70, s70, 1
    s_cmp_gt_u32 s70, 400000
    s_cbranch_scc1 L_END
    s_waitcnt vmcnt(0)
    v_cmp_ne_u32 vcc, 0, v14
    s_nop 1
    s_cmp_eq_u64 vcc, exec
    s_cbranch_scc1 L_poll_85_ok
    s_branch L_poll_85
L_poll_85_ok:
    s_mov_b64 exec, -1
    s_mov_b64 exec, 0xff
    v_cmp_ne_u32 vcc, s82, v14
    s_mov_b64 exec, -1
    s_nop 0
    s_cmp_eq_u64 vcc, 0
    s_cselect_b32 s82, 1, 0
    v_mov_b32 v15, s82
    ds_write_b32 v18, v15 offset:28
    s_mov_b64 exec, 1
    ds_add_u32 v18, v17 offset:68
    s_mov_b64 exec, -1
    s_branch L_pd_84
L_np_83:
    s_mov_b32 s70, 0
L_lw_86:
    ds_read_b32 v15, v18 offset:68
    s_add_u32 s70, s70, 1
    s_cmp_gt_u32 s70, 3200000
    s_cbranch_scc1 L_END
    s_waitcnt lgkmcnt(0)
    v_readfirstlane_b32 s68, v15
    s_nop 1
    s_cmp_ge_u32 s68, 1
    s_cbranch_scc0 L_lw_86
L_pd_84:
    ds_read_b32 v14, v18 offset:28
    s_waitcnt lgkmcnt(0)
    v_readfirstlane_b32 s82, v14
    s_nop 1
    s_cmp_eq_u32 s82, 0
    s_cbranch_scc1 L_pl_87
    v_lshlrev_b32 v13, 7, v1
    s_lshl_b32 s65, s61, 13
    s_add_u32 s65, s65, s60
    s_add_u32 s66, s65, 57344
    buffer_load_dword v31, v13, s[44:47], s66 offen sc1
    s_waitcnt vmcnt(1)
L_pp_88:
    s_cmp_ge_u32 s61, 3
    s_cbranch_scc1 L_pp_89
    s_add_u32 s66, s65, 90112
    buffer_load_dword v31, v13, s[44:47], s66 offen sc1
    s_waitcnt vmcnt(1)
L_pp_89:
L_pl_87:
    s_cmp_eq_u32 s82, 0
    s_cbranch_scc1 L_pl_90
    v_lshlrev_b32 v13, 7, v1
    s_lshl_b32 s65, s61, 13
    s_add_u32 s65, s65, s60
    s_cmp_ge_u32 s61, 1
    s_cbranch_scc1 L_pp_91
    s_add_u32 s66, s65, 172032
    buffer_load_dword v31, v13, s[44:47], s66 offen sc1
    s_waitcnt vmcnt(1)
L_pp_91:
L_pl_90:
    s_cmp_ge_u32 s4, 28
    s_cbranch_scc1 L_nocs_92
    v_lshrrev_b32 v13, 3, v1
    v_lshlrev_b32 v14, 2, v1
    v_and_b32 v14, 64, v14
    v_and_b32 v15, 7, v1
    v_lshlrev_b32 v15, 4, v15
    v_xor_b32 v14, v14, v15
    v_mul_u32_u24 v10, 3584, v13
    v_add_u32 v10, v10, v14
    s_mul_i32 s74, s61, 14336
    s_mul_i32 s72, s61, 401408
    s_lshl_b32 s65, s4, 7
    s_add_u32 s72, s72, s65
    v_add_u32 v27, s74, v12
    v_xor_b32 v28, 64, v27
    s_mov_b32 s70, 0
L_lw_93:
    ds_read_b32 v15, v18 offset:4
    s_add_u32 s70, s70, 1
    s_cmp_gt_u32 s70, 3200000
    s_cbranch_scc1 L_END
    s_waitcnt lgkmcnt(0)
    v_readfirstlane_b32 s68, v15
    s_nop 1
    s_cmp_ge_u32 s68, 12
    s_cbranch_scc0 L_lw_93
    s_add_u32 m0, s74, 0
    s_add_u32 s69, s72, 28672
    buffer_load_dwordx4 v10, s[28:31], s72 offen lds
    s_add_u32 m0, m0, 1024
    s_add_u32 s72, s72, 57344
    buffer_load_dwordx4 v10, s[28:31], s69 offen lds
    s_add_u32 m0, s74, 2048
    s_add_u32 s69, s72, 28672
    buffer_load_dwordx4 v10, s[28:31], s72 offen lds
    s_add_u32 m0, m0, 1024
    s_add_u32 s72, s72, 57344
    buffer_load_dwordx4 v10, s[28:31], s69 offen lds
    s_add_u32 m0, s74, 4096
    s_add_u32 s69, s72, 28672
    buffer_load_dwordx4 v10, s[28:31], s72 offen lds
    s_add_u32 m0, m0, 1024
    s_add_u32 s72, s72, 57344
    buffer_load_dwordx4 v10, s[28:31], s69 offen lds
    s_add_u32 m0, s74, 6144
    s_add_u32 s69, s72, 28672
    buffer_load_dwordx4 v10, s[28:31], s72 offen lds
    s_add_u32 m0, m0, 1024
    s_add_u32 s72, s72, 57344
    buffer_load_dwordx4 v10, s[28:31], s69 offen lds
    s_add_u32 m0, s74, 8192
    s_add_u32 s69, s72, 28672
    buffer_load_dwordx4 v10, s[28:31], s72 offen lds
    s_add_u32 m0, m0, 1024
    s_add_u32 s72, s72, 57344
    buffer_load_dwordx4 v10, s[28:31], s69 offen lds
    s_add_u32 m0, s74, 10240
    s_add_u32 s69, s72, 28672
    buffer_load_dwordx4 v10, s[28:31], s72 offen lds
    s_add_u32 m0, m0, 1024
    s_add_u32 s72, s72, 57344
    buffer_load_dwordx4 v10, s[28:31], s69 offen lds
    s_add_u32 m0, s74, 12288
    s_add_u32 s69, s72, 28672
    buffer_load_dwordx4 v10, s[28:31], s72 offen lds
    s_add_u32 m0, m0, 1024
    s_add_u32 s72, s72, 57344
    buffer_load_dwordx4 v10, s[28:31], s69 offen lds
    s_waitcnt vmcnt(12)
    ds_read_b64_tr_b16 v[32:33], v27 offset:0
    ds_read_b64_tr_b16 v[34:35], v27 offset:512
    ds_read_b64_tr_b16 v[36:37], v28 offset:0
    ds_read_b64_tr_b16 v[38:39], v28 offset:512
    s_waitcnt lgkmcnt(0)
    v_mfma_f32_16x16x32_bf16 v[96:99], v[32:35], v[20:23], 0
    v_mfma_f32_16x16x32_bf16 v[100:103], v[36:39], v[20:23], 0
    s_waitcnt vmcnt(10)
    ds_read_b64_tr_b16 v[40:41], v27 offset:2048
    ds_read_b64_tr_b16 v[42:43], v27 offset:2560
    ds_read_b64_tr_b16 v[44:45], v28 offset:2048
    ds_read_b64_tr_b16 v[46:47], v28 offset:2560
    s_waitcnt lgkmcnt(0)
    v_mfma_f32_16x16x32_bf16 v[96:99], v[40:43], v[20:23], v[96:99]
    v_mfma_f32_16x16x32_bf16 v[100:103], v[44:47], v[20:23], v[100:103]
    s_waitcnt vmcnt(8)
    ds_read_b64_tr_b16 v[48:49], v27 offset:4096
    ds_read_b64_tr_b16 v[50:51], v27 offset:4608
    ds_read_b64_tr_b16 v[52:53], v28 offset:4096
    ds_read_b64_tr_b16 v[54:55], v28 offset:4608
    s_waitcnt lgkmcnt(0)
    v_mfma_f32_16x16x32_bf16 v[96:99], v[48:51], v[20:23], v[96:99]
    v_mfma_f32_16x16x32_bf16 v[100:103], v[52:55], v[20:23], v[100:103]
    s_waitcnt vmcnt(6)
    ds_read_b64_tr_b16 v[56:57], v27 offset:6144
    ds_read_b64_tr_b16 v[58:59], v27 offset:6656
    ds_read_b64_tr_b16 v[60:61], v28 offset:6144
    ds_read_b64_tr_b16 v[62:63], v28 offset:6656
    s_waitcnt lgkmcnt(0)
    v_mfma_f32_16x16x32_bf16 v[96:99], v[56:59], v[20:23], v[96:99]
    v_mfma_f32_16x16x32_bf16 v[100:103], v[60:63], v[20:23], v[100:103]
    s_waitcnt vmcnt(4)
    ds_read_b64_tr_b16 v[64:65], v27 offset:8192
    ds_read_b64_tr_b16 v[66:67], v27 offset:8704
    ds_read_b64_tr_b16 v[68:69], v28 offset:8192
    ds_read_b64_tr_b16 v[70:71], v28 offset:8704
    s_waitcnt lgkmcnt(0)
    v_mfma_f32_16x16x32_bf16 v[96:99], v[64:67], v[20:23], v[96:99]
    v_mfma_f32_16x16x32_bf16 v[100:103], v[68:71], v[20:23], v[100:103]
    s_waitcnt vmcnt(2)
    ds_read_b64_tr_b16 v[72:73], v27 offset:10240
    ds_read_b64_tr_b16 v[74:75], v27 offset:10752
    ds_read_b64_tr_b16 v[76:77], v28 offset:10240
    ds_read_b64_tr_b16 v[78:79], v28 offset:10752
    s_waitcnt lgkmcnt(0)
    v_mfma_f32_16x16x32_bf16 v[96:99], v[72:75], v[20:23], v[96:99]
    v_mfma_f32_16x16x32_bf16 v[100:103], v[76:79], v[20:23], v[100:103]
    s_waitcnt vmcnt(0)
    ds_read_b64_tr_b16 v[80:81], v27 offset:12288
    ds_read_b64_tr_b16 v[82:83], v27 offset:12800
    ds_read_b64_tr_b16 v[84:85], v28 offset:12288
    ds_read_b64_tr_b16 v[86:87], v28 offset:12800
    s_waitcnt lgkmcnt(0)
    v_mfma_f32_16x16x32_bf16 v[96:99], v[80:83], v[20:23], v[96:99]
    v_mfma_f32_16x16x32_bf16 v[100:103], v[84:87], v[20:23], v[100:103]
    s_lshl_b32 s68, s61, 8
    s_add_u32 s68, s68, 158720
    v_and_b32 v13, 15, v1
    v_cmp_gt_u32 vcc, 2, v13
    v_lshlrev_b32 v13, 6, v13
    v_and_b32 v14, 48, v1
    v_add3_u32 v13, v13, v14, s68
    s_mov_b64 exec, vcc
    ds_write_b128 v13, v[96:99]
    ds_write_b128 v13, v[100:103] offset:128
    s_mov_b64 exec, -1
    s_mov_b64 exec, 1
    ds_add_u32 v18, v17 offset:0
    s_mov_b64 exec, -1
    s_cmp_lg_u32 s61, 0
    s_cbranch_scc1 L_nocs_92
    s_mov_b32 s70, 0
L_lw_94:
    ds_read_b32 v15, v18 offset:0
    s_add_u32 s70, s70, 1
    s_cmp_gt_u32 s70, 3200000
    s_cbranch_scc1 L_END
    s_waitcnt lgkmcnt(0)
    v_readfirstlane_b32 s68, v15
    s_nop 1
    s_cmp_ge_u32 s68, 8
    s_cbranch_scc0 L_lw_94
    v_lshlrev_b32 v13, 2, v1
    v_add_u32 v14, 158720, v13
    ds_read_b32 v32, v14 offset:0
    ds_read_b32 v33, v14 offset:256
    ds_read_b32 v34, v14 offset:512
    ds_read_b32 v35, v14 offset:768
    s_lshl_b32 s65, s4, 8
    s_add_u32 s65, s65, 458752
    s_waitcnt lgkmcnt(0)
    v_add_f32 v32, v32, v33
    v_add_f32 v34, v34, v35
    v_add_f32 v32, v32, v34
    buffer_store_dword v32, v13, s[44:47], s65 offen sc1
    s_add_u32 s65, s80, 1920
    v_mov_b32 v13, 0
    s_waitcnt vmcnt(0)
    s_mov_b64 exec, 1
    buffer_store_dword v17, v13, s[44:47], s65 offen sc1
    s_mov_b64 exec, -1
L_nocs_92:
    s_mov_b64 exec, 1
    ds_add_u32 v18, v17 offset:64
    s_mov_b64 exec, -1
    s_lshl_b32 s64, s4, 2
    s_add_u32 s64, s64, s61
    s_mul_i32 s65, s64, 12544
    v_lshlrev_b32 v13, 7, v1
    buffer_load_dword v31, v13, s[32:35], s65 offen sc1
    s_add_u32 s65, s65, 8192
    s_mov_b32 exec_hi, 0x3
    buffer_load_dword v31, v13, s[32:35], s65 offen sc1
    s_mov_b64 exec, -1
    s_mul_i32 s65, s64, 3200
    v_lshlrev_b32 v13, 7, v1
    s_mov_b64 exec, 0x1ffffff
    buffer_load_dword v31, v13, s[16:19], s65 offen sc1
    s_mov_b64 exec, -1
    s_cmp_eq_u32 s82, 0
    s_cbranch_scc1 L_pl_95
    v_lshlrev_b32 v13, 7, v1
    s_lshl_b32 s65, s61, 13
    s_add_u32 s65, s65, s60
    s_add_u32 s66, s65, 114688
    buffer_load_dword v31, v13, s[44:47], s66 offen sc1
    s_waitcnt vmcnt(1)
L_pp_96:
    s_cmp_ge_u32 s61, 3
    s_cbranch_scc1 L_pp_97
    s_add_u32 s66, s65, 147456
    buffer_load_dword v31, v13, s[44:47], s66 offen sc1
    s_waitcnt vmcnt(1)
L_pp_97:
L_pl_95:
    s_endpgm
L_role_A:
    s_cmp_eq_u32 s81, 1
    s_cbranch_scc1 L_a_kvcopy
    s_lshl_b32 s64, s61, 10
    s_mul_i32 s66, s61, 7168
    s_lshl_b32 s65, s5, 7
    s_add_u32 s66, s66, s65
    s_add_u32 m0, s64, 0
    s_add_u32 s65, s66, 0
    buffer_load_dwordx4 v11, s[20:23], s65 offen lds
    s_add_u32 m0, s64, 4096
    s_add_u32 s65, s66, 28672
    buffer_load_dwordx4 v11, s[20:23], s65 offen lds
    s_add_u32 m0, s64, 8192
    s_add_u32 s65, s66, 57344
    buffer_load_dwordx4 v11, s[20:23], s65 offen lds
    s_add_u32 m0, s64, 12288
    s_add_u32 s65, s66, 86016
    buffer_load_dwordx4 v11, s[20:23], s65 offen lds
    s_add_u32 m0, s64, 16384
    s_add_u32 s65, s66, 114688
    buffer_load_dwordx4 v11, s[20:23], s65 offen lds
    s_add_u32 m0, s64, 20480
    s_add_u32 s65, s66, 143360
    buffer_load_dwordx4 v11, s[20:23], s65 offen lds
    s_add_u32 m0, s64, 24576
    s_add_u32 s65, s66, 172032
    buffer_load_dwordx4 v11, s[20:23], s65 offen lds
    s_add_u32 m0, s64, 28672
    s_add_u32 s65, s66, 200704
    buffer_load_dwordx4 v11, s[20:23], s65 offen lds
    s_add_u32 m0, s64, 32768
    s_add_u32 s65, s66, 229376
    buffer_load_dwordx4 v11, s[20:23], s65 offen lds
    s_add_u32 m0, s64, 36864
    s_add_u32 s65, s66, 258048
    buffer_load_dwordx4 v11, s[20:23], s65 offen lds
    s_add_u32 m0, s64, 40960
    s_add_u32 s65, s66, 286720
    buffer_load_dwordx4 v11, s[20:23], s65 offen lds
    s_add_u32 m0, s64, 45056
    s_add_u32 s65, s66, 315392
    buffer_load_dwordx4 v11, s[20:23], s65 offen lds
    s_add_u32 m0, s64, 49152
    s_add_u32 s65, s66, 344064
    buffer_load_dwordx4 v11, s[20:23], s65 offen lds
    s_add_u32 m0, s64, 53248
    s_add_u32 s65, s66, 372736
    buffer_load_dwordx4 v11, s[20:23], s65 offen lds
    s_branch L_a_copied
L_a_kvcopy:
    s_mov_b32 s58, 25088
    s_add_u32 s65, s61, 0
    s_min_u32 s65, s65, 13
    s_cmp_ge_u32 s65, 7
    s_cselect_b64 s[56:57], s[52:53], s[48:49]
    s_cselect_b32 s66, 7, 0
    s_cselect_b32 s67, 25088, 0
    s_sub_u32 s65, s65, s66
    s_lshl_b32 s65, s65, 10
    s_add_u32 s65, s65, 0
    s_add_u32 s67, s67, s65
    s_add_u32 m0, s67, 0
    s_nop 0
    buffer_load_dwordx4 v2, s[56:59], s65 offen lds
    s_add_u32 s65, s61, 4
    s_min_u32 s65, s65, 13
    s_cmp_ge_u32 s65, 7
    s_cselect_b64 s[56:57], s[52:53], s[48:49]
    s_cselect_b32 s66, 7, 0
    s_cselect_b32 s67, 25088, 0
    s_sub_u32 s65, s65, s66
    s_lshl_b32 s65, s65, 10
    s_add_u32 s65, s65, 0
    s_add_u32 s67, s67, s65
    s_add_u32 m0, s67, 0
    s_nop 0
    buffer_load_dwordx4 v2, s[56:59], s65 offen lds
    s_add_u32 s65, s61, 8
    s_min_u32 s65, s65, 13
    s_cmp_ge_u32 s65, 7
    s_cselect_b64 s[56:57], s[52:53], s[48:49]
    s_cselect_b32 s66, 7, 0
    s_cselect_b32 s67, 25088, 0
    s_sub_u32 s65, s65, s66
    s_lshl_b32 s65, s65, 10
    s_add_u32 s65, s65, 0
    s_add_u32 s67, s67, s65
    s_add_u32 m0, s67, 0
    s_nop 0
    buffer_load_dwordx4 v2, s[56:59], s65 offen lds
    s_add_u32 s65, s61, 12
    s_min_u32 s65, s65, 13
    s_cmp_ge_u32 s65, 7
    s_cselect_b64 s[56:57], s[52:53], s[48:49]
    s_cselect_b32 s66, 7, 0
    s_cselect_b32 s67, 25088, 0
    s_sub_u32 s65, s65, s66
    s_lshl_b32 s65, s65, 10
    s_add_u32 s65, s65, 0
    s_add_u32 s67, s67, s65
    s_add_u32 m0, s67, 0
    s_nop 0
    buffer_load_dwordx4 v2, s[56:59], s65 offen lds
    s_add_u32 s65, s61, 0
    s_min_u32 s65, s65, 13
    s_cmp_ge_u32 s65, 7
    s_cselect_b64 s[56:57], s[52:53], s[48:49]
    s_cselect_b32 s66, 7, 0
    s_cselect_b32 s67, 25088, 0
    s_sub_u32 s65, s65, s66
    s_lshl_b32 s65, s65, 10
    s_add_u32 s65, s65, 7168
    s_add_u32 s67, s67, s65
    s_add_u32 m0, s67, 0
    s_nop 0
    buffer_load_dwordx4 v2, s[56:59], s65 offen lds
    s_add_u32 s65, s61, 4
    s_min_u32 s65, s65, 13
    s_cmp_ge_u32 s65, 7
    s_cselect_b64 s[56:57], s[52:53], s[48:49]
    s_cselect_b32 s66, 7, 0
    s_cselect_b32 s67, 25088, 0
    s_sub_u32 s65, s65, s66
    s_lshl_b32 s65, s65, 10
    s_add_u32 s65, s65, 7168
    s_add_u32 s67, s67, s65
    s_add_u32 m0, s67, 0
    s_nop 0
    buffer_load_dwordx4 v2, s[56:59], s65 offen lds
    s_add_u32 s65, s61, 8
    s_min_u32 s65, s65, 13
    s_cmp_ge_u32 s65, 7
    s_cselect_b64 s[56:57], s[52:53], s[48:49]
    s_cselect_b32 s66, 7, 0
    s_cselect_b32 s67, 25088, 0
    s_sub_u32 s65, s65, s66
    s_lshl_b32 s65, s65, 10
    s_add_u32 s65, s65, 7168
    s_add_u32 s67, s67, s65
    s_add_u32 m0, s67, 0
    s_nop 0
    buffer_load_dwordx4 v2, s[56:59], s65 offen lds
    s_add_u32 s65, s61, 12
    s_min_u32 s65, s65, 13
    s_cmp_ge_u32 s65, 7
    s_cselect_b64 s[56:57], s[52:53], s[48:49]
    s_cselect_b32 s66, 7, 0
    s_cselect_b32 s67, 25088, 0
    s_sub_u32 s65, s65, s66
    s_lshl_b32 s65, s65, 10
    s_add_u32 s65, s65, 7168
    s_add_u32 s67, s67, s65
    s_add_u32 m0, s67, 0
    s_nop 0
    buffer_load_dwordx4 v2, s[56:59], s65 offen lds
    s_add_u32 s65, s61, 0
    s_min_u32 s65, s65, 13
    s_cmp_ge_u32 s65, 7
    s_cselect_b64 s[56:57], s[52:53], s[48:49]
    s_cselect_b32 s66, 7, 0
    s_cselect_b32 s67, 25088, 0
    s_sub_u32 s65, s65, s66
    s_lshl_b32 s65, s65, 10
    s_add_u32 s65, s65, 14336
    s_add_u32 s67, s67, s65
    s_add_u32 m0, s67, 0
    s_nop 0
    buffer_load_dwordx4 v2, s[56:59], s65 offen lds
    s_add_u32 s65, s61, 4
    s_min_u32 s65, s65, 13
    s_cmp_ge_u32 s65, 7
    s_cselect_b64 s[56:57], s[52:53], s[48:49]
    s_cselect_b32 s66, 7, 0
    s_cselect_b32 s67, 25088, 0
    s_sub_u32 s65, s65, s66
    s_lshl_b32 s65, s65, 10
    s_add_u32 s65, s65, 14336
    s_add_u32 s67, s67, s65
    s_add_u32 m0, s67, 0
    s_nop 0
    buffer_load_dwordx4 v2, s[56:59], s65 offen lds
    s_add_u32 s65, s61, 8
    s_min_u32 s65, s65, 13
    s_cmp_ge_u32 s65, 7
    s_cselect_b64 s[56:57], s[52:53], s[48:49]
    s_cselect_b32 s66, 7, 0
    s_cselect_b32 s67, 25088, 0
    s_sub_u32 s65, s65, s66
    s_lshl_b32 s65, s65, 10
    s_add_u32 s65, s65, 14336
    s_add_u32 s67, s67, s65
    s_add_u32 m0, s67, 0
    s_nop 0
    buffer_load_dwordx4 v2, s[56:59], s65 offen lds
    s_add_u32 s65, s61, 12
    s_min_u32 s65, s65, 13
    s_cmp_ge_u32 s65, 7
    s_cselect_b64 s[56:57], s[52:53], s[48:49]
    s_cselect_b32 s66, 7, 0
    s_cselect_b32 s67, 25088, 0
    s_sub_u32 s65, s65, s66
    s_lshl_b32 s65, s65, 10
    s_add_u32 s65, s65, 14336
    s_add_u32 s67, s67, s65
    s_add_u32 m0, s67, 0
    s_nop 0
    buffer_load_dwordx4 v2, s[56:59], s65 offen lds
    s_lshl_b32 s65, s61, 10
    s_add_u32 s65, s65, 21504
    s_add_u32 m0, s65, 0
    s_cmp_eq_u32 s61, 3
    s_cselect_b32 exec_hi, 0, -1
    buffer_load_dwordx4 v2, s[48:51], s65 offen lds
    s_add_u32 m0, m0, 25088
    s_nop 0
    buffer_load_dwordx4 v2, s[52:55], s65 offen lds
    s_mov_b32 exec_hi, -1
L_a_copied:
    s_waitcnt vmcnt(14)
    s_barrier
    v_lshl_add_u32 v25, s61, 6, v1
    s_mul_i32 s74, s81, 41984
    s_add_u32 s74, s74, 8192
    v_mul_u32_u24 v13, 9363, v25
    v_lshrrev_b32 v13, 16, v13
    v_mul_u32_u24 v14, 7, v13
    v_sub_u32 v14, v25, v14
    v_and_b32 v15, 3, v13
    v_bfe_u32 v16, v13, 2, 2
    v_and_b32 v13, 48, v13
    v_lshl_add_u32 v13, v15, 2, v13
    v_add_u32 v13, v13, v16
    v_mul_u32_u24 v13, 896, v13
    v_lshl_add_u32 v24, v14, 4, v13
    s_mul_i32 s68, s5, 112
    v_add_u32 v24, s68, v24
    v_add_u32 v25, 256, v25
    v_mul_u32_u24 v13, 9363, v25
    v_lshrrev_b32 v13, 16, v13
    v_mul_u32_u24 v14, 7, v13
    v_sub_u32 v14, v25, v14
    v_and_b32 v15, 3, v13
    v_bfe_u32 v16, v13, 2, 2
    v_and_b32 v13, 48, v13
    v_lshl_add_u32 v13, v15, 2, v13
    v_add_u32 v13, v13, v16
    v_mul_u32_u24 v13, 896, v13
    v_lshl_add_u32 v25, v14, 4, v13
    s_mul_i32 s68, s5, 112
    v_add_u32 v25, s68, v25
    s_add_u32 s64, s61, 4
    s_cmp_eq_u32 s61, 3
    s_cbranch_scc1 L_a_wq3
    s_lshl_b32 s65, s61, 10
    s_add_u32 m0, s65, 115712
    s_mov_b32 s66, 0
    buffer_load_dwordx4 v24, s[12:15], s66 offen lds
    s_lshl_b32 s65, s64, 10
    s_add_u32 m0, s65, 115712
    s_mov_b32 s66, 0
    buffer_load_dwordx4 v25, s[12:15], s66 offen lds
    s_waitcnt vmcnt(12)
    s_mov_b64 exec, 1
    ds_add_u32 v18, v17 offset:92
    s_mov_b64 exec, -1
    s_lshl_b32 s65, s61, 10
    s_add_u32 m0, s65, 122880
    s_mov_b32 s66, 57344
    buffer_load_dwordx4 v24, s[12:15], s66 offen lds
    s_lshl_b32 s65, s64, 10
    s_add_u32 m0, s65, 122880
    s_mov_b32 s66, 57344
    buffer_load_dwordx4 v25, s[12:15], s66 offen lds
    s_waitcnt vmcnt(10)
    s_mov_b64 exec, 1
    ds_add_u32 v18, v17 offset:96
    s_mov_b64 exec, -1
    s_lshl_b32 s65, s61, 10
    s_add_u32 m0, s65, 130048
    s_mov_b32 s66, 114688
    buffer_load_dwordx4 v24, s[12:15], s66 offen lds
    s_lshl_b32 s65, s64, 10
    s_add_u32 m0, s65, 130048
    s_mov_b32 s66, 114688
    buffer_load_dwordx4 v25, s[12:15], s66 offen lds
    s_waitcnt vmcnt(8)
    s_mov_b64 exec, 1
    ds_add_u32 v18, v17 offset:100
    s_mov_b64 exec, -1
    s_lshl_b32 s65, s61, 10
    s_add_u32 m0, s65, 137216
    s_mov_b32 s66, 172032
    buffer_load_dwordx4 v24, s[12:15], s66 offen lds
    s_waitcnt vmcnt(7)
    s_mov_b64 exec, 1
    ds_add_u32 v18, v17 offset:104
    s_mov_b64 exec, -1
    s_lshl_b32 s65, s64, 10
    s_add_u32 m0, s65, 137216
    s_mov_b32 s66, 172032
    buffer_load_dwordx4 v25, s[12:15], s66 offen lds
    s_lshl_b32 s65, s61, 10
    s_add_u32 m0, s65, 144384
    s_mov_b32 s66, 229376
    buffer_load_dwordx4 v24, s[12:15], s66 offen lds
    s_lshl_b32 s65, s64, 10
    s_add_u32 m0, s65, 144384
    s_mov_b32 s66, 229376
    buffer_load_dwordx4 v25, s[12:15], s66 offen lds
    s_lshl_b32 s65, s61, 10
    s_add_u32 m0, s65, 151552
    s_mov_b32 s66, 286720
    buffer_load_dwordx4 v24, s[12:15], s66 offen lds
    s_lshl_b32 s65, s64, 10
    s_add_u32 m0, s65, 151552
    s_mov_b32 s66, 286720
    buffer_load_dwordx4 v25, s[12:15], s66 offen lds
    v_lshl_add_u32 v8, s62, 5, v3
    v_mul_u32_u24 v8, 912, v8
    v_lshl_add_u32 v8, v4, 4, v8
    v_add_u32 v8, 57344, v8
    v_bfe_u32 v13, v1, 2, 2
    v_and_b32 v14, 3, v1
    v_bfe_u32 v15, v1, 4, 1
    v_lshlrev_b32 v14, 3, v14
    v_lshl_add_u32 v14, v15, 5, v14
    v_and_b32 v16, 1, v1
    v_cmp_eq_u32 vcc, v16, v15
    v_mov_b32 v16, 1065369472
    s_nop 0
    v_cndmask_b32 v20, 0, v16, vcc
    v_cndmask_b32 v21, 0, v16, vcc
    v_cndmask_b32 v22, 0, v16, vcc
    v_cndmask_b32 v23, 0, v16, vcc
    v_lshlrev_b32 v16, 1, v4
    v_lshl_add_u32 v16, v13, 2, v16
    v_mul_u32_u24 v9, 112, v16
    v_add_u32 v9, v9, v14
    v_cmp_le_u32 vcc, 56, v14
    s_lshl_b32 s66, s63, 5
    v_mov_b32 v13, s66
    v_cndmask_b32 v13, 0, v13, vcc
    v_sub_u32 v9, v9, v13
    s_mul_i32 s65, s63, 56
    s_add_u32 s66, s65, s74
    v_add_u32 v10, s66, v9
    s_add_u32 s66, s65, 115712
    v_add_u32 v9, s66, v9
    s_lshl_b32 s75, s61, 10
    s_mul_i32 s78, s61, 7168
    s_lshl_b32 s65, s5, 7
    s_add_u32 s78, s78, s65
    s_mov_b32 s70, 0
L_lw_98:
    ds_read_b32 v15, v18 offset:108
    s_add_u32 s70, s70, 1
    s_cmp_gt_u32 s70, 3200000
    s_cbranch_scc1 L_END
    s_waitcnt lgkmcnt(0)
    v_readfirstlane_b32 s68, v15
    s_nop 1
    s_cmp_ge_u32 s68, 4
    s_cbranch_scc0 L_lw_98
    s_lshl_b32 s65, s61, 10
    s_add_u32 m0, s65, s74
    s_mov_b32 s66, 344064
    buffer_load_dwordx4 v24, s[12:15], s66 offen lds
    s_lshl_b32 s65, s64, 10
    s_add_u32 m0, s65, s74
    s_mov_b32 s66, 344064
    buffer_load_dwordx4 v25, s[12:15], s66 offen lds
    ds_read_b128 v[32:35], v8 offset:0
    ds_read_b128 v[36:39], v8 offset:32
    ds_read_b128 v[40:43], v8 offset:64
    ds_read_b128 v[44:47], v8 offset:96
    ds_read_b128 v[48:51], v8 offset:128
    ds_read_b128 v[52:55], v8 offset:160
    ds_read_b128 v[56:59], v8 offset:192
    ds_read_b128 v[60:63], v8 offset:224
    s_mov_b32 s70, 0
L_lw_99:
    ds_read_b32 v15, v18 offset:112
    s_add_u32 s70, s70, 1
    s_cmp_gt_u32 s70, 3200000
    s_cbranch_scc1 L_END
    s_waitcnt lgkmcnt(0)
    v_readfirstlane_b32 s68, v15
    s_nop 1
    s_cmp_ge_u32 s68, 4
    s_cbranch_scc0 L_lw_99
    s_cmp_eq_u32 s81, 1
    s_cbranch_scc1 L_w2p_100
    s_add_u32 m0, s75, 0
    s_add_u32 s65, s78, 0
    buffer_load_dwordx4 v11, s[24:27], s65 offen lds
    s_add_u32 m0, s75, 4096
    s_add_u32 s65, s78, 28672
    buffer_load_dwordx4 v11, s[24:27], s65 offen lds
    s_add_u32 m0, s75, 16384
    s_add_u32 s65, s78, 114688
    buffer_load_dwordx4 v11, s[24:27], s65 offen lds
    s_add_u32 m0, s75, 20480
    s_add_u32 s65, s78, 143360
    buffer_load_dwordx4 v11, s[24:27], s65 offen lds
    s_add_u32 m0, s75, 24576
    s_add_u32 s65, s78, 172032
    buffer_load_dwordx4 v11, s[24:27], s65 offen lds
    s_add_u32 m0, s75, 28672
    s_add_u32 s65, s78, 200704
    buffer_load_dwordx4 v11, s[24:27], s65 offen lds
L_w2p_100:
    s_cmp_eq_u32 s81, 1
    s_cbranch_scc1 L_kw_101
    s_waitcnt vmcnt(10)
    s_branch L_kwe_102
L_kw_101:
    s_waitcnt vmcnt(4)
L_kwe_102:
    s_branch L_a_wqin
L_a_wq3:
    s_lshl_b32 s65, s61, 10
    s_add_u32 m0, s65, 115712
    s_mov_b32 s66, 0
    buffer_load_dwordx4 v24, s[12:15], s66 offen lds
    s_waitcnt vmcnt(11)
    s_mov_b64 exec, 1
    ds_add_u32 v18, v17 offset:92
    s_mov_b64 exec, -1
    s_lshl_b32 s65, s61, 10
    s_add_u32 m0, s65, 122880
    s_mov_b32 s66, 57344
    buffer_load_dwordx4 v24, s[12:15], s66 offen lds
    s_waitcnt vmcnt(8)
    s_mov_b64 exec, 1
    ds_add_u32 v18, v17 offset:96
    s_mov_b64 exec, -1
    s_lshl_b32 s65, s61, 10
    s_add_u32 m0, s65, 130048
    s_mov_b32 s66, 114688
    buffer_load_dwordx4 v24, s[12:15], s66 offen lds
    s_waitcnt vmcnt(5)
    s_mov_b64 exec, 1
    ds_add_u32 v18, v17 offset:100
    s_mov_b64 exec, -1
    s_lshl_b32 s65, s61, 10
    s_add_u32 m0, s65, 137216
    s_mov_b32 s66, 172032
    buffer_load_dwordx4 v24, s[12:15], s66 offen lds
    s_waitcnt vmcnt(4)
    s_mov_b64 exec, 1
    ds_add_u32 v18, v17 offset:104
    s_mov_b64 exec, -1
    s_lshl_b32 s65, s61, 10
    s_add_u32 m0, s65, 144384
    s_mov_b32 s66, 229376
    buffer_load_dwordx4 v24, s[12:15], s66 offen lds
    s_lshl_b32 s65, s61, 10
    s_add_u32 m0, s65, 151552
    s_mov_b32 s66, 286720
    buffer_load_dwordx4 v24, s[12:15], s66 offen lds
    v_lshl_add_u32 v8, s62, 5, v3
    v_mul_u32_u24 v8, 912, v8
    v_lshl_add_u32 v8, v4, 4, v8
    v_add_u32 v8, 57344, v8
    v_bfe_u32 v13, v1, 2, 2
    v_and_b32 v14, 3, v1
    v_bfe_u32 v15, v1, 4, 1
    v_lshlrev_b32 v14, 3, v14
    v_lshl_add_u32 v14, v15, 5, v14
    v_and_b32 v16, 1, v1
    v_cmp_eq_u32 vcc, v16, v15
    v_mov_b32 v16, 1065369472
    s_nop 0
    v_cndmask_b32 v20, 0, v16, vcc
    v_cndmask_b32 v21, 0, v16, vcc
    v_cndmask_b32 v22, 0, v16, vcc
    v_cndmask_b32 v23, 0, v16, vcc
    v_lshlrev_b32 v16, 1, v4
    v_lshl_add_u32 v16, v13, 2, v16
    v_mul_u32_u24 v9, 112, v16
    v_add_u32 v9, v9, v14
    v_cmp_le_u32 vcc, 56, v14
    s_lshl_b32 s66, s63, 5
    v_mov_b32 v13, s66
    v_cndmask_b32 v13, 0, v13, vcc
    v_sub_u32 v9, v9, v13
    s_mul_i32 s65, s63, 56
    s_add_u32 s66, s65, s74
    v_add_u32 v10, s66, v9
    s_add_u32 s66, s65, 115712
    v_add_u32 v9, s66, v9
    s_lshl_b32 s75, s61, 10
    s_mul_i32 s78, s61, 7168
    s_lshl_b32 s65, s5, 7
    s_add_u32 s78, s78, s65
    s_mov_b32 s70, 0
L_lw_103:
    ds_read_b32 v15, v18 offset:108
    s_add_u32 s70, s70, 1
    s_cmp_gt_u32 s70, 3200000
    s_cbranch_scc1 L_END
    s_waitcnt lgkmcnt(0)
    v_readfirstlane_b32 s68, v15
    s_nop 1
    s_cmp_ge_u32 s68, 4
    s_cbranch_scc0 L_lw_103
    s_lshl_b32 s65, s61, 10
    s_add_u32 m0, s65, s74
    s_mov_b32 s66, 344064
    buffer_load_dwordx4 v24, s[12:15], s66 offen lds
    ds_read_b128 v[32:35], v8 offset:0
    ds_read_b128 v[36:39], v8 offset:32
    ds_read_b128 v[40:43], v8 offset:64
    ds_read_b128 v[44:47], v8 offset:96
    ds_read_b128 v[48:51], v8 offset:128
    ds_read_b128 v[52:55], v8 offset:160
    ds_read_b128 v[56:59], v8 offset:192
    ds_read_b128 v[60:63], v8 offset:224
    s_mov_b32 s70, 0
L_lw_104:
    ds_read_b32 v15, v18 offset:112
    s_add_u32 s70, s70, 1
    s_cmp_gt_u32 s70, 3200000
    s_cbranch_scc1 L_END
    s_waitcnt lgkmcnt(0)
    v_readfirstlane_b32 s68, v15
    s_nop 1
    s_cmp_ge_u32 s68, 4
    s_cbranch_scc0 L_lw_104
    s_cmp_eq_u32 s81, 1
    s_cbranch_scc1 L_w2p_105
    s_add_u32 m0, s75, 0
    s_add_u32 s65, s78, 0
    buffer_load_dwordx4 v11, s[24:27], s65 offen lds
    s_add_u32 m0, s75, 4096
    s_add_u32 s65, s78, 28672
    buffer_load_dwordx4 v11, s[24:27], s65 offen lds
    s_add_u32 m0, s75, 16384
    s_add_u32 s65, s78, 114688
    buffer_load_dwordx4 v11, s[24:27], s65 offen lds
    s_add_u32 m0, s75, 20480
    s_add_u32 s65, s78, 143360
    buffer_load_dwordx4 v11, s[24:27], s65 offen lds
    s_add_u32 m0, s75, 24576
    s_add_u32 s65, s78, 172032
    buffer_load_dwordx4 v11, s[24:27], s65 offen lds
    s_add_u32 m0, s75, 28672
    s_add_u32 s65, s78, 200704
    buffer_load_dwordx4 v11, s[24:27], s65 offen lds
L_w2p_105:
    s_cmp_eq_u32 s81, 1
    s_cbranch_scc1 L_kw_106
    s_waitcnt vmcnt(8)
    s_branch L_kwe_107
L_kw_106:
    s_waitcnt vmcnt(2)
L_kwe_107:
L_a_wqin:
    s_mov_b64 exec, 1
    ds_add_u32 v18, v17 offset:4
    s_mov_b64 exec, -1
    s_mov_b32 s70, 0
L_lw_108:
    ds_read_b32 v15, v18 offset:116
    s_add_u32 s70, s70, 1
    s_cmp_gt_u32 s70, 3200000
    s_cbranch_scc1 L_END
    s_waitcnt lgkmcnt(0)
    v_readfirstlane_b32 s68, v15
    s_nop 1
    s_cmp_ge_u32 s68, 4
    s_cbranch_scc0 L_lw_108
    v_lshl_add_u32 v13, s62, 5, v3
    v_lshlrev_b32 v13, 3, v13
    v_add_u32 v13, 158720, v13
    ds_read_b64 v[136:137], v13
    ds_read_b64 v[138:139], v13 offset:512
    s_mov_b32 s70, 0
L_lw_109:
    ds_read_b32 v15, v18 offset:4
    s_add_u32 s70, s70, 1
    s_cmp_gt_u32 s70, 3200000
    s_cbranch_scc1 L_END
    s_waitcnt lgkmcnt(0)
    v_readfirstlane_b32 s68, v15
    s_nop 1
    s_cmp_ge_u32 s68, 4
    s_cbranch_scc0 L_lw_109
    s_setprio 1
    ds_read_b64_tr_b16 v[64:65], v9 offset:0
    ds_read_b64_tr_b16 v[66:67], v9 offset:112
    ds_read_b64_tr_b16 v[68:69], v9 offset:1792
    ds_read_b64_tr_b16 v[70:71], v9 offset:1904
    ds_read_b64_tr_b16 v[72:73], v9 offset:3584
    ds_read_b64_tr_b16 v[74:75], v9 offset:3696
    ds_read_b64_tr_b16 v[76:77], v9 offset:5376
    ds_read_b64_tr_b16 v[78:79], v9 offset:5488
    s_waitcnt lgkmcnt(6)
    v_mfma_f32_32x32x16_bf16 v[96:111], v[64:67], v[32:35], 0
    ds_read_b64_tr_b16 v[80:81], v9 offset:7168
    ds_read_b64_tr_b16 v[82:83], v9 offset:7280
    v_mfma_f32_16x16x32_bf16 v[112:115], v[64:67], v[20:23], 0
    s_waitcnt lgkmcnt(6)
    v_mfma_f32_32x32x16_bf16 v[96:111], v[68:71], v[36:39], v[96:111]
    ds_read_b64_tr_b16 v[84:85], v9 offset:8960
    ds_read_b64_tr_b16 v[86:87], v9 offset:9072
    v_mfma_f32_16x16x32_bf16 v[112:115], v[68:71], v[20:23], v[112:115]
    v_add_f32 v136, v136, v138
    v_add_f32 v137, v137, v139
    v_mul_f32 v5, 0x3b124925, v136
    v_mul_f32 v137, 0x3b124925, v137
    v_fma_f32 v137, -v5, v5, v137
    v_max_f32 v137, 0, v137
    v_add_f32 v138, 0x3727c5ac, v137
    v_rsq_f32 v6, v138
    s_nop 0
    v_mul_f32 v137, v137, v6
    v_fmaak_f32 v137, v137, v6, 0x3727c5ac
    v_rsq_f32 v137, v137
    s_nop 0
    v_mul_f32 v7, v6, v137
    s_waitcnt lgkmcnt(6)
    v_mfma_f32_32x32x16_bf16 v[96:111], v[72:75], v[40:43], v[96:111]
    ds_read_b64_tr_b16 v[88:89], v9 offset:10752
    ds_read_b64_tr_b16 v[90:91], v9 offset:10864
    v_mfma_f32_16x16x32_bf16 v[112:115], v[72:75], v[20:23], v[112:115]
    s_waitcnt lgkmcnt(6)
    v_mfma_f32_32x32x16_bf16 v[96:111], v[76:79], v[44:47], v[96:111]
    ds_read_b64_tr_b16 v[92:93], v9 offset:12544
    ds_read_b64_tr_b16 v[94:95], v9 offset:12656
    v_mfma_f32_16x16x32_bf16 v[112:115], v[76:79], v[20:23], v[112:115]
    s_waitcnt lgkmcnt(6)
    v_mfma_f32_32x32x16_bf16 v[96:111], v[80:83], v[48:51], v[96:111]
    ds_read_b64_tr_b16 v[64:65], v9 offset:14336
    ds_read_b64_tr_b16 v[66:67], v9 offset:14448
    ds_read_b128 v[32:35], v8 offset:256
    v_mfma_f32_16x16x32_bf16 v[112:115], v[80:83], v[20:23], v[112:115]
    s_waitcnt lgkmcnt(7)
    v_mfma_f32_32x32x16_bf16 v[96:111], v[84:87], v[52:55], v[96:111]
    ds_read_b64_tr_b16 v[68:69], v9 offset:16128
    ds_read_b64_tr_b16 v[70:71], v9 offset:16240
    ds_read_b128 v[36:39], v8 offset:288
    v_mfma_f32_16x16x32_bf16 v[112:115], v[84:87], v[20:23], v[112:115]
    s_waitcnt lgkmcnt(8)
    v_mfma_f32_32x32x16_bf16 v[96:111], v[88:91], v[56:59], v[96:111]
    ds_read_b64_tr_b16 v[72:73], v9 offset:17920
    ds_read_b64_tr_b16 v[74:75], v9 offset:18032
    ds_read_b128 v[40:43], v8 offset:320
    v_mfma_f32_16x16x32_bf16 v[112:115], v[88:91], v[20:23], v[112:115]
    s_waitcnt lgkmcnt(9)
    v_mfma_f32_32x32x16_bf16 v[96:111], v[92:95], v[60:63], v[96:111]
    ds_read_b64_tr_b16 v[76:77], v9 offset:19712
    ds_read_b64_tr_b16 v[78:79], v9 offset:19824
    ds_read_b128 v[44:47], v8 offset:352
    v_mfma_f32_16x16x32_bf16 v[112:115], v[92:95], v[20:23], v[112:115]
    s_waitcnt lgkmcnt(9)
    v_mfma_f32_32x32x16_bf16 v[96:111], v[64:67], v[32:35], v[96:111]
    ds_read_b64_tr_b16 v[80:81], v9 offset:21504
    ds_read_b64_tr_b16 v[82:83], v9 offset:21616
    ds_read_b128 v[48:51], v8 offset:384
    v_mfma_f32_16x16x32_bf16 v[112:115], v[64:67], v[20:23], v[112:115]
    s_waitcnt lgkmcnt(9)
    v_mfma_f32_32x32x16_bf16 v[96:111], v[68:71], v[36:39], v[96:111]
    ds_read_b64_tr_b16 v[84:85], v9 offset:23296
    ds_read_b64_tr_b16 v[86:87], v9 offset:23408
    ds_read_b128 v[52:55], v8 offset:416
    v_mfma_f32_16x16x32_bf16 v[112:115], v[68:71], v[20:23], v[112:115]
    s_waitcnt lgkmcnt(9)
    v_mfma_f32_32x32x16_bf16 v[96:111], v[72:75], v[40:43], v[96:111]
    ds_read_b64_tr_b16 v[88:89], v9 offset:25088
    ds_read_b64_tr_b16 v[90:91], v9 offset:25200
    ds_read_b128 v[56:59], v8 offset:448
    v_mfma_f32_16x16x32_bf16 v[112:115], v[72:75], v[20:23], v[112:115]
    s_waitcnt lgkmcnt(9)
    v_mfma_f32_32x32x16_bf16 v[96:111], v[76:79], v[44:47], v[96:111]
    ds_read_b64_tr_b16 v[92:93], v9 offset:26880
    ds_read_b64_tr_b16 v[94:95], v9 offset:26992
    ds_read_b128 v[60:63], v8 offset:480
    v_mfma_f32_16x16x32_bf16 v[112:115], v[76:79], v[20:23], v[112:115]
    s_waitcnt lgkmcnt(9)
    v_mfma_f32_32x32x16_bf16 v[96:111], v[80:83], v[48:51], v[96:111]
    ds_read_b64_tr_b16 v[64:65], v9 offset:28672
    ds_read_b64_tr_b16 v[66:67], v9 offset:28784
    ds_read_b128 v[32:35], v8 offset:512
    v_mfma_f32_16x16x32_bf16 v[112:115], v[80:83], v[20:23], v[112:115]
    s_waitcnt lgkmcnt(9)
    v_mfma_f32_32x32x16_bf16 v[96:111], v[84:87], v[52:55], v[96:111]
    ds_read_b64_tr_b16 v[68:69], v9 offset:30464
    ds_read_b64_tr_b16 v[70:71], v9 offset:30576
    ds_read_b128 v[36:39], v8 offset:544
    v_mfma_f32_16x16x32_bf16 v[112:115], v[84:87], v[20:23], v[112:115]
    s_cmp_eq_u32 s81, 1
    s_cbranch_scc1 L_kw_110
    s_waitcnt vmcnt(6)
    s_branch L_kwe_111
L_kw_110:
    s_waitcnt vmcnt(0)
L_kwe_111:
    s_mov_b64 exec, 1
    ds_add_u32 v18, v17 offset:4
    s_mov_b64 exec, -1
    s_waitcnt lgkmcnt(9)
    v_mfma_f32_32x32x16_bf16 v[96:111], v[88:91], v[56:59], v[96:111]
    ds_read_b64_tr_b16 v[72:73], v9 offset:32256
    ds_read_b64_tr_b16 v[74:75], v9 offset:32368
    ds_read_b128 v[40:43], v8 offset:576
    v_mfma_f32_16x16x32_bf16 v[112:115], v[88:91], v[20:23], v[112:115]
    s_waitcnt lgkmcnt(9)
    v_mfma_f32_32x32x16_bf16 v[96:111], v[92:95], v[60:63], v[96:111]
    ds_read_b64_tr_b16 v[76:77], v9 offset:34048
    ds_read_b64_tr_b16 v[78:79], v9 offset:34160
    ds_read_b128 v[44:47], v8 offset:608
    v_mfma_f32_16x16x32_bf16 v[112:115], v[92:95], v[20:23], v[112:115]
    s_mov_b32 s70, 0
L_lw_112:
    ds_read_b32 v15, v18 offset:4
    s_add_u32 s70, s70, 1
    s_cmp_gt_u32 s70, 3200000
    s_cbranch_scc1 L_END
    s_waitcnt lgkmcnt(0)
    v_readfirstlane_b32 s68, v15
    s_nop 1
    s_cmp_ge_u32 s68, 8
    s_cbranch_scc0 L_lw_112
    s_waitcnt lgkmcnt(9)
    v_mfma_f32_32x32x16_bf16 v[96:111], v[64:67], v[32:35], v[96:111]
    ds_read_b64_tr_b16 v[80:81], v9 offset:35840
    ds_read_b64_tr_b16 v[82:83], v9 offset:35952
    ds_read_b128 v[48:51], v8 offset:640
    v_mfma_f32_16x16x32_bf16 v[112:115], v[64:67], v[20:23], v[112:115]
    s_waitcnt lgkmcnt(9)
    v_mfma_f32_32x32x16_bf16 v[96:111], v[68:71], v[36:39], v[96:111]
    ds_read_b64_tr_b16 v[84:85], v9 offset:37632
    ds_read_b64_tr_b16 v[86:87], v9 offset:37744
    ds_read_b128 v[52:55], v8 offset:672
    v_mfma_f32_16x16x32_bf16 v[112:115], v[68:71], v[20:23], v[112:115]
    s_waitcnt lgkmcnt(9)
    v_mfma_f32_32x32x16_bf16 v[96:111], v[72:75], v[40:43], v[96:111]
    ds_read_b64_tr_b16 v[88:89], v9 offset:39424
    ds_read_b64_tr_b16 v[90:91], v9 offset:39536
    ds_read_b128 v[56:59], v8 offset:704
    v_mfma_f32_16x16x32_bf16 v[112:115], v[72:75], v[20:23], v[112:115]
    s_waitcnt lgkmcnt(9)
    v_mfma_f32_32x32x16_bf16 v[96:111], v[76:79], v[44:47], v[96:111]
    ds_read_b64_tr_b16 v[92:93], v9 offset:41216
    ds_read_b64_tr_b16 v[94:95], v9 offset:41328
    ds_read_b128 v[60:63], v8 offset:736
    v_mfma_f32_16x16x32_bf16 v[112:115], v[76:79], v[20:23], v[112:115]
    s_waitcnt lgkmcnt(9)
    v_mfma_f32_32x32x16_bf16 v[96:111], v[80:83], v[48:51], v[96:111]
    ds_read_b64_tr_b16 v[64:65], v10 offset:0
    ds_read_b64_tr_b16 v[66:67], v10 offset:112
    ds_read_b128 v[32:35], v8 offset:768
    v_mfma_f32_16x16x32_bf16 v[112:115], v[80:83], v[20:23], v[112:115]
    s_waitcnt lgkmcnt(9)
    v_mfma_f32_32x32x16_bf16 v[96:111], v[84:87], v[52:55], v[96:111]
    ds_read_b64_tr_b16 v[68:69], v10 offset:1792
    ds_read_b64_tr_b16 v[70:71], v10 offset:1904
    ds_read_b128 v[36:39], v8 offset:800
    v_mfma_f32_16x16x32_bf16 v[112:115], v[84:87], v[20:23], v[112:115]
    s_waitcnt lgkmcnt(9)
    v_mfma_f32_32x32x16_bf16 v[96:111], v[88:91], v[56:59], v[96:111]
    ds_read_b64_tr_b16 v[72:73], v10 offset:3584
    ds_read_b64_tr_b16 v[74:75], v10 offset:3696
    ds_read_b128 v[40:43], v8 offset:832
    v_mfma_f32_16x16x32_bf16 v[112:115], v[88:91], v[20:23], v[112:115]
    s_waitcnt lgkmcnt(9)
    v_mfma_f32_32x32x16_bf16 v[96:111], v[92:95], v[60:63], v[96:111]
    ds_read_b64_tr_b16 v[76:77], v10 offset:5376
    ds_read_b64_tr_b16 v[78:79], v10 offset:5488
    ds_read_b128 v[44:47], v8 offset:864
    v_mfma_f32_16x16x32_bf16 v[112:115], v[92:95], v[20:23], v[112:115]
    s_waitcnt lgkmcnt(9)
    v_mfma_f32_32x32x16_bf16 v[96:111], v[64:67], v[32:35], v[96:111]
    v_mfma_f32_16x16x32_bf16 v[112:115], v[64:67], v[20:23], v[112:115]
    s_waitcnt lgkmcnt(6)
    v_mfma_f32_32x32x16_bf16 v[96:111], v[68:71], v[36:39], v[96:111]
    v_mfma_f32_16x16x32_bf16 v[112:115], v[68:71], v[20:23], v[112:115]
    s_waitcnt lgkmcnt(3)
    v_mfma_f32_32x32x16_bf16 v[96:111], v[72:75], v[40:43], v[96:111]
    v_mfma_f32_16x16x32_bf16 v[112:115], v[72:75], v[20:23], v[112:115]
    s_waitcnt lgkmcnt(0)
    v_mfma_f32_32x32x16_bf16 v[96:111], v[76:79], v[44:47], v[96:111]
    v_mfma_f32_16x16x32_bf16 v[112:115], v[76:79], v[20:23], v[112:115]
    s_mov_b64 exec, 1
    ds_add_u32 v18, v17 offset:4
    s_mov_b64 exec, -1
    s_setprio 1
    s_mov_b32 s70, 0
L_lw_113:
    ds_read_b32 v15, v18 offset:0
    s_add_u32 s70, s70, 1
    s_cmp_gt_u32 s70, 3200000
    s_cbranch_scc1 L_END
    s_waitcnt lgkmcnt(0)
    v_readfirstlane_b32 s68, v15
    s_nop 1
    s_cmp_ge_u32 s68, 4
    s_cbranch_scc0 L_lw_113
    s_cmp_eq_u32 s81, 1
    s_cbranch_scc1 L_w2p_114
    s_add_u32 m0, s75, 32768
    s_add_u32 s65, s78, 229376
    buffer_load_dwordx4 v11, s[24:27], s65 offen lds
    s_add_u32 m0, s75, 36864
    s_add_u32 s65, s78, 258048
    buffer_load_dwordx4 v11, s[24:27], s65 offen lds
    s_add_u32 m0, s75, 40960
    s_add_u32 s65, s78, 286720
    buffer_load_dwordx4 v11, s[24:27], s65 offen lds
    s_add_u32 m0, s75, 45056
    s_add_u32 s65, s78, 315392
    buffer_load_dwordx4 v11, s[24:27], s65 offen lds
    s_add_u32 m0, s75, 49152
    s_add_u32 s65, s78, 344064
    buffer_load_dwordx4 v11, s[24:27], s65 offen lds
    s_add_u32 m0, s75, 53248
    s_add_u32 s65, s78, 372736
    buffer_load_dwordx4 v11, s[24:27], s65 offen lds
L_w2p_114:
    s_lshl_b32 s68, s3, 7
    s_add_u32 s68, s68, 160896
    v_and_b32 v13, 15, v1
    v_cmp_gt_u32 vcc, 2, v13
    v_lshlrev_b32 v13, 6, v13
    v_and_b32 v14, 48, v1
    v_add3_u32 v13, v13, v14, s68
    s_mov_b64 exec, vcc
    ds_write_b128 v13, v[112:115]
    s_mov_b64 exec, -1
    v_lshl_add_u32 v13, v4, 4, s68
    ds_read_b128 v[120:123], v13 offset:0
    ds_read_b128 v[124:127], v13 offset:32
    ds_read_b128 v[128:131], v13 offset:64
    ds_read_b128 v[132:135], v13 offset:96
    s_waitcnt lgkmcnt(0)
    s_mov_b32 s70, 0
L_lw_115:
    ds_read_b32 v15, v18 offset:4
    s_add_u32 s70, s70, 1
    s_cmp_gt_u32 s70, 3200000
    s_cbranch_scc1 L_END
    s_waitcnt lgkmcnt(0)
    v_readfirstlane_b32 s68, v15
    s_nop 1
    s_cmp_ge_u32 s68, 12
    s_cbranch_scc0 L_lw_115
    s_mov_b32 s90, 0
    v_mul_f32 v7, 0x3e8b97f6, v6
    v_fma_f32 v96, -v5, v120, v96
    v_fma_f32 v97, -v5, v121, v97
    v_fma_f32 v98, -v5, v122, v98
    v_fma_f32 v99, -v5, v123, v99
    v_fma_f32 v100, -v5, v124, v100
    v_fma_f32 v101, -v5, v125, v101
    v_fma_f32 v102, -v5, v126, v102
    v_fma_f32 v103, -v5, v127, v103
    v_fma_f32 v104, -v5, v128, v104
    v_fma_f32 v105, -v5, v129, v105
    v_fma_f32 v106, -v5, v130, v106
    v_fma_f32 v107, -v5, v131, v107
    v_fma_f32 v108, -v5, v132, v108
    v_fma_f32 v109, -v5, v133, v109
    v_fma_f32 v110, -v5, v134, v110
    v_fma_f32 v111, -v5, v135, v111
    v_mul_f32 v96, v96, v7
    v_mul_f32 v97, v97, v7
    v_mul_f32 v98, v98, v7
    v_mul_f32 v99, v99, v7
    v_mul_f32 v100, v100, v7
    v_mul_f32 v101, v101, v7
    v_mul_f32 v102, v102, v7
    v_mul_f32 v103, v103, v7
    v_mul_f32 v104, v104, v7
    v_mul_f32 v105, v105, v7
    v_mul_f32 v106, v106, v7
    v_mul_f32 v107, v107, v7
    v_mul_f32 v108, v108, v7
    v_mul_f32 v109, v109, v7
    v_mul_f32 v110, v110, v7
    v_mul_f32 v111, v111, v7
    s_mov_b32 exec_lo, 0
    s_mov_b32 exec_hi, -1
    v_mov_b32 v108, 0
    v_mov_b32 v109, 0
    v_mov_b32 v110, 0
    v_mov_b32 v111, 0
    s_mov_b64 exec, -1
    v_cvt_pk_bf16_f32 v152, v96, v97
    v_cvt_pk_bf16_f32 v153, v98, v99
    v_cvt_pk_bf16_f32 v154, v100, v101
    v_cvt_pk_bf16_f32 v155, v102, v103
    v_cvt_pk_bf16_f32 v156, v104, v105
    v_cvt_pk_bf16_f32 v157, v106, v107
    v_cvt_pk_bf16_f32 v158, v108, v109
    v_cvt_pk_bf16_f32 v159, v110, v111
    v_mul_f32 v13, v96, v96
    v_mul_f32 v14, v97, v97
    v_fmac_f32 v13, v98, v98
    v_fmac_f32 v14, v99, v99
    v_fmac_f32 v13, v100, v100
    v_fmac_f32 v14, v101, v101
    v_fmac_f32 v13, v102, v102
    v_fmac_f32 v14, v103, v103
    v_fmac_f32 v13, v104, v104
    v_fmac_f32 v14, v105, v105
    v_fmac_f32 v13, v106, v106
    v_fmac_f32 v14, v107, v107
    v_fmac_f32 v13, v108, v108
    v_fmac_f32 v14, v109, v109
    v_fmac_f32 v13, v110, v110
    v_fmac_f32 v14, v111, v111
    v_add_f32 v13, v13, v14
    v_mov_b32 v14, v13
    s_nop 1
    v_permlane32_swap_b32 v13, v14
    v_add_f32 v13, v13, v14
    s_lshl_b32 s65, s61, 7
    s_add_u32 s65, s65, 159744
    v_lshl_add_u32 v14, v3, 2, s65
    ds_write_b32 v14, v13
    s_mul_i32 s65, s61, 24576
    s_add_u32 s65, s65, 61440
    v_add_u32 v14, s65, v2
    ds_write_b128 v14, v[152:155]
    ds_write_b128 v14, v[156:159] offset:1024
    s_mov_b64 exec, 1
    ds_add_u32 v18, v17 offset:4
    s_mov_b64 exec, -1
    v_add_u32 v13, s6, v1
    v_and_b32 v13, 7, v13
    v_lshl_add_u32 v13, v13, 2, s61
    v_mul_u32_u24 v13, 12288, v13
    s_mov_b32 s67, 4096
    s_lshl_b32 s79, s61, 13
    s_add_u32 s79, s79, 524288
    s_waitcnt vmcnt(0)
    s_mov_b64 exec, 1
    ds_add_u32 v18, v17 offset:52
    s_mov_b64 exec, -1
    s_mov_b32 s70, 0
L_lw_116:
    ds_read_b32 v15, v18 offset:4
    s_add_u32 s70, s70, 1
    s_cmp_gt_u32 s70, 3200000
    s_cbranch_scc1 L_END
    s_waitcnt lgkmcnt(0)
    v_readfirstlane_b32 s68, v15
    s_nop 1
    s_cmp_ge_u32 s68, 16
    s_cbranch_scc0 L_lw_116
    v_add_u32 v14, 61440, v2
    v_add_u32 v16, 110592, v2
    ds_read_b128 v[32:35], v14 offset:0
    ds_read_b128 v[36:39], v14 offset:1024
    ds_read_b128 v[40:43], v14 offset:24576
    ds_read_b128 v[44:47], v14 offset:25600
    ds_read_b128 v[48:51], v16 offset:0
    ds_read_b128 v[52:55], v16 offset:1024
    ds_read_b128 v[56:59], v16 offset:24576
    ds_read_b128 v[60:63], v16 offset:25600
    v_lshlrev_b32 v14, 3, v1
    v_add_u32 v14, 159744, v14
    ds_read_b64 v[24:25], v14
    v_mov_b32 v64, 0
    v_mov_b32 v65, 0
    v_mov_b32 v66, 0
    v_mov_b32 v67, 0
    v_mov_b32 v68, 0
    v_mov_b32 v69, 0
    v_mov_b32 v70, 0
    v_mov_b32 v71, 0
    v_mov_b32 v72, 0
    v_mov_b32 v73, 0
    v_mov_b32 v74, 0
    v_mov_b32 v75, 0
    v_mov_b32 v76, 0
    v_mov_b32 v77, 0
    v_mov_b32 v78, 0
    v_mov_b32 v79, 0
    v_mov_b32 v80, 0
    v_mov_b32 v81, 0
    v_mov_b32 v82, 0
    v_mov_b32 v83, 0
    v_mov_b32 v84, 0
    v_mov_b32 v85, 0
    v_mov_b32 v86, 0
    v_mov_b32 v87, 0
    v_mov_b32 v88, 0
    v_mov_b32 v89, 0
    v_mov_b32 v90, 0
    v_mov_b32 v91, 0
    v_mov_b32 v92, 0
    v_mov_b32 v93, 0
    v_mov_b32 v94, 0
    v_mov_b32 v95, 0
    v_mov_b32 v96, 0
    v_mov_b32 v97, 0
    v_mov_b32 v98, 0
    v_mov_b32 v99, 0
    v_mov_b32 v100, 0
    v_mov_b32 v101, 0
    v_mov_b32 v102, 0
    v_mov_b32 v103, 0
    v_mov_b32 v104, 0
    v_mov_b32 v105, 0
    v_mov_b32 v106, 0
    v_mov_b32 v107, 0
    v_mov_b32 v108, 0
    v_mov_b32 v109, 0
    v_mov_b32 v110, 0
    v_mov_b32 v111, 0
    v_mov_b32 v112, 0
    v_mov_b32 v113, 0
    v_mov_b32 v114, 0
    v_mov_b32 v115, 0
    v_mov_b32 v116, 0
    v_mov_b32 v117, 0
    v_mov_b32 v118, 0
    v_mov_b32 v119, 0
    v_mov_b32 v120, 0
    v_mov_b32 v121, 0
    v_mov_b32 v122, 0
    v_mov_b32 v123, 0
    v_mov_b32 v124, 0
    v_mov_b32 v125, 0
    v_mov_b32 v126, 0
    v_mov_b32 v127, 0
    s_mov_b32 s70, 0
L_lw_117:
    ds_read_b32 v15, v18 offset:20
    s_add_u32 s70, s70, 1
    s_cmp_gt_u32 s70, 3200000
    s_cbranch_scc1 L_END
    s_waitcnt lgkmcnt(0)
    v_readfirstlane_b32 s68, v15
    s_nop 1
    s_cmp_ge_u32 s68, 4
    s_cbranch_scc0 L_lw_117
    v_max_f32 v24, v24, v25
    s_lshl_b32 s65, s81, 2
    s_or_b32 s65, s65, s61
    s_cmp_eq_u32 s65, 3
    s_cbranch_scc0 L_kvonly_118
    v_add_u32 v13, 4096, v13
    v_lshrrev_b32 v15, 3, v1
    v_mul_u32_u24 v14, 3, v15
    v_lshrrev_b32 v14, 1, v14
    v_add_u32 v14, -3, v14
    v_cmp_eq_u32 vcc, 1, v15
    s_nop 1
    v_cndmask_b32 v14, v14, 0, vcc
    v_cmp_eq_u32 vcc, 2, v15
    s_nop 1
    v_cndmask_b32 v14, v14, -1, vcc
    v_add_u32 v14, s4, v14
    v_mov_b32 v16, s4
    v_cmp_gt_u32 vcc, 32, v14
    s_nop 1
    v_cndmask_b32 v14, v16, v14, vcc
    v_mul_u32_u24 v14, 12288, v14
    v_and_b32 v16, 7, v1
    v_lshl_add_u32 v14, v16, 7, v14
    v_cmp_eq_u32 vcc, 0, v15
    s_nop 1
    v_cndmask_b32 v13, v14, v13, vcc
    s_getreg_b32 s82, hwreg(HW_REG_XCC_ID)
    s_and_b32 s82, s82, 15
    s_add_u32 s82, s82, 1
    s_mov_b32 s70, 0
    s_mov_b32 s66, 0
L_both:
    s_mov_b32 exec_hi, 0
    buffer_load_dword v14, v13, s[44:47], 0 offen sc1
    s_add_u32 s70, s70, 1
    s_cmp_gt_u32 s70, 400000
    s_cbranch_scc1 L_END
    s_waitcnt vmcnt(0)
    v_cmp_ne_u32 vcc, 0, v14
    s_mov_b32 exec_hi, -1
    s_nop 0
    s_mov_b32 s65, vcc_lo
    s_or_b32 s67, s65, 0xff
    s_andn2_b32 s67, s67, s66
    s_cmp_eq_u32 s67, -1
    s_cbranch_scc0 L_both2
    s_mov_b64 exec, 0xff00
    v_cmp_ne_u32 vcc, s82, v14
    s_mov_b64 exec, -1
    s_nop 0
    s_cmp_eq_u64 vcc, 0
    s_cselect_b32 s82, 1, 0
    v_mov_b32 v15, s82
    ds_write_b32 v18, v15 offset:28
    s_mov_b64 exec, 1
    ds_add_u32 v18, v17 offset:68
    s_mov_b64 exec, -1
    s_mov_b32 s66, 1
L_both2:
    s_and_b32 s65, s65, 0xff
    s_cmp_eq_u32 s65, 0xff
    s_cbranch_scc0 L_both
    s_cmp_eq_u32 s66, 1
    s_cbranch_scc1 L_kvdone_119
    v_mov_b32 v15, 256
    s_mov_b64 exec, 1
    ds_add_u32 v18, v15 offset:68
    s_mov_b64 exec, -1
    s_branch L_kvdone_119
L_kvonly_118:
    s_mov_b32 exec_lo, 0xff
    s_mov_b32 exec_hi, 0
    s_mov_b32 s70, 0
L_poll_120:
    buffer_load_dword v14, v13, s[44:47], s67 offen sc1
    s_add_u32 s70, s70, 1
    s_cmp_gt_u32 s70, 400000
    s_cbranch_scc1 L_END
    s_waitcnt vmcnt(0)
    v_cmp_ne_u32 vcc, 0, v14
    s_nop 1
    s_cmp_eq_u64 vcc, exec
    s_cbranch_scc1 L_poll_120_ok
    s_branch L_poll_120
L_poll_120_ok:
    s_mov_b64 exec, -1
L_kvdone_119:
    s_lshl_b32 s66, s6, 15
    s_add_u32 s65, s66, s79
    v_add_u32 v19, 4096, v2
    s_setprio 3
    buffer_load_dwordx4 v[176:179], v2, s[44:47], s65 offen offset:0 sc1
    buffer_load_dwordx4 v[180:183], v2, s[44:47], s65 offen offset:1024 sc1
    buffer_load_dwordx4 v[184:187], v2, s[44:47], s65 offen offset:2048 sc1
    buffer_load_dwordx4 v[188:191], v2, s[44:47], s65 offen offset:3072 sc1
    s_setprio 1
    s_setprio 3
    buffer_load_dwordx4 v[192:195], v19, s[44:47], s65 offen offset:0 sc1
    buffer_load_dwordx4 v[196:199], v19, s[44:47], s65 offen offset:1024 sc1
    buffer_load_dwordx4 v[200:203], v19, s[44:47], s65 offen offset:2048 sc1
    buffer_load_dwordx4 v[204:207], v19, s[44:47], s65 offen offset:3072 sc1
    s_setprio 1
    v_max_f32_dpp v14, v14, v14 row_shr:1 row_mask:0xf bank_mask:0xf
    s_nop 1
    v_max_f32_dpp v14, v14, v14 row_shr:2 row_mask:0xf bank_mask:0xf
    s_nop 1
    v_max_f32_dpp v14, v14, v14 row_shr:4 row_mask:0xf bank_mask:0xf
    s_nop 0
    v_readlane_b32 s71, v14, 7
    s_mov_b32 s76, 24
    s_nop 0
    v_mul_f32 v24, s71, v24
    v_cmp_nge_f32 vcc, 0x44c80000, v24
    s_nop 1
    s_cmp_lg_u64 vcc, 0
    s_cselect_b32 s67, 1, 0
    v_mov_b32 v24, s67
    s_mov_b64 exec, 1
    ds_add_u32 v18, v24 offset:24
    ds_add_u32 v18, v17 offset:4
    s_mov_b64 exec, -1
L_attn:
    s_waitcnt vmcnt(4)
    v_mfma_f32_32x32x16_bf16 v[128:143], v[176:179], v[32:35], 0
    v_mfma_f32_32x32x16_bf16 v[128:143], v[180:183], v[36:39], v[128:143]
    s_add_u32 s66, s66, 0x8000
    s_and_b32 s66, s66, 0x3ffff
    s_add_u32 s65, s66, s79
    s_setprio 3
    buffer_load_dwordx4 v[208:211], v2, s[44:47], s65 offen offset:0 sc1
    buffer_load_dwordx4 v[212:215], v2, s[44:47], s65 offen offset:1024 sc1
    buffer_load_dwordx4 v[216:219], v2, s[44:47], s65 offen offset:2048 sc1
    buffer_load_dwordx4 v[220:223], v2, s[44:47], s65 offen offset:3072 sc1
    s_setprio 1
    v_mfma_f32_32x32x16_bf16 v[144:159], v[176:179], v[40:43], 0
    s_nop 1
    v_exp_f32 v160, v128
    v_exp_f32 v161, v129
    v_exp_f32 v162, v130
    v_exp_f32 v163, v131
    v_cvt_pk_bf16_f32 v168, v160, v161
    v_cvt_pk_bf16_f32 v169, v162, v163
    v_exp_f32 v164, v132
    v_exp_f32 v165, v133
    v_exp_f32 v166, v134
    v_exp_f32 v167, v135
    s_mov_b32 s75, 0
.p2align 6
L_att_loop:
    v_mfma_f32_32x32x16_bf16 v[144:159], v[180:183], v[44:47], v[144:159]
    s_setprio 3
    buffer_load_dwordx4 v[224:227], v19, s[44:47], s65 offen offset:0 sc1
    buffer_load_dwordx4 v[228:231], v19, s[44:47], s65 offen offset:1024 sc1
    s_setprio 1
    v_cvt_pk_bf16_f32 v170, v164, v165
    v_cvt_pk_bf16_f32 v171, v166, v167
    v_exp_f32 v160, v136
    v_exp_f32 v161, v137
    v_exp_f32 v162, v138
    v_exp_f32 v163, v139
    v_mfma_f32_32x32x16_bf16 v[64:79], v[184:187], v[168:171], v[64:79]
    v_cvt_pk_bf16_f32 v172, v160, v161
    v_cvt_pk_bf16_f32 v173, v162, v163
    v_exp_f32 v164, v140
    v_exp_f32 v165, v141
    v_exp_f32 v166, v142
    v_exp_f32 v167, v143
    v_mfma_f32_32x32x16_bf16 v[128:143], v[176:179], v[48:51], 0
    s_setprio 3
    buffer_load_dwordx4 v[232:235], v19, s[44:47], s65 offen offset:2048 sc1
    buffer_load_dwordx4 v[236:239], v19, s[44:47], s65 offen offset:3072 sc1
    s_setprio 1
    v_cvt_pk_bf16_f32 v174, v164, v165
    v_cvt_pk_bf16_f32 v175, v166, v167
    v_exp_f32 v160, v144
    v_exp_f32 v161, v145
    v_exp_f32 v162, v146
    v_exp_f32 v163, v147
    v_mfma_f32_32x32x16_bf16 v[64:79], v[188:191], v[172:175], v[64:79]
    v_cvt_pk_bf16_f32 v168, v160, v161
    v_cvt_pk_bf16_f32 v169, v162, v163
    v_exp_f32 v164, v148
    v_exp_f32 v165, v149
    v_exp_f32 v166, v150
    v_exp_f32 v167, v151
    v_mfma_f32_32x32x16_bf16 v[128:143], v[180:183], v[52:55], v[128:143]
    v_cvt_pk_bf16_f32 v170, v164, v165
    v_cvt_pk_bf16_f32 v171, v166, v167
    v_exp_f32 v160, v152
    v_exp_f32 v161, v153
    v_exp_f32 v162, v154
    v_exp_f32 v163, v155
    v_mfma_f32_32x32x16_bf16 v[80:95], v[184:187], v[168:171], v[80:95]
    v_cvt_pk_bf16_f32 v172, v160, v161
    v_cvt_pk_bf16_f32 v173, v162, v163
    v_exp_f32 v164, v156
    v_exp_f32 v165, v157
    v_exp_f32 v166, v158
    v_exp_f32 v167, v159
    v_mfma_f32_32x32x16_bf16 v[144:159], v[176:179], v[56:59], 0
    v_cvt_pk_bf16_f32 v174, v164, v165
    v_cvt_pk_bf16_f32 v175, v166, v167
    v_exp_f32 v160, v128
    v_exp_f32 v161, v129
    v_exp_f32 v162, v130
    v_exp_f32 v163, v131
    v_mfma_f32_32x32x16_bf16 v[80:95], v[188:191], v[172:175], v[80:95]
    v_cvt_pk_bf16_f32 v168, v160, v161
    v_cvt_pk_bf16_f32 v169, v162, v163
    v_exp_f32 v164, v132
    v_exp_f32 v165, v133
    v_exp_f32 v166, v134
    v_exp_f32 v167, v135
    v_mfma_f32_32x32x16_bf16 v[144:159], v[180:183], v[60:63], v[144:159]
    v_cvt_pk_bf16_f32 v170, v164, v165
    v_cvt_pk_bf16_f32 v171, v166, v167
    v_exp_f32 v160, v136
    v_exp_f32 v161, v137
    v_exp_f32 v162, v138
    v_exp_f32 v163, v139
    v_mfma_f32_32x32x16_bf16 v[96:111], v[184:187], v[168:171], v[96:111]
    v_cvt_pk_bf16_f32 v172, v160, v161
    v_cvt_pk_bf16_f32 v173, v162, v163
    v_exp_f32 v164, v140
    v_exp_f32 v165, v141
    v_exp_f32 v166, v142
    v_exp_f32 v167, v143
    s_waitcnt vmcnt(8)
    v_mfma_f32_32x32x16_bf16 v[128:143], v[192:195], v[32:35], 0
    v_cvt_pk_bf16_f32 v174, v164, v165
    v_cvt_pk_bf16_f32 v175, v166, v167
    v_exp_f32 v160, v144
    v_exp_f32 v161, v145
    v_exp_f32 v162, v146
    v_exp_f32 v163, v147
    v_mfma_f32_32x32x16_bf16 v[96:111], v[188:191], v[172:175], v[96:111]
    v_cvt_pk_bf16_f32 v168, v160, v161
    v_cvt_pk_bf16_f32 v169, v162, v163
    v_exp_f32 v164, v148
    v_exp_f32 v165, v149
    v_exp_f32 v166, v150
    v_exp_f32 v167, v151
    v_mfma_f32_32x32x16_bf16 v[128:143], v[196:199], v[36:39], v[128:143]
    v_cvt_pk_bf16_f32 v170, v164, v165
    v_cvt_pk_bf16_f32 v171, v166, v167
    v_exp_f32 v160, v152
    v_exp_f32 v161, v153
    v_exp_f32 v162, v154
    v_exp_f32 v163, v155
    v_mfma_f32_32x32x16_bf16 v[112:127], v[184:187], v[168:171], v[112:127]
    v_cvt_pk_bf16_f32 v172, v160, v161
    v_cvt_pk_bf16_f32 v173, v162, v163
    v_exp_f32 v164, v156
    v_exp_f32 v165, v157
    v_exp_f32 v166, v158
    v_exp_f32 v167, v159
    v_mfma_f32_32x32x16_bf16 v[144:159], v[192:195], v[40:43], 0
    v_cvt_pk_bf16_f32 v174, v164, v165
    v_cvt_pk_bf16_f32 v175, v166, v167
    v_exp_f32 v160, v128
    v_exp_f32 v161, v129
    v_exp_f32 v162, v130
    v_exp_f32 v163, v131
    v_mfma_f32_32x32x16_bf16 v[112:127], v[188:191], v[172:175], v[112:127]
    v_cvt_pk_bf16_f32 v168, v160, v161
    v_cvt_pk_bf16_f32 v169, v162, v163
    v_exp_f32 v164, v132
    v_exp_f32 v165, v133
    v_exp_f32 v166, v134
    v_exp_f32 v167, v135
    v_mfma_f32_32x32x16_bf16 v[144:159], v[196:199], v[44:47], v[144:159]
    s_add_u32 s66, s66, 0x8000
    s_and_b32 s66, s66, 0x3ffff
    s_add_u32 s65, s66, s79
    s_cmp_eq_u32 s75, 3
    s_cselect_b32 s65, 1073741824, s65
    s_setprio 3
    buffer_load_dwordx4 v[176:179], v2, s[44:47], s65 offen offset:0 sc1
    buffer_load_dwordx4 v[180:183], v2, s[44:47], s65 offen offset:1024 sc1
    s_setprio 1
    v_cvt_pk_bf16_f32 v170, v164, v165
    v_cvt_pk_bf16_f32 v171, v166, v167
    v_exp_f32 v160, v136
    v_exp_f32 v161, v137
    v_exp_f32 v162, v138
    v_exp_f32 v163, v139
    v_mfma_f32_32x32x16_bf16 v[64:79], v[200:203], v[168:171], v[64:79]
    v_cvt_pk_bf16_f32 v172, v160, v161
    v_cvt_pk_bf16_f32 v173, v162, v163
    v_exp_f32 v164, v140
    v_exp_f32 v165, v141
    v_exp_f32 v166, v142
    v_exp_f32 v167, v143
    v_mfma_f32_32x32x16_bf16 v[128:143], v[192:195], v[48:51], 0
    s_setprio 3
    buffer_load_dwordx4 v[184:187], v2, s[44:47], s65 offen offset:2048 sc1
    buffer_load_dwordx4 v[188:191], v2, s[44:47], s65 offen offset:3072 sc1
    s_setprio 1
    v_cvt_pk_bf16_f32 v174, v164, v165
    v_cvt_pk_bf16_f32 v175, v166, v167
    v_exp_f32 v160, v144
    v_exp_f32 v161, v145
    v_exp_f32 v162, v146
    v_exp_f32 v163, v147
    v_mfma_f32_32x32x16_bf16 v[64:79], v[204:207], v[172:175], v[64:79]
    v_cvt_pk_bf16_f32 v168, v160, v161
    v_cvt_pk_bf16_f32 v169, v162, v163
    v_exp_f32 v164, v148
    v_exp_f32 v165, v149
    v_exp_f32 v166, v150
    v_exp_f32 v167, v151
    v_mfma_f32_32x32x16_bf16 v[128:143], v[196:199], v[52:55], v[128:143]
    v_cvt_pk_bf16_f32 v170, v164, v165
    v_cvt_pk_bf16_f32 v171, v166, v167
    v_exp_f32 v160, v152
    v_exp_f32 v161, v153
    v_exp_f32 v162, v154
    v_exp_f32 v163, v155
    v_mfma_f32_32x32x16_bf16 v[80:95], v[200:203], v[168:171], v[80:95]
    v_cvt_pk_bf16_f32 v172, v160, v161
    v_cvt_pk_bf16_f32 v173, v162, v163
    v_exp_f32 v164, v156
    v_exp_f32 v165, v157
    v_exp_f32 v166, v158
    v_exp_f32 v167, v159
    v_mfma_f32_32x32x16_bf16 v[144:159], v[192:195], v[56:59], 0
    v_cvt_pk_bf16_f32 v174, v164, v165
    v_cvt_pk_bf16_f32 v175, v166, v167
    v_exp_f32 v160, v128
    v_exp_f32 v161, v129
    v_exp_f32 v162, v130
    v_exp_f32 v163, v131
    v_mfma_f32_32x32x16_bf16 v[80:95], v[204:207], v[172:175], v[80:95]
    v_cvt_pk_bf16_f32 v168, v160, v161
    v_cvt_pk_bf16_f32 v169, v162, v163
    v_exp_f32 v164, v132
    v_exp_f32 v165, v133
    v_exp_f32 v166, v134
    v_exp_f32 v167, v135
    v_mfma_f32_32x32x16_bf16 v[144:159], v[196:199], v[60:63], v[144:159]
    v_cvt_pk_bf16_f32 v170, v164, v165
    v_cvt_pk_bf16_f32 v171, v166, v167
    v_exp_f32 v160, v136
    v_exp_f32 v161, v137
    v_exp_f32 v162, v138
    v_exp_f32 v163, v139
    v_mfma_f32_32x32x16_bf16 v[96:111], v[200:203], v[168:171], v[96:111]
    v_cvt_pk_bf16_f32 v172, v160, v161
    v_cvt_pk_bf16_f32 v173, v162, v163
    v_exp_f32 v164, v140
    v_exp_f32 v165, v141
    v_exp_f32 v166, v142
    v_exp_f32 v167, v143
    s_waitcnt vmcnt(8)
    v_mfma_f32_32x32x16_bf16 v[128:143], v[208:211], v[32:35], 0
    v_cvt_pk_bf16_f32 v174, v164, v165
    v_cvt_pk_bf16_f32 v175, v166, v167
    v_exp_f32 v160, v144
    v_exp_f32 v161, v145
    v_exp_f32 v162, v146
    v_exp_f32 v163, v147
    v_mfma_f32_32x32x16_bf16 v[96:111], v[204:207], v[172:175], v[96:111]
    v_cvt_pk_bf16_f32 v168, v160, v161
    v_cvt_pk_bf16_f32 v169, v162, v163
    v_exp_f32 v164, v148
    v_exp_f32 v165, v149
    v_exp_f32 v166, v150
    v_exp_f32 v167, v151
    v_mfma_f32_32x32x16_bf16 v[128:143], v[212:215], v[36:39], v[128:143]
    v_cvt_pk_bf16_f32 v170, v164, v165
    v_cvt_pk_bf16_f32 v171, v166, v167
    v_exp_f32 v160, v152
    v_exp_f32 v161, v153
    v_exp_f32 v162, v154
    v_exp_f32 v163, v155
    v_mfma_f32_32x32x16_bf16 v[112:127], v[200:203], v[168:171], v[112:127]
    v_cvt_pk_bf16_f32 v172, v160, v161
    v_cvt_pk_bf16_f32 v173, v162, v163
    v_exp_f32 v164, v156
    v_exp_f32 v165, v157
    v_exp_f32 v166, v158
    v_exp_f32 v167, v159
    v_mfma_f32_32x32x16_bf16 v[144:159], v[208:211], v[40:43], 0
    v_cvt_pk_bf16_f32 v174, v164, v165
    v_cvt_pk_bf16_f32 v175, v166, v167
    v_exp_f32 v160, v128
    v_exp_f32 v161, v129
    v_exp_f32 v162, v130
    v_exp_f32 v163, v131
    v_mfma_f32_32x32x16_bf16 v[112:127], v[204:207], v[172:175], v[112:127]
    v_cvt_pk_bf16_f32 v168, v160, v161
    v_cvt_pk_bf16_f32 v169, v162, v163
    v_exp_f32 v164, v132
    v_exp_f32 v165, v133
    v_exp_f32 v166, v134
    v_exp_f32 v167, v135
    v_mfma_f32_32x32x16_bf16 v[144:159], v[212:215], v[44:47], v[144:159]
    s_setprio 3
    buffer_load_dwordx4 v[192:195], v19, s[44:47], s65 offen offset:0 sc1
    buffer_load_dwordx4 v[196:199], v19, s[44:47], s65 offen offset:1024 sc1
    s_setprio 1
    v_cvt_pk_bf16_f32 v170, v164, v165
    v_cvt_pk_bf16_f32 v171, v166, v167
    v_exp_f32 v160, v136
    v_exp_f32 v161, v137
    v_exp_f32 v162, v138
    v_exp_f32 v163, v139
    v_mfma_f32_32x32x16_bf16 v[64:79], v[216:219], v[168:171], v[64:79]
    v_cvt_pk_bf16_f32 v172, v160, v161
    v_cvt_pk_bf16_f32 v173, v162, v163
    v_exp_f32 v164, v140
    v_exp_f32 v165, v141
    v_exp_f32 v166, v142
    v_exp_f32 v167, v143
    v_mfma_f32_32x32x16_bf16 v[128:143], v[208:211], v[48:51], 0
    s_setprio 3
    buffer_load_dwordx4 v[200:203], v19, s[44:47], s65 offen offset:2048 sc1
    buffer_load_dwordx4 v[204:207], v19, s[44:47], s65 offen offset:3072 sc1
    s_setprio 1
    v_cvt_pk_bf16_f32 v174, v164, v165
    v_cvt_pk_bf16_f32 v175, v166, v167
    v_exp_f32 v160, v144
    v_exp_f32 v161, v145
    v_exp_f32 v162, v146
    v_exp_f32 v163, v147
    v_mfma_f32_32x32x16_bf16 v[64:79], v[220:223], v[172:175], v[64:79]
    v_cvt_pk_bf16_f32 v168, v160, v161
    v_cvt_pk_bf16_f32 v169, v162, v163
    v_exp_f32 v164, v148
    v_exp_f32 v165, v149
    v_exp_f32 v166, v150
    v_exp_f32 v167, v151
    v_mfma_f32_32x32x16_bf16 v[128:143], v[212:215], v[52:55], v[128:143]
    v_cvt_pk_bf16_f32 v170, v164, v165
    v_cvt_pk_bf16_f32 v171, v166, v167
    v_exp_f32 v160, v152
    v_exp_f32 v161, v153
    v_exp_f32 v162, v154
    v_exp_f32 v163, v155
    v_mfma_f32_32x32x16_bf16 v[80:95], v[216:219], v[168:171], v[80:95]
    v_cvt_pk_bf16_f32 v172, v160, v161
    v_cvt_pk_bf16_f32 v173, v162, v163
    v_exp_f32 v164, v156
    v_exp_f32 v165, v157
    v_exp_f32 v166, v158
    v_exp_f32 v167, v159
    v_mfma_f32_32x32x16_bf16 v[144:159], v[208:211], v[56:59], 0
    v_cvt_pk_bf16_f32 v174, v164, v165
    v_cvt_pk_bf16_f32 v175, v166, v167
    v_exp_f32 v160, v128
    v_exp_f32 v161, v129
    v_exp_f32 v162, v130
    v_exp_f32 v163, v131
    v_mfma_f32_32x32x16_bf16 v[80:95], v[220:223], v[172:175], v[80:95]
    v_cvt_pk_bf16_f32 v168, v160, v161
    v_cvt_pk_bf16_f32 v169, v162, v163
    v_exp_f32 v164, v132
    v_exp_f32 v165, v133
    v_exp_f32 v166, v134
    v_exp_f32 v167, v135
    v_mfma_f32_32x32x16_bf16 v[144:159], v[212:215], v[60:63], v[144:159]
    v_cvt_pk_bf16_f32 v170, v164, v165
    v_cvt_pk_bf16_f32 v171, v166, v167
    v_exp_f32 v160, v136
    v_exp_f32 v161, v137
    v_exp_f32 v162, v138
    v_exp_f32 v163, v139
    v_mfma_f32_32x32x16_bf16 v[96:111], v[216:219], v[168:171], v[96:111]
    v_cvt_pk_bf16_f32 v172, v160, v161
    v_cvt_pk_bf16_f32 v173, v162, v163
    v_exp_f32 v164, v140
    v_exp_f32 v165, v141
    v_exp_f32 v166, v142
    v_exp_f32 v167, v143
    s_waitcnt vmcnt(8)
    v_mfma_f32_32x32x16_bf16 v[128:143], v[224:227], v[32:35], 0
    v_cvt_pk_bf16_f32 v174, v164, v165
    v_cvt_pk_bf16_f32 v175, v166, v167
    v_exp_f32 v160, v144
    v_exp_f32 v161, v145
    v_exp_f32 v162, v146
    v_exp_f32 v163, v147
    v_mfma_f32_32x32x16_bf16 v[96:111], v[220:223], v[172:175], v[96:111]
    v_cvt_pk_bf16_f32 v168, v160, v161
    v_cvt_pk_bf16_f32 v169, v162, v163
    v_exp_f32 v164, v148
    v_exp_f32 v165, v149
    v_exp_f32 v166, v150
    v_exp_f32 v167, v151
    v_mfma_f32_32x32x16_bf16 v[128:143], v[228:231], v[36:39], v[128:143]
    v_cvt_pk_bf16_f32 v170, v164, v165
    v_cvt_pk_bf16_f32 v171, v166, v167
    v_exp_f32 v160, v152
    v_exp_f32 v161, v153
    v_exp_f32 v162, v154
    v_exp_f32 v163, v155
    v_mfma_f32_32x32x16_bf16 v[112:127], v[216:219], v[168:171], v[112:127]
    v_cvt_pk_bf16_f32 v172, v160, v161
    v_cvt_pk_bf16_f32 v173, v162, v163
    v_exp_f32 v164, v156
    v_exp_f32 v165, v157
    v_exp_f32 v166, v158
    v_exp_f32 v167, v159
    v_mfma_f32_32x32x16_bf16 v[144:159], v[224:227], v[40:43], 0
    v_cvt_pk_bf16_f32 v174, v164, v165
    v_cvt_pk_bf16_f32 v175, v166, v167
    v_exp_f32 v160, v128
    v_exp_f32 v161, v129
    v_exp_f32 v162, v130
    v_exp_f32 v163, v131
    v_mfma_f32_32x32x16_bf16 v[112:127], v[220:223], v[172:175], v[112:127]
    v_cvt_pk_bf16_f32 v168, v160, v161
    v_cvt_pk_bf16_f32 v169, v162, v163
    v_exp_f32 v164, v132
    v_exp_f32 v165, v133
    v_exp_f32 v166, v134
    v_exp_f32 v167, v135
    v_mfma_f32_32x32x16_bf16 v[144:159], v[228:231], v[44:47], v[144:159]
    s_add_u32 s66, s66, 0x8000
    s_and_b32 s66, s66, 0x3ffff
    s_add_u32 s65, s66, s79
    s_cmp_eq_u32 s75, 3
    s_cselect_b32 s65, 1073741824, s65
    s_setprio 3
    buffer_load_dwordx4 v[208:211], v2, s[44:47], s65 offen offset:0 sc1
    buffer_load_dwordx4 v[212:215], v2, s[44:47], s65 offen offset:1024 sc1
    s_setprio 1
    v_cvt_pk_bf16_f32 v170, v164, v165
    v_cvt_pk_bf16_f32 v171, v166, v167
    v_exp_f32 v160, v136
    v_exp_f32 v161, v137
    v_exp_f32 v162, v138
    v_exp_f32 v163, v139
    v_mfma_f32_32x32x16_bf16 v[64:79], v[232:235], v[168:171], v[64:79]
    v_cvt_pk_bf16_f32 v172, v160, v161
    v_cvt_pk_bf16_f32 v173, v162, v163
    v_exp_f32 v164, v140
    v_exp_f32 v165, v141
    v_exp_f32 v166, v142
    v_exp_f32 v167, v143
    v_mfma_f32_32x32x16_bf16 v[128:143], v[224:227], v[48:51], 0
    s_setprio 3
    buffer_load_dwordx4 v[216:219], v2, s[44:47], s65 offen offset:2048 sc1
    buffer_load_dwordx4 v[220:223], v2, s[44:47], s65 offen offset:3072 sc1
    s_setprio 1
    v_cvt_pk_bf16_f32 v174, v164, v165
    v_cvt_pk_bf16_f32 v175, v166, v167
    v_exp_f32 v160, v144
    v_exp_f32 v161, v145
    v_exp_f32 v162, v146
    v_exp_f32 v163, v147
    v_mfma_f32_32x32x16_bf16 v[64:79], v[236:239], v[172:175], v[64:79]
    v_cvt_pk_bf16_f32 v168, v160, v161
    v_cvt_pk_bf16_f32 v169, v162, v163
    v_exp_f32 v164, v148
    v_exp_f32 v165, v149
    v_exp_f32 v166, v150
    v_exp_f32 v167, v151
    v_mfma_f32_32x32x16_bf16 v[128:143], v[228:231], v[52:55], v[128:143]
    v_cvt_pk_bf16_f32 v170, v164, v165
    v_cvt_pk_bf16_f32 v171, v166, v167
    v_exp_f32 v160, v152
    v_exp_f32 v161, v153
    v_exp_f32 v162, v154
    v_exp_f32 v163, v155
    v_mfma_f32_32x32x16_bf16 v[80:95], v[232:235], v[168:171], v[80:95]
    v_cvt_pk_bf16_f32 v172, v160, v161
    v_cvt_pk_bf16_f32 v173, v162, v163
    v_exp_f32 v164, v156
    v_exp_f32 v165, v157
    v_exp_f32 v166, v158
    v_exp_f32 v167, v159
    v_mfma_f32_32x32x16_bf16 v[144:159], v[224:227], v[56:59], 0
    v_cvt_pk_bf16_f32 v174, v164, v165
    v_cvt_pk_bf16_f32 v175, v166, v167
    v_exp_f32 v160, v128
    v_exp_f32 v161, v129
    v_exp_f32 v162, v130
    v_exp_f32 v163, v131
    v_mfma_f32_32x32x16_bf16 v[80:95], v[236:239], v[172:175], v[80:95]
    v_cvt_pk_bf16_f32 v168, v160, v161
    v_cvt_pk_bf16_f32 v169, v162, v163
    v_exp_f32 v164, v132
    v_exp_f32 v165, v133
    v_exp_f32 v166, v134
    v_exp_f32 v167, v135
    v_mfma_f32_32x32x16_bf16 v[144:159], v[228:231], v[60:63], v[144:159]
    v_cvt_pk_bf16_f32 v170, v164, v165
    v_cvt_pk_bf16_f32 v171, v166, v167
    v_exp_f32 v160, v136
    v_exp_f32 v161, v137
    v_exp_f32 v162, v138
    v_exp_f32 v163, v139
    v_mfma_f32_32x32x16_bf16 v[96:111], v[232:235], v[168:171], v[96:111]
    v_cvt_pk_bf16_f32 v172, v160, v161
    v_cvt_pk_bf16_f32 v173, v162, v163
    v_exp_f32 v164, v140
    v_exp_f32 v165, v141
    v_exp_f32 v166, v142
    v_exp_f32 v167, v143
    s_waitcnt vmcnt(8)
    v_mfma_f32_32x32x16_bf16 v[128:143], v[176:179], v[32:35], 0
    v_cvt_pk_bf16_f32 v174, v164, v165
    v_cvt_pk_bf16_f32 v175, v166, v167
    v_exp_f32 v160, v144
    v_exp_f32 v161, v145
    v_exp_f32 v162, v146
    v_exp_f32 v163, v147
    v_mfma_f32_32x32x16_bf16 v[96:111], v[236:239], v[172:175], v[96:111]
    v_cvt_pk_bf16_f32 v168, v160, v161
    v_cvt_pk_bf16_f32 v169, v162, v163
    v_exp_f32 v164, v148
    v_exp_f32 v165, v149
    v_exp_f32 v166, v150
    v_exp_f32 v167, v151
    v_mfma_f32_32x32x16_bf16 v[128:143], v[180:183], v[36:39], v[128:143]
    v_cvt_pk_bf16_f32 v170, v164, v165
    v_cvt_pk_bf16_f32 v171, v166, v167
    v_exp_f32 v160, v152
    v_exp_f32 v161, v153
    v_exp_f32 v162, v154
    v_exp_f32 v163, v155
    v_mfma_f32_32x32x16_bf16 v[112:127], v[232:235], v[168:171], v[112:127]
    v_cvt_pk_bf16_f32 v172, v160, v161
    v_cvt_pk_bf16_f32 v173, v162, v163
    v_exp_f32 v164, v156
    v_exp_f32 v165, v157
    v_exp_f32 v166, v158
    v_exp_f32 v167, v159
    v_mfma_f32_32x32x16_bf16 v[144:159], v[176:179], v[40:43], 0
    v_cvt_pk_bf16_f32 v174, v164, v165
    v_cvt_pk_bf16_f32 v175, v166, v167
    v_exp_f32 v160, v128
    v_exp_f32 v161, v129
    v_exp_f32 v162, v130
    v_exp_f32 v163, v131
    v_mfma_f32_32x32x16_bf16 v[112:127], v[236:239], v[172:175], v[112:127]
    v_cvt_pk_bf16_f32 v168, v160, v161
    v_cvt_pk_bf16_f32 v169, v162, v163
    v_exp_f32 v164, v132
    v_exp_f32 v165, v133
    v_exp_f32 v166, v134
    v_exp_f32 v167, v135
    s_add_u32 s75, s75, 1
    s_cmp_lt_u32 s75, 4
    s_cbranch_scc1 L_att_loop
    s_setprio 3
    s_mov_b32 s70, 0
L_lw_121:
    ds_read_b32 v15, v18 offset:64
    s_add_u32 s70, s70, 1
    s_cmp_gt_u32 s70, 3200000
    s_cbranch_scc1 L_END
    s_waitcnt lgkmcnt(0)
    v_readfirstlane_b32 s68, v15
    s_nop 1
    s_cmp_ge_u32 s68, 4
    s_cbranch_scc0 L_lw_121
    s_mov_b32 s70, 0
L_lw_124:
    ds_read_b32 v15, v18 offset:4
    s_add_u32 s70, s70, 1
    s_cmp_gt_u32 s70, 3200000
    s_cbranch_scc1 L_END
    s_waitcnt lgkmcnt(0)
    v_readfirstlane_b32 s68, v15
    s_nop 1
    s_cmp_ge_u32 s68, 20
    s_cbranch_scc0 L_lw_124
    ds_read_b32 v24, v18 offset:24
    s_cmp_eq_u32 s81, 1
    s_cbranch_scc1 L_nowo_122
    v_bfe_u32 v13, v1, 2, 2
    v_lshl_add_u32 v16, v4, 3, v13
    v_and_b32 v14, 3, v1
    v_lshlrev_b32 v14, 3, v14
    v_lshl_add_u32 v12, v16, 7, v14
    v_lshlrev_b32 v13, 5, v13
    v_and_b32 v13, 64, v13
    v_lshlrev_b32 v14, 1, v1
    v_and_b32 v14, 32, v14
    v_add3_u32 v12, v12, v13, v14
    s_mul_i32 s65, s63, 28672
    s_lshl_b32 s66, s63, 6
    v_xor_b32 v13, s66, v12
    v_xor_b32 v14, 64, v13
    v_add_u32 v13, s65, v13
    v_add_u32 v14, s65, v14
    s_waitcnt vmcnt(0) lgkmcnt(0)
    v_readfirstlane_b32 s65, v24
    s_cmp_eq_u32 s76, 24
    s_nop 0
    s_cselect_b32 s65, s65, 0
    s_cmp_lg_u32 s65, 0
    s_cbranch_scc1 L_slow_early
    s_mov_b32 s70, 0
L_lw_125:
    ds_read_b32 v15, v18 offset:88
    s_add_u32 s70, s70, 1
    s_cmp_gt_u32 s70, 3200000
    s_cbranch_scc1 L_END
    s_waitcnt lgkmcnt(0)
    v_readfirstlane_b32 s68, v15
    s_nop 1
    s_cmp_ge_u32 s68, 4
    s_cbranch_scc0 L_lw_125
    ds_read_b64_tr_b16 v[144:145], v13 offset:0
    ds_read_b64_tr_b16 v[146:147], v13 offset:512
    ds_read_b64_tr_b16 v[148:149], v14 offset:0
    ds_read_b64_tr_b16 v[150:151], v14 offset:512
    ds_read_b64_tr_b16 v[152:153], v13 offset:2048
    ds_read_b64_tr_b16 v[154:155], v13 offset:2560
    ds_read_b64_tr_b16 v[156:157], v14 offset:2048
    ds_read_b64_tr_b16 v[158:159], v14 offset:2560
    s_waitcnt lgkmcnt(4)
    ds_read_b64_tr_b16 v[160:161], v13 offset:4096
    ds_read_b64_tr_b16 v[162:163], v13 offset:4608
    ds_read_b64_tr_b16 v[164:165], v14 offset:4096
    ds_read_b64_tr_b16 v[166:167], v14 offset:4608
    ds_read_b64_tr_b16 v[168:169], v13 offset:6144
    ds_read_b64_tr_b16 v[170:171], v13 offset:6656
    ds_read_b64_tr_b16 v[172:173], v14 offset:6144
    ds_read_b64_tr_b16 v[174:175], v14 offset:6656
    s_waitcnt lgkmcnt(4)
    ds_read_b64_tr_b16 v[176:177], v13 offset:8192
    ds_read_b64_tr_b16 v[178:179], v13 offset:8704
    ds_read_b64_tr_b16 v[180:181], v14 offset:8192
    ds_read_b64_tr_b16 v[182:183], v14 offset:8704
    ds_read_b64_tr_b16 v[184:185], v13 offset:10240
    ds_read_b64_tr_b16 v[186:187], v13 offset:10752
    ds_read_b64_tr_b16 v[188:189], v14 offset:10240
    ds_read_b64_tr_b16 v[190:191], v14 offset:10752
    s_waitcnt lgkmcnt(4)
    ds_read_b64_tr_b16 v[192:193], v13 offset:12288
    ds_read_b64_tr_b16 v[194:195], v13 offset:12800
    ds_read_b64_tr_b16 v[196:197], v14 offset:12288
    ds_read_b64_tr_b16 v[198:199], v14 offset:12800
    ds_read_b64_tr_b16 v[200:201], v13 offset:14336
    ds_read_b64_tr_b16 v[202:203], v13 offset:14848
    ds_read_b64_tr_b16 v[204:205], v14 offset:14336
    ds_read_b64_tr_b16 v[206:207], v14 offset:14848
    s_waitcnt lgkmcnt(4)
    ds_read_b64_tr_b16 v[208:209], v13 offset:16384
    ds_read_b64_tr_b16 v[210:211], v13 offset:16896
    ds_read_b64_tr_b16 v[212:213], v14 offset:16384
    ds_read_b64_tr_b16 v[214:215], v14 offset:16896
    ds_read_b64_tr_b16 v[216:217], v13 offset:18432
    ds_read_b64_tr_b16 v[218:219], v13 offset:18944
    ds_read_b64_tr_b16 v[220:221], v14 offset:18432
    ds_read_b64_tr_b16 v[222:223], v14 offset:18944
    s_waitcnt lgkmcnt(4)
    ds_read_b64_tr_b16 v[224:225], v13 offset:20480
    ds_read_b64_tr_b16 v[226:227], v13 offset:20992
    ds_read_b64_tr_b16 v[228:229], v14 offset:20480
    ds_read_b64_tr_b16 v[230:231], v14 offset:20992
    ds_read_b64_tr_b16 v[232:233], v13 offset:22528
    ds_read_b64_tr_b16 v[234:235], v13 offset:23040
    ds_read_b64_tr_b16 v[236:237], v14 offset:22528
    ds_read_b64_tr_b16 v[238:239], v14 offset:23040
    s_waitcnt lgkmcnt(4)
    ds_read_b64_tr_b16 v[240:241], v13 offset:24576
    ds_read_b64_tr_b16 v[242:243], v13 offset:25088
    ds_read_b64_tr_b16 v[244:245], v14 offset:24576
    ds_read_b64_tr_b16 v[246:247], v14 offset:25088
    ds_read_b64_tr_b16 v[248:249], v13 offset:26624
    ds_read_b64_tr_b16 v[250:251], v13 offset:27136
    ds_read_b64_tr_b16 v[252:253], v14 offset:26624
    ds_read_b64_tr_b16 v[254:255], v14 offset:27136
    s_waitcnt lgkmcnt(4)
    s_waitcnt lgkmcnt(0)
    s_mov_b64 exec, 1
    ds_add_u32 v18, v17 offset:60
    s_mov_b64 exec, -1
    s_mov_b32 s70, 0
L_lw_126:
    ds_read_b32 v15, v18 offset:60
    s_add_u32 s70, s70, 1
    s_cmp_gt_u32 s70, 3200000
    s_cbranch_scc1 L_END
    s_waitcnt lgkmcnt(0)
    v_readfirstlane_b32 s68, v15
    s_nop 1
    s_cmp_ge_u32 s68, 4
    s_cbranch_scc0 L_lw_126
L_nowo_122:
L_red_127:
    s_cmp_lg_u32 s61, 0
    s_cbranch_scc1 L_red_128
    ds_write_b128 v2, v[80:83] offset:12288
    ds_write_b128 v2, v[84:87] offset:13312
    ds_write_b128 v2, v[88:91] offset:14336
    ds_write_b128 v2, v[92:95] offset:15360
    ds_write_b128 v2, v[96:99] offset:24576
    ds_write_b128 v2, v[100:103] offset:25600
    ds_write_b128 v2, v[104:107] offset:26624
    ds_write_b128 v2, v[108:111] offset:27648
    ds_write_b128 v2, v[112:115] offset:36864
    ds_write_b128 v2, v[116:119] offset:37888
    ds_write_b128 v2, v[120:123] offset:38912
    ds_write_b128 v2, v[124:127] offset:39936
    v_mov_b32 v128, v64
    v_mov_b32 v129, v65
    v_mov_b32 v130, v66
    v_mov_b32 v131, v67
    v_mov_b32 v132, v68
    v_mov_b32 v133, v69
    v_mov_b32 v134, v70
    v_mov_b32 v135, v71
    v_mov_b32 v136, v72
    v_mov_b32 v137, v73
    v_mov_b32 v138, v74
    v_mov_b32 v139, v75
    v_mov_b32 v140, v76
    v_mov_b32 v141, v77
    v_mov_b32 v142, v78
    v_mov_b32 v143, v79
    s_branch L_redd_131
L_red_128:
    s_cmp_lg_u32 s61, 1
    s_cbranch_scc1 L_red_129
    ds_write_b128 v2, v[64:67] offset:0
    ds_write_b128 v2, v[68:71] offset:1024
    ds_write_b128 v2, v[72:75] offset:2048
    ds_write_b128 v2, v[76:79] offset:3072
    ds_write_b128 v2, v[96:99] offset:28672
    ds_write_b128 v2, v[100:103] offset:29696
    ds_write_b128 v2, v[104:107] offset:30720
    ds_write_b128 v2, v[108:111] offset:31744
    ds_write_b128 v2, v[112:115] offset:40960
    ds_write_b128 v2, v[116:119] offset:41984
    ds_write_b128 v2, v[120:123] offset:43008
    ds_write_b128 v2, v[124:127] offset:44032
    v_mov_b32 v128, v80
    v_mov_b32 v129, v81
    v_mov_b32 v130, v82
    v_mov_b32 v131, v83
    v_mov_b32 v132, v84
    v_mov_b32 v133, v85
    v_mov_b32 v134, v86
    v_mov_b32 v135, v87
    v_mov_b32 v136, v88
    v_mov_b32 v137, v89
    v_mov_b32 v138, v90
    v_mov_b32 v139, v91
    v_mov_b32 v140, v92
    v_mov_b32 v141, v93
    v_mov_b32 v142, v94
    v_mov_b32 v143, v95
    s_branch L_redd_131
L_red_129:
    s_cmp_lg_u32 s61, 2
    s_cbranch_scc1 L_red_130
    ds_write_b128 v2, v[64:67] offset:4096
    ds_write_b128 v2, v[68:71] offset:5120
    ds_write_b128 v2, v[72:75] offset:6144
    ds_write_b128 v2, v[76:79] offset:7168
    ds_write_b128 v2, v[80:83] offset:16384
    ds_write_b128 v2, v[84:87] offset:17408
    ds_write_b128 v2, v[88:91] offset:18432
    ds_write_b128 v2, v[92:95] offset:19456
    ds_write_b128 v2, v[112:115] offset:45056
    ds_write_b128 v2, v[116:119] offset:46080
    ds_write_b128 v2, v[120:123] offset:47104
    ds_write_b128 v2, v[124:127] offset:48128
    v_mov_b32 v128, v96
    v_mov_b32 v129, v97
    v_mov_b32 v130, v98
    v_mov_b32 v131, v99
    v_mov_b32 v132, v100
    v_mov_b32 v133, v101
    v_mov_b32 v134, v102
    v_mov_b32 v135, v103
    v_mov_b32 v136, v104
    v_mov_b32 v137, v105
    v_mov_b32 v138, v106
    v_mov_b32 v139, v107
    v_mov_b32 v140, v108
    v_mov_b32 v141, v109
    v_mov_b32 v142, v110
    v_mov_b32 v143, v111
    s_branch L_redd_131
L_red_130:
    ds_write_b128 v2, v[64:67] offset:8192
    ds_write_b128 v2, v[68:71] offset:9216
    ds_write_b128 v2, v[72:75] offset:10240
    ds_write_b128 v2, v[76:79] offset:11264
    ds_write_b128 v2, v[80:83] offset:20480
    ds_write_b128 v2, v[84:87] offset:21504
    ds_write_b128 v2, v[88:91] offset:22528
    ds_write_b128 v2, v[92:95] offset:23552
    ds_write_b128 v2, v[96:99] offset:32768
    ds_write_b128 v2, v[100:103] offset:33792
    ds_write_b128 v2, v[104:107] offset:34816
    ds_write_b128 v2, v[108:111] offset:35840
    v_mov_b32 v128, v112
    v_mov_b32 v129, v113
    v_mov_b32 v130, v114
    v_mov_b32 v131, v115
    v_mov_b32 v132, v116
    v_mov_b32 v133, v117
    v_mov_b32 v134, v118
    v_mov_b32 v135, v119
    v_mov_b32 v136, v120
    v_mov_b32 v137, v121
    v_mov_b32 v138, v122
    v_mov_b32 v139, v123
    v_mov_b32 v140, v124
    v_mov_b32 v141, v125
    v_mov_b32 v142, v126
    v_mov_b32 v143, v127
L_redd_131:
    s_mov_b64 exec, 1
    ds_add_u32 v18, v17 offset:4
    s_mov_b64 exec, -1
    s_mul_i32 s65, s61, 12288
    v_add_u32 v13, s65, v2
    s_mov_b32 s70, 0
L_lw_132:
    ds_read_b32 v15, v18 offset:4
    s_add_u32 s70, s70, 1
    s_cmp_gt_u32 s70, 3200000
    s_cbranch_scc1 L_END
    s_waitcnt lgkmcnt(0)
    v_readfirstlane_b32 s68, v15
    s_nop 1
    s_cmp_ge_u32 s68, s76
    s_cbranch_scc0 L_lw_132
    ds_read_b64 v[24:25], v18 offset:24
    ds_read_b128 v[64:67], v13 offset:0
    ds_read_b128 v[68:71], v13 offset:1024
    ds_read_b128 v[72:75], v13 offset:2048
    ds_read_b128 v[76:79], v13 offset:3072
    ds_read_b128 v[80:83], v13 offset:4096
    ds_read_b128 v[84:87], v13 offset:5120
    ds_read_b128 v[88:91], v13 offset:6144
    ds_read_b128 v[92:95], v13 offset:7168
    ds_read_b128 v[96:99], v13 offset:8192
    ds_read_b128 v[100:103], v13 offset:9216
    ds_read_b128 v[104:107], v13 offset:10240
    ds_read_b128 v[108:111], v13 offset:11264
    s_waitcnt lgkmcnt(12)
    v_readfirstlane_b32 s65, v24
    v_readfirstlane_b32 s82, v25
    s_cmp_eq_u32 s76, 24
    s_cselect_b32 s65, s65, 0
    s_cmp_lg_u32 s65, 0
    s_cbranch_scc1 L_slow
    s_waitcnt lgkmcnt(11)
    v_add_f32 v128, v128, v64
    v_add_f32 v129, v129, v65
    v_add_f32 v130, v130, v66
    v_add_f32 v131, v131, v67
    s_waitcnt lgkmcnt(10)
    v_add_f32 v132, v132, v68
    v_add_f32 v133, v133, v69
    v_add_f32 v134, v134, v70
    v_add_f32 v135, v135, v71
    s_waitcnt lgkmcnt(9)
    v_add_f32 v136, v136, v72
    v_add_f32 v137, v137, v73
    v_add_f32 v138, v138, v74
    v_add_f32 v139, v139, v75
    s_waitcnt lgkmcnt(8)
    v_add_f32 v140, v140, v76
    v_add_f32 v141, v141, v77
    v_add_f32 v142, v142, v78
    v_add_f32 v143, v143, v79
    s_waitcnt lgkmcnt(7)
    v_add_f32 v128, v128, v80
    v_add_f32 v129, v129, v81
    v_add_f32 v130, v130, v82
    v_add_f32 v131, v131, v83
    s_waitcnt lgkmcnt(6)
    v_add_f32 v132, v132, v84
    v_add_f32 v133, v133, v85
    v_add_f32 v134, v134, v86
    v_add_f32 v135, v135, v87
    s_waitcnt lgkmcnt(5)
    v_add_f32 v136, v136, v88
    v_add_f32 v137, v137, v89
    v_add_f32 v138, v138, v90
    v_add_f32 v139, v139, v91
    s_waitcnt lgkmcnt(4)
    v_add_f32 v140, v140, v92
    v_add_f32 v141, v141, v93
    v_add_f32 v142, v142, v94
    v_add_f32 v143, v143, v95
    s_waitcnt lgkmcnt(3)
    v_add_f32 v128, v128, v96
    v_add_f32 v129, v129, v97
    v_add_f32 v130, v130, v98
    v_add_f32 v131, v131, v99
    s_waitcnt lgkmcnt(2)
    v_add_f32 v132, v132, v100
    v_add_f32 v133, v133, v101
    v_add_f32 v134, v134, v102
    v_add_f32 v135, v135, v103
    s_waitcnt lgkmcnt(1)
    v_add_f32 v136, v136, v104
    v_add_f32 v137, v137, v105
    v_add_f32 v138, v138, v106
    v_add_f32 v139, v139, v107
    s_waitcnt lgkmcnt(0)
    v_add_f32 v140, v140, v108
    v_add_f32 v141, v141, v109
    v_add_f32 v142, v142, v110
    v_add_f32 v143, v143, v111
    v_mov_b32 v13, v140
    v_mov_b32 v14, v140
    s_nop 1
    v_permlane32_swap_b32 v13, v14
    v_rcp_f32 v14, v14
    s_nop 0
    v_mul_f32 v128, v128, v14
    v_mul_f32 v129, v129, v14
    v_mul_f32 v130, v130, v14
    v_mul_f32 v131, v131, v14
    v_mul_f32 v132, v132, v14
    v_mul_f32 v133, v133, v14
    v_mul_f32 v134, v134, v14
    v_mul_f32 v135, v135, v14
    v_mul_f32 v136, v136, v14
    v_mul_f32 v137, v137, v14
    v_mul_f32 v138, v138, v14
    v_mul_f32 v139, v139, v14
    v_mul_f32 v140, v140, v14
    v_mul_f32 v141, v141, v14
    v_mul_f32 v142, v142, v14
    v_mul_f32 v143, v143, v14
    v_cvt_pk_bf16_f32 v64, v128, v129
    v_cvt_pk_bf16_f32 v65, v130, v131
    v_cvt_pk_bf16_f32 v66, v132, v133
    v_cvt_pk_bf16_f32 v67, v134, v135
    v_cvt_pk_bf16_f32 v68, v136, v137
    v_cvt_pk_bf16_f32 v69, v138, v139
    v_cvt_pk_bf16_f32 v70, v140, v141
    v_cvt_pk_bf16_f32 v71, v142, v143
    s_mul_i32 s65, s63, 7
    v_add_u32 v13, s65, v4
    v_lshrrev_b32 v14, 1, v13
    v_and_b32 v13, 1, v13
    v_lshlrev_b32 v14, 10, v14
    v_lshl_add_u32 v14, v13, 3, v14
    v_lshl_add_u32 v14, v3, 4, v14
    s_mul_i32 s65, s5, 7168
    s_lshl_b32 s66, s62, 9
    s_add_u32 s65, s65, s66
    s_add_u32 s65, s65, s60
    s_add_u32 s65, s65, 114688
    s_cmp_eq_u32 s82, 0
    s_cbranch_scc1 L_far_133
    buffer_store_dwordx2 v[64:65], v14, s[44:47], s65 offen offset:0
    buffer_store_dwordx2 v[66:67], v14, s[44:47], s65 offen offset:1024
    buffer_store_dwordx2 v[68:69], v14, s[44:47], s65 offen offset:2048
    s_mov_b32 exec_lo, -1
    s_mov_b32 exec_hi, 0
    buffer_store_dwordx2 v[70:71], v14, s[44:47], s65 offen offset:3072
    s_mov_b64 exec, -1
    s_branch L_md_134
L_far_133:
    buffer_store_dwordx2 v[64:65], v14, s[44:47], s65 offen offset:0 sc1
    buffer_store_dwordx2 v[66:67], v14, s[44:47], s65 offen offset:1024 sc1
    buffer_store_dwordx2 v[68:69], v14, s[44:47], s65 offen offset:2048 sc1
    s_mov_b32 exec_lo, -1
    s_mov_b32 exec_hi, 0
    buffer_store_dwordx2 v[70:71], v14, s[44:47], s65 offen offset:3072 sc1
    s_mov_b64 exec, -1
L_md_134:
    s_mov_b64 exec, 1
    ds_add_u32 v18, v17 offset:60
    s_mov_b64 exec, -1
    s_waitcnt vmcnt(0)
    s_mov_b64 exec, 1
    ds_add_rtn_u32 v13, v18, v17 offset:16
    s_lshl_b32 s67, s5, 7
    s_add_u32 s67, s67, s80
    s_add_u32 s67, s67, 3072
    s_waitcnt lgkmcnt(0)
    v_readfirstlane_b32 s68, v13
    v_mov_b32 v13, 0
    s_nop 0
    s_cmp_eq_u32 s68, 3
    s_cbranch_scc0 L_sig_135
    s_cmp_eq_u32 s82, 0
    s_cbranch_scc1 L_far_136
    buffer_store_dword v17, v13, s[44:47], s67 offen
    s_branch L_md_137
L_far_136:
    buffer_store_dword v17, v13, s[44:47], s67 offen sc1
L_md_137:
L_sig_135:
    s_mov_b64 exec, -1
    s_setprio 1
    s_cmp_eq_u32 s81, 1
    s_cbranch_scc1 L_a_end
    v_lshlrev_b32 v8, 4, v3
    v_lshl_add_u32 v8, v4, 10, v8
    s_mul_i32 s65, s63, 28672
    s_lshl_b32 s66, s62, 9
    s_add_u32 s65, s65, s66
    s_add_u32 s65, s65, s60
    s_add_u32 s65, s65, 114688
    s_cmp_lg_u32 s61, 0
    s_cbranch_scc1 L_np_138
    s_add_u32 s67, s80, 3072
    v_lshlrev_b32 v13, 7, v1
    s_mov_b32 exec_lo, 0xff
    s_mov_b32 exec_hi, 0
    s_mov_b32 s70, 0
L_poll_140:
    buffer_load_dword v14, v13, s[44:47], s67 offen sc1
    s_add_u32 s70, s70, 1
    s_cmp_gt_u32 s70, 400000
    s_cbranch_scc1 L_END
    s_waitcnt vmcnt(0)
    v_cmp_ne_u32 vcc, 0, v14
    s_nop 1
    s_cmp_eq_u64 vcc, exec
    s_cbranch_scc1 L_poll_140_ok
    s_branch L_poll_140
L_poll_140_ok:
    s_mov_b64 exec, -1
    s_mov_b64 exec, 1
    ds_add_u32 v18, v17 offset:76
    s_mov_b64 exec, -1
    s_branch L_pd_139
L_np_138:
    s_mov_b32 s70, 0
L_lw_141:
    ds_read_b32 v15, v18 offset:76
    s_add_u32 s70, s70, 1
    s_cmp_gt_u32 s70, 3200000
    s_cbranch_scc1 L_END
    s_waitcnt lgkmcnt(0)
    v_readfirstlane_b32 s68, v15
    s_nop 1
    s_cmp_ge_u32 s68, 1
    s_cbranch_scc0 L_lw_141
L_pd_139:
    s_add_u32 s66, s65, 0
    buffer_load_dwordx4 v[32:35], v8, s[44:47], s66 offen sc1
    s_add_u32 s66, s65, 2048
    buffer_load_dwordx4 v[36:39], v8, s[44:47], s66 offen sc1
    s_add_u32 s66, s65, 4096
    buffer_load_dwordx4 v[40:43], v8, s[44:47], s66 offen sc1
    s_add_u32 s66, s65, 6144
    buffer_load_dwordx4 v[44:47], v8, s[44:47], s66 offen sc1
    s_add_u32 s66, s65, 8192
    buffer_load_dwordx4 v[48:51], v8, s[44:47], s66 offen sc1
    s_add_u32 s66, s65, 10240
    buffer_load_dwordx4 v[52:55], v8, s[44:47], s66 offen sc1
    s_add_u32 s66, s65, 12288
    buffer_load_dwordx4 v[56:59], v8, s[44:47], s66 offen sc1
    s_add_u32 s66, s65, 14336
    buffer_load_dwordx4 v[60:63], v8, s[44:47], s66 offen sc1
    s_add_u32 s66, s65, 16384
    buffer_load_dwordx4 v[64:67], v8, s[44:47], s66 offen sc1
    s_add_u32 s66, s65, 18432
    buffer_load_dwordx4 v[68:71], v8, s[44:47], s66 offen sc1
    s_add_u32 s66, s65, 20480
    buffer_load_dwordx4 v[72:75], v8, s[44:47], s66 offen sc1
    s_add_u32 s66, s65, 22528
    buffer_load_dwordx4 v[76:79], v8, s[44:47], s66 offen sc1
    s_add_u32 s66, s65, 24576
    buffer_load_dwordx4 v[80:83], v8, s[44:47], s66 offen sc1
    s_add_u32 s66, s65, 26624
    buffer_load_dwordx4 v[84:87], v8, s[44:47], s66 offen sc1
    s_waitcnt vmcnt(13)
    v_mfma_f32_32x32x16_bf16 v[104:119], v[148:151], v[32:35], 0
    v_mfma_f32_32x32x16_bf16 v[88:103], v[144:147], v[32:35], 0
    s_waitcnt vmcnt(12)
    v_mfma_f32_32x32x16_bf16 v[104:119], v[156:159], v[36:39], v[104:119]
    v_mfma_f32_32x32x16_bf16 v[88:103], v[152:155], v[36:39], v[88:103]
    s_waitcnt vmcnt(11)
    v_mfma_f32_32x32x16_bf16 v[104:119], v[164:167], v[40:43], v[104:119]
    v_mfma_f32_32x32x16_bf16 v[88:103], v[160:163], v[40:43], v[88:103]
    s_waitcnt vmcnt(10)
    v_mfma_f32_32x32x16_bf16 v[104:119], v[172:175], v[44:47], v[104:119]
    v_mfma_f32_32x32x16_bf16 v[88:103], v[168:171], v[44:47], v[88:103]
    s_waitcnt vmcnt(9)
    v_mfma_f32_32x32x16_bf16 v[104:119], v[180:183], v[48:51], v[104:119]
    v_mfma_f32_32x32x16_bf16 v[88:103], v[176:179], v[48:51], v[88:103]
    s_waitcnt vmcnt(8)
    v_mfma_f32_32x32x16_bf16 v[104:119], v[188:191], v[52:55], v[104:119]
    v_mfma_f32_32x32x16_bf16 v[88:103], v[184:187], v[52:55], v[88:103]
    s_waitcnt vmcnt(7)
    v_mfma_f32_32x32x16_bf16 v[104:119], v[196:199], v[56:59], v[104:119]
    v_mfma_f32_32x32x16_bf16 v[88:103], v[192:195], v[56:59], v[88:103]
    s_waitcnt vmcnt(6)
    v_mfma_f32_32x32x16_bf16 v[104:119], v[204:207], v[60:63], v[104:119]
    v_mfma_f32_32x32x16_bf16 v[88:103], v[200:203], v[60:63], v[88:103]
    s_waitcnt vmcnt(5)
    v_mfma_f32_32x32x16_bf16 v[104:119], v[212:215], v[64:67], v[104:119]
    v_mfma_f32_32x32x16_bf16 v[88:103], v[208:211], v[64:67], v[88:103]
    s_waitcnt vmcnt(4)
    v_mfma_f32_32x32x16_bf16 v[104:119], v[220:223], v[68:71], v[104:119]
    v_mfma_f32_32x32x16_bf16 v[88:103], v[216:219], v[68:71], v[88:103]
    s_waitcnt vmcnt(3)
    v_mfma_f32_32x32x16_bf16 v[104:119], v[228:231], v[72:75], v[104:119]
    v_mfma_f32_32x32x16_bf16 v[88:103], v[224:227], v[72:75], v[88:103]
    s_waitcnt vmcnt(2)
    v_mfma_f32_32x32x16_bf16 v[104:119], v[236:239], v[76:79], v[104:119]
    v_mfma_f32_32x32x16_bf16 v[88:103], v[232:235], v[76:79], v[88:103]
    s_waitcnt vmcnt(1)
    v_mfma_f32_32x32x16_bf16 v[104:119], v[244:247], v[80:83], v[104:119]
    v_mfma_f32_32x32x16_bf16 v[88:103], v[240:243], v[80:83], v[88:103]
    s_waitcnt vmcnt(0)
    v_mfma_f32_32x32x16_bf16 v[104:119], v[252:255], v[84:87], v[104:119]
    v_mfma_f32_32x32x16_bf16 v[88:103], v[248:251], v[84:87], v[88:103]
    s_lshl_b32 s65, s61, 13
    s_lshl_b32 s66, s63, 12
    s_add_u32 s65, s65, s66
    v_add_u32 v13, s65, v2
    v_xor_b32 v14, 8192, v13
    s_mov_b32 s70, 0
L_lw_142:
    ds_read_b32 v15, v18 offset:60
    s_add_u32 s70, s70, 1
    s_cmp_gt_u32 s70, 3200000
    s_cbranch_scc1 L_END
    s_waitcnt lgkmcnt(0)
    v_readfirstlane_b32 s68, v15
    s_nop 1
    s_cmp_ge_u32 s68, 8
    s_cbranch_scc0 L_lw_142
    ds_write_b128 v13, v[88:91] offset:0
    ds_write_b128 v14, v[104:107] offset:0
    ds_write_b128 v13, v[92:95] offset:1024
    ds_write_b128 v14, v[108:111] offset:1024
    ds_write_b128 v13, v[96:99] offset:2048
    ds_write_b128 v14, v[112:115] offset:2048
    ds_write_b128 v13, v[100:103] offset:3072
    ds_write_b128 v14, v[116:119] offset:3072
    s_mov_b64 exec, 1
    ds_add_u32 v18, v17 offset:56
    s_mov_b64 exec, -1
L_a_end:
    s_endpgm
L_slow_early:
    s_mov_b64 exec, 1
    ds_add_u32 v18, v17 offset:4
    s_mov_b64 exec, -1
L_slow:
    s_waitcnt vmcnt(0) lgkmcnt(0)
    s_mov_b32 s75, 0
    v_mov_b32 v24, 0xff800000
    v_mov_b32 v25, 0xff800000
    v_mov_b32 v26, 0xff800000
    v_mov_b32 v27, 0xff800000
L_slow_loop:
    s_lshr_b32 s66, s75, 1
    s_add_u32 s65, s6, s66
    s_and_b32 s65, s65, 7
    s_lshl_b32 s65, s65, 15
    s_add_u32 s65, s65, s79
    s_and_b32 s66, s75, 1
    s_lshl_b32 s66, s66, 12
    s_add_u32 s65, s65, s66
    buffer_load_dwordx4 v[64:67], v2, s[44:47], s65 offen offset:0 sc1
    buffer_load_dwordx4 v[68:71], v2, s[44:47], s65 offen offset:1024 sc1
    s_waitcnt vmcnt(0)
    v_mfma_f32_32x32x16_bf16 v[128:143], v[64:67], v[32:35], 0
    v_mfma_f32_32x32x16_bf16 v[128:143], v[68:71], v[36:39], v[128:143]
    s_nop 11
    v_max3_f32 v24, v128, v129, v24
    v_max3_f32 v24, v130, v131, v24
    v_max3_f32 v24, v132, v133, v24
    v_max3_f32 v24, v134, v135, v24
    v_max3_f32 v24, v136, v137, v24
    v_max3_f32 v24, v138, v139, v24
    v_max3_f32 v24, v140, v141, v24
    v_max3_f32 v24, v142, v143, v24
    v_mfma_f32_32x32x16_bf16 v[128:143], v[64:67], v[40:43], 0
    v_mfma_f32_32x32x16_bf16 v[128:143], v[68:71], v[44:47], v[128:143]
    s_nop 11
    v_max3_f32 v25, v128, v129, v25
    v_max3_f32 v25, v130, v131, v25
    v_max3_f32 v25, v132, v133, v25
    v_max3_f32 v25, v134, v135, v25
    v_max3_f32 v25, v136, v137, v25
    v_max3_f32 v25, v138, v139, v25
    v_max3_f32 v25, v140, v141, v25
    v_max3_f32 v25, v142, v143, v25
    v_mfma_f32_32x32x16_bf16 v[128:143], v[64:67], v[48:51], 0
    v_mfma_f32_32x32x16_bf16 v[128:143], v[68:71], v[52:55], v[128:143]
    s_nop 11
    v_max3_f32 v26, v128, v129, v26
    v_max3_f32 v26, v130, v131, v26
    v_max3_f32 v26, v132, v133, v26
    v_max3_f32 v26, v134, v135, v26
    v_max3_f32 v26, v136, v137, v26
    v_max3_f32 v26, v138, v139, v26
    v_max3_f32 v26, v140, v141, v26
    v_max3_f32 v26, v142, v143, v26
    v_mfma_f32_32x32x16_bf16 v[128:143], v[64:67], v[56:59], 0
    v_mfma_f32_32x32x16_bf16 v[128:143], v[68:71], v[60:63], v[128:143]
    s_nop 11
    v_max3_f32 v27, v128, v129, v27
    v_max3_f32 v27, v130, v131, v27
    v_max3_f32 v27, v132, v133, v27
    v_max3_f32 v27, v134, v135, v27
    v_max3_f32 v27, v136, v137, v27
    v_max3_f32 v27, v138, v139, v27
    v_max3_f32 v27, v140, v141, v27
    v_max3_f32 v27, v142, v143, v27
    s_add_u32 s75, s75, 1
    s_cmp_lt_u32 s75, 16
    s_cbranch_scc1 L_slow_loop
    s_lshl_b32 s65, s61, 9
    s_add_u32 s65, s65, 161792
    v_lshl_add_u32 v13, v3, 2, s65
    v_mov_b32 v14, v24
    s_nop 1
    v_permlane32_swap_b32 v24, v14
    v_max_f32 v24, v24, v14
    ds_write_b32 v13, v24 offset:0
    v_mov_b32 v14, v25
    s_nop 1
    v_permlane32_swap_b32 v25, v14
    v_max_f32 v25, v25, v14
    ds_write_b32 v13, v25 offset:128
    v_mov_b32 v14, v26
    s_nop 1
    v_permlane32_swap_b32 v26, v14
    v_max_f32 v26, v26, v14
    ds_write_b32 v13, v26 offset:256
    v_mov_b32 v14, v27
    s_nop 1
    v_permlane32_swap_b32 v27, v14
    v_max_f32 v27, v27, v14
    ds_write_b32 v13, v27 offset:384
    s_mov_b64 exec, 1
    ds_add_u32 v18, v17 offset:4
    s_mov_b64 exec, -1
    s_lshl_b32 s66, s6, 15
    s_add_u32 s65, s66, s79
    v_add_u32 v19, 4096, v2
    s_setprio 3
    buffer_load_dwordx4 v[176:179], v2, s[44:47], s65 offen offset:0 sc1
    buffer_load_dwordx4 v[180:183], v2, s[44:47], s65 offen offset:1024 sc1
    buffer_load_dwordx4 v[184:187], v2, s[44:47], s65 offen offset:2048 sc1
    buffer_load_dwordx4 v[188:191], v2, s[44:47], s65 offen offset:3072 sc1
    s_setprio 1
    s_setprio 3
    buffer_load_dwordx4 v[192:195], v19, s[44:47], s65 offen offset:0 sc1
    buffer_load_dwordx4 v[196:199], v19, s[44:47], s65 offen offset:1024 sc1
    buffer_load_dwordx4 v[200:203], v19, s[44:47], s65 offen offset:2048 sc1
    buffer_load_dwordx4 v[204:207], v19, s[44:47], s65 offen offset:3072 sc1
    s_setprio 1
    s_mov_b32 s70, 0
L_lw_143:
    ds_read_b32 v15, v18 offset:4
    s_add_u32 s70, s70, 1
    s_cmp_gt_u32 s70, 3200000
    s_cbranch_scc1 L_END
    s_waitcnt lgkmcnt(0)
    v_readfirstlane_b32 s68, v15
    s_nop 1
    s_cmp_ge_u32 s68, 28
    s_cbranch_scc0 L_lw_143
    v_lshlrev_b32 v13, 2, v3
    v_add_u32 v13, 161792, v13
    ds_read_b32 v128, v13 offset:0
    ds_read_b32 v129, v13 offset:512
    ds_read_b32 v130, v13 offset:1024
    ds_read_b32 v131, v13 offset:1536
    s_waitcnt lgkmcnt(0)
    ds_read_b32 v132, v13 offset:128
    ds_read_b32 v133, v13 offset:640
    ds_read_b32 v134, v13 offset:1152
    ds_read_b32 v135, v13 offset:1664
    s_waitcnt lgkmcnt(0)
    ds_read_b32 v136, v13 offset:256
    ds_read_b32 v137, v13 offset:768
    ds_read_b32 v138, v13 offset:1280
    ds_read_b32 v139, v13 offset:1792
    s_waitcnt lgkmcnt(0)
    ds_read_b32 v140, v13 offset:384
    ds_read_b32 v141, v13 offset:896
    ds_read_b32 v142, v13 offset:1408
    ds_read_b32 v143, v13 offset:1920
    s_waitcnt lgkmcnt(0)
    s_mov_b32 exec_lo, 0
    s_mov_b32 exec_hi, -1
    v_max3_f32 v128, v128, v129, v130
    v_max_f32 v128, v128, v131
    v_sub_f32 v128, 0, v128
    v_and_b32 v129, 0xffff0000, v128
    v_sub_f32 v128, v128, v129
    v_and_b32 v130, 0xffff0000, v128
    v_sub_f32 v128, v128, v130
    v_lshrrev_b32 v129, 16, v129
    v_or_b32 v38, v129, v130
    v_lshrrev_b32 v39, 16, v128
    v_max3_f32 v132, v132, v133, v134
    v_max_f32 v132, v132, v135
    v_sub_f32 v132, 0, v132
    v_and_b32 v133, 0xffff0000, v132
    v_sub_f32 v132, v132, v133
    v_and_b32 v134, 0xffff0000, v132
    v_sub_f32 v132, v132, v134
    v_lshrrev_b32 v133, 16, v133
    v_or_b32 v46, v133, v134
    v_lshrrev_b32 v47, 16, v132
    v_max3_f32 v136, v136, v137, v138
    v_max_f32 v136, v136, v139
    v_sub_f32 v136, 0, v136
    v_and_b32 v137, 0xffff0000, v136
    v_sub_f32 v136, v136, v137
    v_and_b32 v138, 0xffff0000, v136
    v_sub_f32 v136, v136, v138
    v_lshrrev_b32 v137, 16, v137
    v_or_b32 v54, v137, v138
    v_lshrrev_b32 v55, 16, v136
    v_max3_f32 v140, v140, v141, v142
    v_max_f32 v140, v140, v143
    v_sub_f32 v140, 0, v140
    v_and_b32 v141, 0xffff0000, v140
    v_sub_f32 v140, v140, v141
    v_and_b32 v142, 0xffff0000, v140
    v_sub_f32 v140, v140, v142
    v_lshrrev_b32 v141, 16, v141
    v_or_b32 v62, v141, v142
    v_lshrrev_b32 v63, 16, v140
    s_mov_b64 exec, -1
    v_mov_b32 v64, 0
    v_mov_b32 v65, 0
    v_mov_b32 v66, 0
    v_mov_b32 v67, 0
    v_mov_b32 v68, 0
    v_mov_b32 v69, 0
    v_mov_b32 v70, 0
    v_mov_b32 v71, 0
    v_mov_b32 v72, 0
    v_mov_b32 v73, 0
    v_mov_b32 v74, 0
    v_mov_b32 v75, 0
    v_mov_b32 v76, 0
    v_mov_b32 v77, 0
    v_mov_b32 v78, 0
    v_mov_b32 v79, 0
    v_mov_b32 v80, 0
    v_mov_b32 v81, 0
    v_mov_b32 v82, 0
    v_mov_b32 v83, 0
    v_mov_b32 v84, 0
    v_mov_b32 v85, 0
    v_mov_b32 v86, 0
    v_mov_b32 v87, 0
    v_mov_b32 v88, 0
    v_mov_b32 v89, 0
    v_mov_b32 v90, 0
    v_mov_b32 v91, 0
    v_mov_b32 v92, 0
    v_mov_b32 v93, 0
    v_mov_b32 v94, 0
    v_mov_b32 v95, 0
    v_mov_b32 v96, 0
    v_mov_b32 v97, 0
    v_mov_b32 v98, 0
    v_mov_b32 v99, 0
    v_mov_b32 v100, 0
    v_mov_b32 v101, 0
    v_mov_b32 v102, 0
    v_mov_b32 v103, 0
    v_mov_b32 v104, 0
    v_mov_b32 v105, 0
    v_mov_b32 v106, 0
    v_mov_b32 v107, 0
    v_mov_b32 v108, 0
    v_mov_b32 v109, 0
    v_mov_b32 v110, 0
    v_mov_b32 v111, 0
    v_mov_b32 v112, 0
    v_mov_b32 v113, 0
    v_mov_b32 v114, 0
    v_mov_b32 v115, 0
    v_mov_b32 v116, 0
    v_mov_b32 v117, 0
    v_mov_b32 v118, 0
    v_mov_b32 v119, 0
    v_mov_b32 v120, 0
    v_mov_b32 v121, 0
    v_mov_b32 v122, 0
    v_mov_b32 v123, 0
    v_mov_b32 v124, 0
    v_mov_b32 v125, 0
    v_mov_b32 v126, 0
    v_mov_b32 v127, 0
    s_mov_b32 s76, 32
    s_branch L_attn
L_END:
    s_endpgm
L_CODE_END:
.section .rodata,"a"
.p2align 6
.amdhsa_kernel recurrent_scan__grouped_kv_mqa__mixer_s_mlp__prompt_kernel
  .amdhsa_next_free_vgpr 256
  .amdhsa_next_free_sgpr 100
  .amdhsa_accum_offset 256
  .amdhsa_group_segment_fixed_size 0
  .amdhsa_kernarg_size 104
  .amdhsa_user_sgpr_count 2
  .amdhsa_user_sgpr_kernarg_segment_ptr 1
  .amdhsa_system_sgpr_workgroup_id_x 1
.end_amdhsa_kernel
```
